```python
import torch

def _softmax(x, axis=-1):
    return torch.softmax(x, dim=axis)
def _gelu(x):
    return torch.nn.functional.gelu(x, approximate="tanh")
def _silu(x):
    return torch.nn.functional.silu(x)
def _sigmoid(x):
    return torch.sigmoid(x)
def _layernorm(x, axis=-1, eps=1e-5):
    m = x.mean(dim=axis, keepdim=True)
    v = x.var(dim=axis, keepdim=True, unbiased=False)
    return (x - m) / torch.sqrt(v + eps)
def _scatter_add(tgt, idx, src, axis=0):
    return tgt.clone().index_add_(axis, idx, src)
def _segment_sum(src, seg, n):
    out = torch.zeros((n,) + src.shape[1:], dtype=src.dtype)
    return out.index_add_(0, seg, src)
def _pad(x, pw):
    flat = tuple(v for pair in reversed(pw) for v in pair)
    return torch.nn.functional.pad(x, flat)

kernel_name = 'recurrent_scan__sliding_local_dilated__dense_activation_relu__prompt'

def setup_inputs():

    _w = (lambda a: (lambda t: t.to(torch.bfloat16) if t.is_floating_point() else t)(torch.as_tensor(a)))
    def _A_setup():
        B, S, D = 1, 2048, 576
        return {
            "x": _w((lambda *s: torch.randn(*s, dtype=torch.bfloat16) * 0.05)(B, S, D)),
            "wqkv": _w((lambda *s: torch.randn(*s, dtype=torch.bfloat16) * 0.05)(D, 3 * D)),
            "wo": _w((lambda *s: torch.randn(*s, dtype=torch.bfloat16) * 0.05)(D, D)),
        }
    _A_in = _A_setup()

    def _B_setup():
        B, S, D, Dff = 1, 2048, 576, 4608
        return {
            "x": _w((lambda *s: torch.randn(*s, dtype=torch.bfloat16) * 0.05)(B, S, D)),
            "w1": _w((lambda *s: torch.randn(*s, dtype=torch.bfloat16) * 0.05)(D, Dff)),
            "w2": _w((lambda *s: torch.randn(*s, dtype=torch.bfloat16) * 0.05)(Dff, D)),
        }
    _B_in = _B_setup()

    return {
        "A_x": _A_in["x"],
        "A_wqkv": _A_in["wqkv"],
        "A_wo": _A_in["wo"],
        "B_x": _B_in["x"],
        "B_w1": _B_in["w1"],
        "B_w2": _B_in["w2"],
    }

def reference(A_x, A_wqkv, A_wo, B_x, B_w1, B_w2):
    def _A_ref(x, wqkv, wo):
        B, S, D = x.shape
        H = 32; Dh = D // H
        W, dil = 8, 2
        qkv = (lambda x, *d: x.permute(*d))((x @ wqkv).reshape(B, S, 3, H, Dh), 2, 0, 3, 1, 4)
        q, k, v = qkv[0], qkv[1], qkv[2]
        scale = Dh ** -0.5
        pos = torch.arange(S)
        off = torch.arange(W) * dil
        idx = pos[:, None] - off[None, :]
        mask = idx >= 0
        idx_c = torch.where(mask, idx, 0).reshape(-1)
        kg = k[:, :, idx_c, :].reshape(B, H, S, W, Dh)
        vg = v[:, :, idx_c, :].reshape(B, H, S, W, Dh)
        logits = torch.einsum("bhsd,bhswd->bhsw", q, kg) * scale
        logits = torch.where(mask[None, None, :, :], logits, -1e9)
        attn = _softmax(logits, axis=-1)
        o = torch.einsum("bhsw,bhswd->bhsd", attn, vg)
        return (lambda x, *d: x.permute(*d))(o, 0, 2, 1, 3).reshape(B, S, D) @ wo

    def _B_ref(x, w1, w2):
        h = torch.einsum("bsd,df->bsf", x, w1)
        zero = torch.zeros_like(h)
        h = torch.maximum(h, zero)
        return torch.einsum("bsf,fd->bsd", h, w2)

    x = A_x
    xn = _layernorm(x, axis=-1)
    s = _A_ref(xn, A_wqkv, A_wo)
    g = _silu(_B_ref(xn, B_w1, B_w2))
    return x + s * g
```

```asm
; @launch grid=(256,1,1) block=(256,1,1) lds=163840
.amdgcn_target "amdgcn-amd-amdhsa--gfx950"
.text
.globl recurrent_scan__sliding_local_dilated__dense_activation_relu__prompt_kernel
.p2align 8
.type recurrent_scan__sliding_local_dilated__dense_activation_relu__prompt_kernel,@function
recurrent_scan__sliding_local_dilated__dense_activation_relu__prompt_kernel:
    s_cmp_ge_u32 s2, 256
    s_cbranch_scc1 Lend1
    s_load_dwordx16 s[64:79], s[0:1], 0
    s_load_dwordx2 s[80:81], s[0:1], 64
    v_and_b32 v1, 63, v0
    v_lshrrev_b32 v96, 6, v0
    v_and_b32 v2, 31, v0
    v_readfirstlane_b32 s20, v96
    v_bfe_u32 v3, v0, 5, 1
    s_and_b32 s54, s2, 3
    s_bfe_u32 s55, s2, 0x20003
    s_bfe_u32 s56, s2, 0x10002
    s_lshr_b32 s57, s2, 5
    s_lshl_b32 s21, s56, 3
    s_add_u32 s21, s21, s57
    s_mul_i32 s22, s54, 3
    s_add_u32 s22, s22, s55
    s_add_u32 s56, s54, 12
    s_cmp_eq_u32 s55, 3
    s_cselect_b32 s22, s56, s22
    s_cselect_b32 s23, 1, 0
    s_mul_i32 s59, s20, 6144
    s_mov_b32 s41, 0x3f803f80
    s_mov_b32 s42, 0x00003f80
    s_mov_b32 s43, 0x3f800000
    v_lshrrev_b32 v96, 3, v1
    v_and_b32 v97, 7, v1
    v_lshrrev_b32 v98, 1, v96
    v_xor_b32 v98, v97, v98
    v_mul_u32_u24 v99, 1152, v96
    v_lshl_add_u32 v100, v98, 4, v99
    v_xor_b32 v101, 64, v100
    s_waitcnt lgkmcnt(0)
    s_mov_b32 s8, s64
    s_and_b32 s9, s65, 0xffff
    s_mov_b32 s10, 2359296
    s_mov_b32 s11, 0x00020000
    s_mov_b32 s12, s80
    s_and_b32 s13, s81, 0xffff
    s_mov_b32 s14, 38371328
    s_mov_b32 s15, 0x00020000
    s_mov_b32 s16, s78
    s_and_b32 s17, s79, 0xffff
    s_mov_b32 s18, 256
    s_mov_b32 s19, 0x00020000
    s_mul_i32 s63, s21, 1536
    s_add_u32 s63, s63, 38338560
    s_lshl_b32 s62, s21, 4
    s_add_u32 s54, s20, s22
    s_cmp_eq_u32 s54, 0
    s_cselect_b32 s63, s63, 1073741824
    s_cselect_b32 s62, s62, 1073741824
    v_min_u32 v24, 47, v1
    v_and_b32 v25, 3, v24
    v_lshrrev_b32 v24, 2, v24
    v_lshlrev_b32 v24, 7, v24
    v_lshl_add_u32 v24, v25, 4, v24
    v_mov_b32 v76, 0
    v_mov_b32 v77, 0
    v_mov_b32 v78, 0
    v_mov_b32 v79, 0
    buffer_store_dwordx4 v[76:79], v24, s[12:15], s63 offen sc0 sc1
    s_lshl_b32 s54, s21, 7
    s_lshl_b32 s55, s20, 5
    s_add_u32 s54, s54, s55
    s_mul_i32 s54, s54, 1152
    s_add_u32 s55, s54, 9216
    s_add_u32 s56, s54, 18432
    s_add_u32 s57, s54, 27648
    s_mul_i32 s60, s20, 36864
    s_add_u32 m0, s60, 0
    s_nop 0
    buffer_load_dwordx4 v100, s[8:11], s54 offen offset:0 lds
    s_add_u32 m0, s60, 9216
    s_nop 0
    buffer_load_dwordx4 v101, s[8:11], s55 offen offset:0 lds
    s_add_u32 m0, s60, 18432
    s_nop 0
    buffer_load_dwordx4 v100, s[8:11], s56 offen offset:0 lds
    s_add_u32 m0, s60, 27648
    s_nop 0
    buffer_load_dwordx4 v101, s[8:11], s57 offen offset:0 lds
    s_add_u32 m0, s60, 896
    s_nop 0
    buffer_load_dwordx4 v100, s[8:11], s54 offen offset:128 lds
    s_add_u32 m0, s60, 10112
    s_nop 0
    buffer_load_dwordx4 v101, s[8:11], s55 offen offset:128 lds
    s_add_u32 m0, s60, 19328
    s_nop 0
    buffer_load_dwordx4 v100, s[8:11], s56 offen offset:128 lds
    s_add_u32 m0, s60, 28544
    s_nop 0
    buffer_load_dwordx4 v101, s[8:11], s57 offen offset:128 lds
    s_add_u32 m0, s60, 1792
    s_nop 0
    buffer_load_dwordx4 v100, s[8:11], s54 offen offset:256 lds
    s_add_u32 m0, s60, 11008
    s_nop 0
    buffer_load_dwordx4 v101, s[8:11], s55 offen offset:256 lds
    s_add_u32 m0, s60, 20224
    s_nop 0
    buffer_load_dwordx4 v100, s[8:11], s56 offen offset:256 lds
    s_add_u32 m0, s60, 29440
    s_nop 0
    buffer_load_dwordx4 v101, s[8:11], s57 offen offset:256 lds
    s_add_u32 m0, s60, 2688
    s_nop 0
    buffer_load_dwordx4 v100, s[8:11], s54 offen offset:384 lds
    s_add_u32 m0, s60, 11904
    s_nop 0
    buffer_load_dwordx4 v101, s[8:11], s55 offen offset:384 lds
    s_add_u32 m0, s60, 21120
    s_nop 0
    buffer_load_dwordx4 v100, s[8:11], s56 offen offset:384 lds
    s_add_u32 m0, s60, 30336
    s_nop 0
    buffer_load_dwordx4 v101, s[8:11], s57 offen offset:384 lds
    s_add_u32 m0, s60, 3584
    s_nop 0
    buffer_load_dwordx4 v100, s[8:11], s54 offen offset:512 lds
    s_add_u32 m0, s60, 12800
    s_nop 0
    buffer_load_dwordx4 v101, s[8:11], s55 offen offset:512 lds
    s_add_u32 m0, s60, 22016
    s_nop 0
    buffer_load_dwordx4 v100, s[8:11], s56 offen offset:512 lds
    s_add_u32 m0, s60, 31232
    s_nop 0
    buffer_load_dwordx4 v101, s[8:11], s57 offen offset:512 lds
    s_add_u32 m0, s60, 4480
    s_nop 0
    buffer_load_dwordx4 v100, s[8:11], s54 offen offset:640 lds
    s_add_u32 m0, s60, 13696
    s_nop 0
    buffer_load_dwordx4 v101, s[8:11], s55 offen offset:640 lds
    s_add_u32 m0, s60, 22912
    s_nop 0
    buffer_load_dwordx4 v100, s[8:11], s56 offen offset:640 lds
    s_add_u32 m0, s60, 32128
    s_nop 0
    buffer_load_dwordx4 v101, s[8:11], s57 offen offset:640 lds
    s_add_u32 m0, s60, 5376
    s_nop 0
    buffer_load_dwordx4 v100, s[8:11], s54 offen offset:768 lds
    s_add_u32 m0, s60, 14592
    s_nop 0
    buffer_load_dwordx4 v101, s[8:11], s55 offen offset:768 lds
    s_add_u32 m0, s60, 23808
    s_nop 0
    buffer_load_dwordx4 v100, s[8:11], s56 offen offset:768 lds
    s_add_u32 m0, s60, 33024
    s_nop 0
    buffer_load_dwordx4 v101, s[8:11], s57 offen offset:768 lds
    s_add_u32 m0, s60, 6272
    s_nop 0
    buffer_load_dwordx4 v100, s[8:11], s54 offen offset:896 lds
    s_add_u32 m0, s60, 15488
    s_nop 0
    buffer_load_dwordx4 v101, s[8:11], s55 offen offset:896 lds
    s_add_u32 m0, s60, 24704
    s_nop 0
    buffer_load_dwordx4 v100, s[8:11], s56 offen offset:896 lds
    s_add_u32 m0, s60, 33920
    s_nop 0
    buffer_load_dwordx4 v101, s[8:11], s57 offen offset:896 lds
    s_add_u32 m0, s60, 7168
    s_nop 0
    buffer_load_dwordx4 v100, s[8:11], s54 offen offset:1024 lds
    s_add_u32 m0, s60, 16384
    s_nop 0
    buffer_load_dwordx4 v101, s[8:11], s55 offen offset:1024 lds
    s_add_u32 m0, s60, 25600
    s_nop 0
    buffer_load_dwordx4 v100, s[8:11], s56 offen offset:1024 lds
    s_add_u32 m0, s60, 34816
    s_nop 0
    buffer_load_dwordx4 v101, s[8:11], s57 offen offset:1024 lds
    s_lshl_b32 s54, s2, 2
    s_add_u32 s54, s54, s20
    s_mov_b32 s44, s66
    s_and_b32 s45, s67, 0xffff
    s_mov_b32 s46, 1990656
    s_mov_b32 s47, 0x00020000
    v_min_u32 v96, 15, v1
    v_lshlrev_b32 v96, 7, v96
    s_mul_i32 s55, s54, 2048
    buffer_load_dword a63, v96, s[44:47], s55 offen
    s_mov_b32 s44, s72
    s_and_b32 s45, s73, 0xffff
    s_mov_b32 s46, 0
    s_mov_b32 s47, 0x00020000
    v_min_u32 v96, 40, v1
    v_lshlrev_b32 v96, 7, v96
    s_mul_i32 s55, s54, 5248
    buffer_load_dword a63, v96, s[44:47], s55 offen
    s_mov_b32 s44, s68
    s_and_b32 s45, s69, 0xffff
    s_mov_b32 s46, 663552
    s_mov_b32 s47, 0x00020000
    v_min_u32 v96, 5, v1
    v_lshlrev_b32 v96, 7, v96
    s_mul_i32 s55, s54, 768
    buffer_load_dword a63, v96, s[44:47], s55 offen
    s_mov_b32 s44, s74
    s_and_b32 s45, s75, 0xffff
    s_mov_b32 s46, 5308416
    s_mov_b32 s47, 0x00020000
    v_min_u32 v79, 13, v1
    v_lshlrev_b32 v79, 7, v79
    s_mul_i32 s52, s54, 5376
    s_lshr_b32 s82, s2, 3
    s_and_b32 s82, s82, 31
    s_lshl_b32 s82, s82, 2
    s_add_u32 s82, s82, s20
    s_and_b32 s83, s82, 7
    s_lshr_b32 s82, s82, 3
    s_mov_b64 exec, 0
Lhop:
    s_cmp_eq_u32 s82, 0
    s_cbranch_scc1 Lwg0
    s_cmp_eq_u32 s82, 1
    s_cbranch_scc1 Lwg1
    s_cmp_eq_u32 s82, 2
    s_cbranch_scc1 Lwg2
    s_cmp_eq_u32 s82, 3
    s_cbranch_scc1 Lwg3
    s_cmp_eq_u32 s82, 4
    s_cbranch_scc1 Lwg4
    s_cmp_eq_u32 s82, 5
    s_cbranch_scc1 Lwg5
    s_cmp_eq_u32 s82, 6
    s_cbranch_scc1 Lwg6
    s_cmp_eq_u32 s82, 7
    s_cbranch_scc1 Lwg7
    s_cmp_eq_u32 s82, 8
    s_cbranch_scc1 Lwg8
    s_cmp_eq_u32 s82, 9
    s_cbranch_scc1 Lwg9
    s_cmp_eq_u32 s82, 10
    s_cbranch_scc1 Lwg10
    s_cmp_eq_u32 s82, 11
    s_cbranch_scc1 Lwg11
    s_cmp_eq_u32 s82, 12
    s_cbranch_scc1 Lwg12
    s_branch Ldone
Lwg0:
    s_cmp_eq_u32 s83, 0
    s_cbranch_scc1 Lpad0
    s_cmp_eq_u32 s83, 1
    s_cbranch_scc1 Lpad1
    s_cmp_eq_u32 s83, 2
    s_cbranch_scc1 Lpad2
    s_cmp_eq_u32 s83, 3
    s_cbranch_scc1 Lpad3
    s_cmp_eq_u32 s83, 4
    s_cbranch_scc1 Lpad4
    s_cmp_eq_u32 s83, 5
    s_cbranch_scc1 Lpad5
    s_cmp_eq_u32 s83, 6
    s_cbranch_scc1 Lpad6
    s_cmp_eq_u32 s83, 7
    s_cbranch_scc1 Lpad7
    s_branch Lret
Lwg1:
    s_cmp_eq_u32 s83, 0
    s_cbranch_scc1 Lpad8
    s_cmp_eq_u32 s83, 1
    s_cbranch_scc1 Lpad9
    s_cmp_eq_u32 s83, 2
    s_cbranch_scc1 Lpad10
    s_cmp_eq_u32 s83, 3
    s_cbranch_scc1 Lpad11
    s_cmp_eq_u32 s83, 4
    s_cbranch_scc1 Lpad12
    s_cmp_eq_u32 s83, 5
    s_cbranch_scc1 Lpad13
    s_cmp_eq_u32 s83, 6
    s_cbranch_scc1 Lpad14
    s_cmp_eq_u32 s83, 7
    s_cbranch_scc1 Lpad15
    s_branch Lret
Lwg2:
    s_cmp_eq_u32 s83, 0
    s_cbranch_scc1 Lpad16
    s_cmp_eq_u32 s83, 1
    s_cbranch_scc1 Lpad17
    s_cmp_eq_u32 s83, 2
    s_cbranch_scc1 Lpad18
    s_cmp_eq_u32 s83, 3
    s_cbranch_scc1 Lpad19
    s_cmp_eq_u32 s83, 4
    s_cbranch_scc1 Lpad20
    s_cmp_eq_u32 s83, 5
    s_cbranch_scc1 Lpad21
    s_cmp_eq_u32 s83, 6
    s_cbranch_scc1 Lpad22
    s_cmp_eq_u32 s83, 7
    s_cbranch_scc1 Lpad23
    s_branch Lret
Lwg3:
    s_cmp_eq_u32 s83, 0
    s_cbranch_scc1 Lpad24
    s_cmp_eq_u32 s83, 1
    s_cbranch_scc1 Lpad25
    s_cmp_eq_u32 s83, 2
    s_cbranch_scc1 Lpad26
    s_cmp_eq_u32 s83, 3
    s_cbranch_scc1 Lpad27
    s_cmp_eq_u32 s83, 4
    s_cbranch_scc1 Lpad28
    s_cmp_eq_u32 s83, 5
    s_cbranch_scc1 Lpad29
    s_cmp_eq_u32 s83, 6
    s_cbranch_scc1 Lpad30
    s_cmp_eq_u32 s83, 7
    s_cbranch_scc1 Lpad31
    s_branch Lret
Lwg4:
    s_cmp_eq_u32 s83, 0
    s_cbranch_scc1 Lpad32
    s_cmp_eq_u32 s83, 1
    s_cbranch_scc1 Lpad33
    s_cmp_eq_u32 s83, 2
    s_cbranch_scc1 Lpad34
    s_cmp_eq_u32 s83, 3
    s_cbranch_scc1 Lpad35
    s_cmp_eq_u32 s83, 4
    s_cbranch_scc1 Lpad36
    s_cmp_eq_u32 s83, 5
    s_cbranch_scc1 Lpad37
    s_cmp_eq_u32 s83, 6
    s_cbranch_scc1 Lpad38
    s_cmp_eq_u32 s83, 7
    s_cbranch_scc1 Lpad39
    s_branch Lret
Lwg5:
    s_cmp_eq_u32 s83, 0
    s_cbranch_scc1 Lpad40
    s_cmp_eq_u32 s83, 1
    s_cbranch_scc1 Lpad41
    s_cmp_eq_u32 s83, 2
    s_cbranch_scc1 Lpad42
    s_cmp_eq_u32 s83, 3
    s_cbranch_scc1 Lpad43
    s_cmp_eq_u32 s83, 4
    s_cbranch_scc1 Lpad44
    s_cmp_eq_u32 s83, 5
    s_cbranch_scc1 Lpad45
    s_cmp_eq_u32 s83, 6
    s_cbranch_scc1 Lpad46
    s_cmp_eq_u32 s83, 7
    s_cbranch_scc1 Lpad47
    s_branch Lret
Lwg6:
    s_cmp_eq_u32 s83, 0
    s_cbranch_scc1 Lpad48
    s_cmp_eq_u32 s83, 1
    s_cbranch_scc1 Lpad49
    s_cmp_eq_u32 s83, 2
    s_cbranch_scc1 Lpad50
    s_cmp_eq_u32 s83, 3
    s_cbranch_scc1 Lpad51
    s_cmp_eq_u32 s83, 4
    s_cbranch_scc1 Lpad52
    s_cmp_eq_u32 s83, 5
    s_cbranch_scc1 Lpad53
    s_cmp_eq_u32 s83, 6
    s_cbranch_scc1 Lpad54
    s_cmp_eq_u32 s83, 7
    s_cbranch_scc1 Lpad55
    s_branch Lret
Lwg7:
    s_cmp_eq_u32 s83, 0
    s_cbranch_scc1 Lpad56
    s_cmp_eq_u32 s83, 1
    s_cbranch_scc1 Lpad57
    s_cmp_eq_u32 s83, 2
    s_cbranch_scc1 Lpad58
    s_cmp_eq_u32 s83, 3
    s_cbranch_scc1 Lpad59
    s_cmp_eq_u32 s83, 4
    s_cbranch_scc1 Lpad60
    s_cmp_eq_u32 s83, 5
    s_cbranch_scc1 Lpad61
    s_cmp_eq_u32 s83, 6
    s_cbranch_scc1 Lpad62
    s_cmp_eq_u32 s83, 7
    s_cbranch_scc1 Lpad63
    s_branch Lret
Lwg8:
    s_cmp_eq_u32 s83, 0
    s_cbranch_scc1 Lpad64
    s_cmp_eq_u32 s83, 1
    s_cbranch_scc1 Lpad65
    s_cmp_eq_u32 s83, 2
    s_cbranch_scc1 Lpad66
    s_cmp_eq_u32 s83, 3
    s_cbranch_scc1 Lpad67
    s_cmp_eq_u32 s83, 4
    s_cbranch_scc1 Lpad68
    s_cmp_eq_u32 s83, 5
    s_cbranch_scc1 Lpad69
    s_cmp_eq_u32 s83, 6
    s_cbranch_scc1 Lpad70
    s_cmp_eq_u32 s83, 7
    s_cbranch_scc1 Lpad71
    s_branch Lret
Lwg9:
    s_cmp_eq_u32 s83, 0
    s_cbranch_scc1 Lpad72
    s_cmp_eq_u32 s83, 1
    s_cbranch_scc1 Lpad73
    s_cmp_eq_u32 s83, 2
    s_cbranch_scc1 Lpad74
    s_cmp_eq_u32 s83, 3
    s_cbranch_scc1 Lpad75
    s_cmp_eq_u32 s83, 4
    s_cbranch_scc1 Lpad76
    s_cmp_eq_u32 s83, 5
    s_cbranch_scc1 Lpad77
    s_cmp_eq_u32 s83, 6
    s_cbranch_scc1 Lpad78
    s_cmp_eq_u32 s83, 7
    s_cbranch_scc1 Lpad79
    s_branch Lret
Lwg10:
    s_cmp_eq_u32 s83, 0
    s_cbranch_scc1 Lpad80
    s_cmp_eq_u32 s83, 1
    s_cbranch_scc1 Lpad81
    s_cmp_eq_u32 s83, 2
    s_cbranch_scc1 Lpad82
    s_cmp_eq_u32 s83, 3
    s_cbranch_scc1 Lpad83
    s_cmp_eq_u32 s83, 4
    s_cbranch_scc1 Lpad84
    s_cmp_eq_u32 s83, 5
    s_cbranch_scc1 Lpad85
    s_cmp_eq_u32 s83, 6
    s_cbranch_scc1 Lpad86
    s_cmp_eq_u32 s83, 7
    s_cbranch_scc1 Lpad87
    s_branch Lret
Lwg11:
    s_cmp_eq_u32 s83, 0
    s_cbranch_scc1 Lpad88
    s_cmp_eq_u32 s83, 1
    s_cbranch_scc1 Lpad89
    s_cmp_eq_u32 s83, 2
    s_cbranch_scc1 Lpad90
    s_cmp_eq_u32 s83, 3
    s_cbranch_scc1 Lpad91
    s_cmp_eq_u32 s83, 4
    s_cbranch_scc1 Lpad92
    s_cmp_eq_u32 s83, 5
    s_cbranch_scc1 Lpad93
    s_cmp_eq_u32 s83, 6
    s_cbranch_scc1 Lpad94
    s_cmp_eq_u32 s83, 7
    s_cbranch_scc1 Lpad95
    s_branch Lret
Lwg12:
    s_cmp_eq_u32 s83, 0
    s_cbranch_scc1 Lpad96
    s_cmp_eq_u32 s83, 1
    s_cbranch_scc1 Lpad97
    s_cmp_eq_u32 s83, 2
    s_cbranch_scc1 Lpad98
    s_cmp_eq_u32 s83, 3
    s_cbranch_scc1 Lpad99
    s_cmp_eq_u32 s83, 4
    s_cbranch_scc1 Lpad100
    s_branch Lret
Lret:
    s_add_u32 s82, s82, 16
    s_cmp_lt_u32 s82, 13
    s_cbranch_scc1 Lhop
Ldone:
    s_mov_b64 exec, -1
    v_lshrrev_b32 v96, 3, v2
    v_mul_u32_u24 v96, 9216, v96
    v_and_b32 v97, 7, v2
    v_lshl_add_u32 v96, v97, 7, v96
    v_add_u32 v96, s60, v96
    v_bfe_u32 v97, v2, 1, 3
    v_xor_b32 v97, v97, v3
    v_xor_b32 v98, 0, v97
    v_lshl_add_u32 v102, v98, 4, v96
    v_xor_b32 v98, 2, v97
    v_lshl_add_u32 v103, v98, 4, v96
    v_xor_b32 v98, 4, v97
    v_lshl_add_u32 v104, v98, 4, v96
    v_xor_b32 v98, 6, v97
    v_lshl_add_u32 v105, v98, 4, v96
    v_bfe_u32 v90, v1, 2, 2
    v_and_b32 v91, 3, v1
    v_bfe_u32 v92, v1, 4, 1
    v_lshl_add_u32 v93, v3, 3, v90
    v_lshlrev_b32 v93, 7, v93
    v_lshrrev_b32 v94, 1, v90
    v_lshl_add_u32 v4, v94, 6, v93
    v_lshl_add_u32 v4, v92, 5, v4
    v_lshl_add_u32 v4, v91, 3, v4
    v_and_b32 v95, 1, v91
    v_lshlrev_b32 v89, 6, v94
    v_lshl_add_u32 v89, v95, 5, v89
    v_lshl_add_u32 v89, v92, 4, v89
    v_lshrrev_b32 v98, 1, v91
    v_lshl_add_u32 v89, v98, 3, v89
    v_add_u32 v14, v89, v93
    v_mul_u32_u24 v15, 72, v3
    v_add_u32 v15, v15, v90
    v_lshl_add_u32 v15, v15, 7, v89
    v_lshrrev_b32 v90, 3, v1
    v_and_b32 v91, 7, v1
    v_bfe_u32 v92, v90, 1, 1
    v_lshlrev_b32 v93, 2, v92
    v_xor_b32 v91, v91, v93
    v_lshlrev_b32 v93, 4, v91
    s_mul_i32 s54, s20, 48
    v_add_u32 v94, s54, v90
    v_mov_b32 v9, 0
    v_mov_b32 v70, 0
    v_mov_b32 v71, 0
    v_mov_b32 v72, 0
    v_mov_b32 v73, 0
    v_mov_b32 v74, 0
    v_mov_b32 v75, 0
    s_cmp_eq_u32 s23, 1
    s_cbranch_scc1 Lsetup_att
    v_mul_u32_u24 v94, 9216, v94
    v_add_u32 v64, v94, v93
    v_add_u32 v65, 72704, v64
    v_add_u32 v66, 145408, v64
    v_add_u32 v67, 218112, v64
    v_add_u32 v68, 294912, v64
    v_add_u32 v69, 367616, v64
    v_lshrrev_b32 v94, 2, v90
    v_and_b32 v95, 3, v90
    v_lshl_add_u32 v94, v94, 3, v95
    v_add_u32 v94, s54, v94
    v_mul_u32_u24 v94, 1152, v94
    v_add_u32 v70, v94, v93
    v_add_u32 v71, 3584, v70
    v_add_u32 v72, 16384, v70
    v_add_u32 v73, 19968, v70
    v_add_u32 v74, 36864, v70
    v_add_u32 v75, 40448, v70
    s_mov_b32 s4, s72
    s_and_b32 s5, s73, 0xffff
    s_mov_b32 s6, 5308416
    s_mul_i32 s24, s22, 768
    s_mov_b32 s25, 4291428480
    s_mov_b32 s26, 1769472
    s_mov_b32 s27, 1769472
    v_mov_b32 v76, 0
    s_branch Lsetup_done
Lsetup_att:
    v_mov_b32 v4, v14
    v_lshrrev_b32 v95, 1, v91
    v_add_u32 v12, 9, v95
    v_lshlrev_b32 v13, 5, v12
    v_add_u32 v13, 864, v13
    v_mul_u32_u24 v94, 3456, v94
    v_add3_u32 v64, v94, v93, 0
    v_add_u32 v64, 1152, v64
    v_add_u32 v65, 26624, v64
    v_add_u32 v66, 53248, v64
    v_add_u32 v67, 79872, v64
    v_add_u32 v68, 110592, v64
    v_add_u32 v69, 137216, v64
    s_mul_i32 s55, s20, 40
    v_add_u32 v94, s55, v90
    v_mul_u32_u24 v94, 1152, v94
    v_add_u32 v9, v94, v93
    s_mov_b32 s4, s66
    s_and_b32 s5, s67, 0xffff
    s_mov_b32 s6, 1990656
    s_sub_u32 s55, s22, 12
    s_mul_i32 s24, s55, 288
    s_mov_b32 s25, 4293640192
    s_mov_b32 s26, 663552
    s_mov_b32 s27, 663552
    v_add_u32 v12, 4, v12
    v_subrev_u32 v76, 27, v12
    v_min_u32 v12, v12, v76
    v_mul_u32_u24 v76, 57, v12
    v_lshrrev_b32 v76, 9, v76
    v_mul_u32_u24 v76, 864, v76
    v_lshl_add_u32 v77, v12, 5, v76
    v_sub_u32 v76, v77, v13
    v_mov_b32 v13, v77
Lsetup_done:
    s_mov_b32 s7, 0x00020000
    s_mov_b32 s28, 0
    s_mov_b32 s29, 73728
    s_mov_b32 s31, 0
    s_mov_b32 s32, 0
    s_mov_b32 s33, 0
    v_xor_b32 v5, 64, v4
    v_add_u32 v6, 49152, v4
    v_add_u32 v7, 49152, v5
    v_mov_b32 v8, 73728
    v_lshlrev_b32 v11, 4, v1
    s_lshl_b32 s54, s21, 4
    s_add_u32 s54, s54, s22
    s_lshl_b32 s54, s54, 2
    s_add_u32 s54, s54, s20
    s_mul_i32 s58, s54, 36864
    v_mov_b32 v16, 0
    v_mov_b32 v17, 0
    v_mov_b32 v18, 0
    v_mov_b32 v19, 0
    v_mov_b32 v20, 0
    v_mov_b32 v21, 0
    v_mov_b32 v22, 0
    v_mov_b32 v23, 0
    s_cmp_eq_u32 s23, 1
    s_waitcnt vmcnt(35)
    ds_read_b128 v[112:115], v102 offset:0
    ds_read_b128 v[116:119], v103 offset:0
    ds_read_b128 v[120:123], v104 offset:0
    ds_read_b128 v[124:127], v105 offset:0
    s_waitcnt vmcnt(31)
    ds_read_b128 v[128:131], v102 offset:1024
    ds_read_b128 v[132:135], v103 offset:1024
    ds_read_b128 v[136:139], v104 offset:1024
    ds_read_b128 v[140:143], v105 offset:1024
    s_waitcnt lgkmcnt(4)
    v_dot2c_f32_bf16 v16, s41, v112
    v_dot2c_f32_bf16 v17, s41, v113
    v_dot2c_f32_bf16 v18, s41, v114
    v_dot2c_f32_bf16 v19, s41, v115
    v_dot2c_f32_bf16 v16, s41, v116
    v_dot2c_f32_bf16 v17, s41, v117
    v_dot2c_f32_bf16 v18, s41, v118
    v_dot2c_f32_bf16 v19, s41, v119
    v_dot2c_f32_bf16 v16, s41, v120
    v_dot2c_f32_bf16 v17, s41, v121
    v_dot2c_f32_bf16 v18, s41, v122
    v_dot2c_f32_bf16 v19, s41, v123
    v_dot2c_f32_bf16 v16, s41, v124
    v_dot2c_f32_bf16 v17, s41, v125
    v_dot2c_f32_bf16 v18, s41, v126
    v_dot2c_f32_bf16 v19, s41, v127
    v_dot2c_f32_bf16 v20, v112, v112
    v_dot2c_f32_bf16 v21, v113, v113
    v_dot2c_f32_bf16 v22, v114, v114
    v_dot2c_f32_bf16 v23, v115, v115
    v_dot2c_f32_bf16 v20, v116, v116
    v_dot2c_f32_bf16 v21, v117, v117
    v_dot2c_f32_bf16 v22, v118, v118
    v_dot2c_f32_bf16 v23, v119, v119
    v_dot2c_f32_bf16 v20, v120, v120
    v_dot2c_f32_bf16 v21, v121, v121
    v_dot2c_f32_bf16 v22, v122, v122
    v_dot2c_f32_bf16 v23, v123, v123
    v_dot2c_f32_bf16 v20, v124, v124
    v_dot2c_f32_bf16 v21, v125, v125
    v_dot2c_f32_bf16 v22, v126, v126
    v_dot2c_f32_bf16 v23, v127, v127
    s_waitcnt vmcnt(27)
    ds_read_b128 v[144:147], v102 offset:2048
    ds_read_b128 v[148:151], v103 offset:2048
    ds_read_b128 v[152:155], v104 offset:2048
    ds_read_b128 v[156:159], v105 offset:2048
    s_waitcnt lgkmcnt(4)
    v_dot2c_f32_bf16 v16, s41, v128
    v_dot2c_f32_bf16 v17, s41, v129
    v_dot2c_f32_bf16 v18, s41, v130
    v_dot2c_f32_bf16 v19, s41, v131
    v_dot2c_f32_bf16 v16, s41, v132
    v_dot2c_f32_bf16 v17, s41, v133
    v_dot2c_f32_bf16 v18, s41, v134
    v_dot2c_f32_bf16 v19, s41, v135
    v_dot2c_f32_bf16 v16, s41, v136
    v_dot2c_f32_bf16 v17, s41, v137
    v_dot2c_f32_bf16 v18, s41, v138
    v_dot2c_f32_bf16 v19, s41, v139
    v_dot2c_f32_bf16 v16, s41, v140
    v_dot2c_f32_bf16 v17, s41, v141
    v_dot2c_f32_bf16 v18, s41, v142
    v_dot2c_f32_bf16 v19, s41, v143
    v_dot2c_f32_bf16 v20, v128, v128
    v_dot2c_f32_bf16 v21, v129, v129
    v_dot2c_f32_bf16 v22, v130, v130
    v_dot2c_f32_bf16 v23, v131, v131
    v_dot2c_f32_bf16 v20, v132, v132
    v_dot2c_f32_bf16 v21, v133, v133
    v_dot2c_f32_bf16 v22, v134, v134
    v_dot2c_f32_bf16 v23, v135, v135
    v_dot2c_f32_bf16 v20, v136, v136
    v_dot2c_f32_bf16 v21, v137, v137
    v_dot2c_f32_bf16 v22, v138, v138
    v_dot2c_f32_bf16 v23, v139, v139
    v_dot2c_f32_bf16 v20, v140, v140
    v_dot2c_f32_bf16 v21, v141, v141
    v_dot2c_f32_bf16 v22, v142, v142
    v_dot2c_f32_bf16 v23, v143, v143
    s_waitcnt vmcnt(23)
    ds_read_b128 v[160:163], v102 offset:3072
    ds_read_b128 v[164:167], v103 offset:3072
    ds_read_b128 v[168:171], v104 offset:3072
    ds_read_b128 v[172:175], v105 offset:3072
    s_waitcnt lgkmcnt(4)
    v_dot2c_f32_bf16 v16, s41, v144
    v_dot2c_f32_bf16 v17, s41, v145
    v_dot2c_f32_bf16 v18, s41, v146
    v_dot2c_f32_bf16 v19, s41, v147
    v_dot2c_f32_bf16 v16, s41, v148
    v_dot2c_f32_bf16 v17, s41, v149
    v_dot2c_f32_bf16 v18, s41, v150
    v_dot2c_f32_bf16 v19, s41, v151
    v_dot2c_f32_bf16 v16, s41, v152
    v_dot2c_f32_bf16 v17, s41, v153
    v_dot2c_f32_bf16 v18, s41, v154
    v_dot2c_f32_bf16 v19, s41, v155
    v_dot2c_f32_bf16 v16, s41, v156
    v_dot2c_f32_bf16 v17, s41, v157
    v_dot2c_f32_bf16 v18, s41, v158
    v_dot2c_f32_bf16 v19, s41, v159
    v_dot2c_f32_bf16 v20, v144, v144
    v_dot2c_f32_bf16 v21, v145, v145
    v_dot2c_f32_bf16 v22, v146, v146
    v_dot2c_f32_bf16 v23, v147, v147
    v_dot2c_f32_bf16 v20, v148, v148
    v_dot2c_f32_bf16 v21, v149, v149
    v_dot2c_f32_bf16 v22, v150, v150
    v_dot2c_f32_bf16 v23, v151, v151
    v_dot2c_f32_bf16 v20, v152, v152
    v_dot2c_f32_bf16 v21, v153, v153
    v_dot2c_f32_bf16 v22, v154, v154
    v_dot2c_f32_bf16 v23, v155, v155
    v_dot2c_f32_bf16 v20, v156, v156
    v_dot2c_f32_bf16 v21, v157, v157
    v_dot2c_f32_bf16 v22, v158, v158
    v_dot2c_f32_bf16 v23, v159, v159
    s_waitcnt vmcnt(19)
    ds_read_b128 v[176:179], v102 offset:4096
    ds_read_b128 v[180:183], v103 offset:4096
    ds_read_b128 v[184:187], v104 offset:4096
    ds_read_b128 v[188:191], v105 offset:4096
    s_waitcnt lgkmcnt(4)
    v_dot2c_f32_bf16 v16, s41, v160
    v_dot2c_f32_bf16 v17, s41, v161
    v_dot2c_f32_bf16 v18, s41, v162
    v_dot2c_f32_bf16 v19, s41, v163
    v_dot2c_f32_bf16 v16, s41, v164
    v_dot2c_f32_bf16 v17, s41, v165
    v_dot2c_f32_bf16 v18, s41, v166
    v_dot2c_f32_bf16 v19, s41, v167
    v_dot2c_f32_bf16 v16, s41, v168
    v_dot2c_f32_bf16 v17, s41, v169
    v_dot2c_f32_bf16 v18, s41, v170
    v_dot2c_f32_bf16 v19, s41, v171
    v_dot2c_f32_bf16 v16, s41, v172
    v_dot2c_f32_bf16 v17, s41, v173
    v_dot2c_f32_bf16 v18, s41, v174
    v_dot2c_f32_bf16 v19, s41, v175
    v_dot2c_f32_bf16 v20, v160, v160
    v_dot2c_f32_bf16 v21, v161, v161
    v_dot2c_f32_bf16 v22, v162, v162
    v_dot2c_f32_bf16 v23, v163, v163
    v_dot2c_f32_bf16 v20, v164, v164
    v_dot2c_f32_bf16 v21, v165, v165
    v_dot2c_f32_bf16 v22, v166, v166
    v_dot2c_f32_bf16 v23, v167, v167
    v_dot2c_f32_bf16 v20, v168, v168
    v_dot2c_f32_bf16 v21, v169, v169
    v_dot2c_f32_bf16 v22, v170, v170
    v_dot2c_f32_bf16 v23, v171, v171
    v_dot2c_f32_bf16 v20, v172, v172
    v_dot2c_f32_bf16 v21, v173, v173
    v_dot2c_f32_bf16 v22, v174, v174
    v_dot2c_f32_bf16 v23, v175, v175
    s_waitcnt vmcnt(15)
    ds_read_b128 v[192:195], v102 offset:5120
    ds_read_b128 v[196:199], v103 offset:5120
    ds_read_b128 v[200:203], v104 offset:5120
    ds_read_b128 v[204:207], v105 offset:5120
    s_waitcnt lgkmcnt(4)
    v_dot2c_f32_bf16 v16, s41, v176
    v_dot2c_f32_bf16 v17, s41, v177
    v_dot2c_f32_bf16 v18, s41, v178
    v_dot2c_f32_bf16 v19, s41, v179
    v_dot2c_f32_bf16 v16, s41, v180
    v_dot2c_f32_bf16 v17, s41, v181
    v_dot2c_f32_bf16 v18, s41, v182
    v_dot2c_f32_bf16 v19, s41, v183
    v_dot2c_f32_bf16 v16, s41, v184
    v_dot2c_f32_bf16 v17, s41, v185
    v_dot2c_f32_bf16 v18, s41, v186
    v_dot2c_f32_bf16 v19, s41, v187
    v_dot2c_f32_bf16 v16, s41, v188
    v_dot2c_f32_bf16 v17, s41, v189
    v_dot2c_f32_bf16 v18, s41, v190
    v_dot2c_f32_bf16 v19, s41, v191
    v_dot2c_f32_bf16 v20, v176, v176
    v_dot2c_f32_bf16 v21, v177, v177
    v_dot2c_f32_bf16 v22, v178, v178
    v_dot2c_f32_bf16 v23, v179, v179
    v_dot2c_f32_bf16 v20, v180, v180
    v_dot2c_f32_bf16 v21, v181, v181
    v_dot2c_f32_bf16 v22, v182, v182
    v_dot2c_f32_bf16 v23, v183, v183
    v_dot2c_f32_bf16 v20, v184, v184
    v_dot2c_f32_bf16 v21, v185, v185
    v_dot2c_f32_bf16 v22, v186, v186
    v_dot2c_f32_bf16 v23, v187, v187
    v_dot2c_f32_bf16 v20, v188, v188
    v_dot2c_f32_bf16 v21, v189, v189
    v_dot2c_f32_bf16 v22, v190, v190
    v_dot2c_f32_bf16 v23, v191, v191
    s_waitcnt vmcnt(11)
    ds_read_b128 v[208:211], v102 offset:6144
    ds_read_b128 v[212:215], v103 offset:6144
    ds_read_b128 v[216:219], v104 offset:6144
    ds_read_b128 v[220:223], v105 offset:6144
    s_waitcnt lgkmcnt(4)
    v_dot2c_f32_bf16 v16, s41, v192
    v_dot2c_f32_bf16 v17, s41, v193
    v_dot2c_f32_bf16 v18, s41, v194
    v_dot2c_f32_bf16 v19, s41, v195
    v_dot2c_f32_bf16 v16, s41, v196
    v_dot2c_f32_bf16 v17, s41, v197
    v_dot2c_f32_bf16 v18, s41, v198
    v_dot2c_f32_bf16 v19, s41, v199
    v_dot2c_f32_bf16 v16, s41, v200
    v_dot2c_f32_bf16 v17, s41, v201
    v_dot2c_f32_bf16 v18, s41, v202
    v_dot2c_f32_bf16 v19, s41, v203
    v_dot2c_f32_bf16 v16, s41, v204
    v_dot2c_f32_bf16 v17, s41, v205
    v_dot2c_f32_bf16 v18, s41, v206
    v_dot2c_f32_bf16 v19, s41, v207
    v_dot2c_f32_bf16 v20, v192, v192
    v_dot2c_f32_bf16 v21, v193, v193
    v_dot2c_f32_bf16 v22, v194, v194
    v_dot2c_f32_bf16 v23, v195, v195
    v_dot2c_f32_bf16 v20, v196, v196
    v_dot2c_f32_bf16 v21, v197, v197
    v_dot2c_f32_bf16 v22, v198, v198
    v_dot2c_f32_bf16 v23, v199, v199
    v_dot2c_f32_bf16 v20, v200, v200
    v_dot2c_f32_bf16 v21, v201, v201
    v_dot2c_f32_bf16 v22, v202, v202
    v_dot2c_f32_bf16 v23, v203, v203
    v_dot2c_f32_bf16 v20, v204, v204
    v_dot2c_f32_bf16 v21, v205, v205
    v_dot2c_f32_bf16 v22, v206, v206
    v_dot2c_f32_bf16 v23, v207, v207
    s_waitcnt vmcnt(7)
    ds_read_b128 v[224:227], v102 offset:7168
    ds_read_b128 v[228:231], v103 offset:7168
    ds_read_b128 v[232:235], v104 offset:7168
    ds_read_b128 v[236:239], v105 offset:7168
    s_waitcnt lgkmcnt(4)
    v_dot2c_f32_bf16 v16, s41, v208
    v_dot2c_f32_bf16 v17, s41, v209
    v_dot2c_f32_bf16 v18, s41, v210
    v_dot2c_f32_bf16 v19, s41, v211
    v_dot2c_f32_bf16 v16, s41, v212
    v_dot2c_f32_bf16 v17, s41, v213
    v_dot2c_f32_bf16 v18, s41, v214
    v_dot2c_f32_bf16 v19, s41, v215
    v_dot2c_f32_bf16 v16, s41, v216
    v_dot2c_f32_bf16 v17, s41, v217
    v_dot2c_f32_bf16 v18, s41, v218
    v_dot2c_f32_bf16 v19, s41, v219
    v_dot2c_f32_bf16 v16, s41, v220
    v_dot2c_f32_bf16 v17, s41, v221
    v_dot2c_f32_bf16 v18, s41, v222
    v_dot2c_f32_bf16 v19, s41, v223
    v_dot2c_f32_bf16 v20, v208, v208
    v_dot2c_f32_bf16 v21, v209, v209
    v_dot2c_f32_bf16 v22, v210, v210
    v_dot2c_f32_bf16 v23, v211, v211
    v_dot2c_f32_bf16 v20, v212, v212
    v_dot2c_f32_bf16 v21, v213, v213
    v_dot2c_f32_bf16 v22, v214, v214
    v_dot2c_f32_bf16 v23, v215, v215
    v_dot2c_f32_bf16 v20, v216, v216
    v_dot2c_f32_bf16 v21, v217, v217
    v_dot2c_f32_bf16 v22, v218, v218
    v_dot2c_f32_bf16 v23, v219, v219
    v_dot2c_f32_bf16 v20, v220, v220
    v_dot2c_f32_bf16 v21, v221, v221
    v_dot2c_f32_bf16 v22, v222, v222
    v_dot2c_f32_bf16 v23, v223, v223
    s_waitcnt vmcnt(3)
    ds_read_b128 v[240:243], v102 offset:8192
    ds_read_b128 v[244:247], v103 offset:8192
    ds_read_b128 v[248:251], v104 offset:8192
    ds_read_b128 v[252:255], v105 offset:8192
    s_waitcnt lgkmcnt(4)
    v_dot2c_f32_bf16 v16, s41, v224
    v_dot2c_f32_bf16 v17, s41, v225
    v_dot2c_f32_bf16 v18, s41, v226
    v_dot2c_f32_bf16 v19, s41, v227
    v_dot2c_f32_bf16 v16, s41, v228
    v_dot2c_f32_bf16 v17, s41, v229
    v_dot2c_f32_bf16 v18, s41, v230
    v_dot2c_f32_bf16 v19, s41, v231
    v_dot2c_f32_bf16 v16, s41, v232
    v_dot2c_f32_bf16 v17, s41, v233
    v_dot2c_f32_bf16 v18, s41, v234
    v_dot2c_f32_bf16 v19, s41, v235
    v_dot2c_f32_bf16 v16, s41, v236
    v_dot2c_f32_bf16 v17, s41, v237
    v_dot2c_f32_bf16 v18, s41, v238
    v_dot2c_f32_bf16 v19, s41, v239
    v_dot2c_f32_bf16 v20, v224, v224
    v_dot2c_f32_bf16 v21, v225, v225
    v_dot2c_f32_bf16 v22, v226, v226
    v_dot2c_f32_bf16 v23, v227, v227
    v_dot2c_f32_bf16 v20, v228, v228
    v_dot2c_f32_bf16 v21, v229, v229
    v_dot2c_f32_bf16 v22, v230, v230
    v_dot2c_f32_bf16 v23, v231, v231
    v_dot2c_f32_bf16 v20, v232, v232
    v_dot2c_f32_bf16 v21, v233, v233
    v_dot2c_f32_bf16 v22, v234, v234
    v_dot2c_f32_bf16 v23, v235, v235
    v_dot2c_f32_bf16 v20, v236, v236
    v_dot2c_f32_bf16 v21, v237, v237
    v_dot2c_f32_bf16 v22, v238, v238
    v_dot2c_f32_bf16 v23, v239, v239
    s_waitcnt lgkmcnt(0)
    s_barrier
    v_dot2c_f32_bf16 v16, s41, v240
    v_dot2c_f32_bf16 v17, s41, v241
    v_dot2c_f32_bf16 v18, s41, v242
    v_dot2c_f32_bf16 v19, s41, v243
    v_dot2c_f32_bf16 v16, s41, v244
    v_dot2c_f32_bf16 v17, s41, v245
    v_dot2c_f32_bf16 v18, s41, v246
    v_dot2c_f32_bf16 v19, s41, v247
    v_dot2c_f32_bf16 v16, s41, v248
    v_dot2c_f32_bf16 v17, s41, v249
    v_dot2c_f32_bf16 v18, s41, v250
    v_dot2c_f32_bf16 v19, s41, v251
    v_dot2c_f32_bf16 v16, s41, v252
    v_dot2c_f32_bf16 v17, s41, v253
    v_dot2c_f32_bf16 v18, s41, v254
    v_dot2c_f32_bf16 v19, s41, v255
    v_dot2c_f32_bf16 v20, v240, v240
    v_dot2c_f32_bf16 v21, v241, v241
    v_dot2c_f32_bf16 v22, v242, v242
    v_dot2c_f32_bf16 v23, v243, v243
    v_dot2c_f32_bf16 v20, v244, v244
    v_dot2c_f32_bf16 v21, v245, v245
    v_dot2c_f32_bf16 v22, v246, v246
    v_dot2c_f32_bf16 v23, v247, v247
    v_dot2c_f32_bf16 v20, v248, v248
    v_dot2c_f32_bf16 v21, v249, v249
    v_dot2c_f32_bf16 v22, v250, v250
    v_dot2c_f32_bf16 v23, v251, v251
    v_dot2c_f32_bf16 v20, v252, v252
    v_dot2c_f32_bf16 v21, v253, v253
    v_dot2c_f32_bf16 v22, v254, v254
    v_dot2c_f32_bf16 v23, v255, v255
    s_add_u32 m0, s59, 0
    s_nop 0
    buffer_load_dwordx4 v64, s[4:7], s24 offen offset:0 lds
    buffer_load_dwordx4 v65, s[4:7], s24 offen offset:1024 lds
    buffer_load_dwordx4 v66, s[4:7], s24 offen offset:2048 lds
    v_add_f32 v16, v16, v17
    v_add_f32 v18, v18, v19
    v_add_f32 v16, v16, v18
    v_mov_b32 v17, v16
    s_nop 1
    v_permlane32_swap_b32 v16, v17
    s_nop 1
    v_add_f32 v16, v16, v17
    v_mul_f32 v16, 1.736111111e-03, v16
    v_add_f32 v20, v20, v21
    v_add_f32 v22, v22, v23
    v_add_f32 v20, v20, v22
    v_mov_b32 v21, v20
    s_nop 1
    v_permlane32_swap_b32 v20, v21
    s_nop 1
    v_add_f32 v20, v20, v21
    v_mul_f32 v20, 1.736111111e-03, v20
    v_fma_f32 v20, -v16, v16, v20
    v_cvt_pk_bf16_f32 v18, v16, v16
    v_lshlrev_b32 v16, 16, v18
    v_sub_f32 v18, 0, v16
    v_max_f32 v20, 0, v20
    v_cvt_pk_bf16_f32 v21, v20, v20
    v_lshlrev_b32 v20, 16, v21
    v_add_f32 v20, 0x3727c5ac, v20
    v_cvt_pk_bf16_f32 v21, v20, v20
    v_lshlrev_b32 v20, 16, v21
    v_sqrt_f32 v20, v20
    s_nop 0
    v_cvt_pk_bf16_f32 v21, v20, v20
    v_lshlrev_b32 v20, 16, v21
    v_rcp_f32 v10, v20
    v_dot2_f32_bf16 v32, v112, s42, v18
    v_dot2_f32_bf16 v33, v112, s43, v18
    v_dot2_f32_bf16 v34, v113, s42, v18
    v_dot2_f32_bf16 v35, v113, s43, v18
    v_dot2_f32_bf16 v36, v114, s42, v18
    v_dot2_f32_bf16 v37, v114, s43, v18
    v_dot2_f32_bf16 v38, v115, s42, v18
    v_dot2_f32_bf16 v39, v115, s43, v18
    buffer_load_dwordx4 v67, s[4:7], s24 offen offset:3072 lds
    v_dot2_f32_bf16 v40, v116, s42, v18
    v_dot2_f32_bf16 v41, v116, s43, v18
    v_dot2_f32_bf16 v42, v117, s42, v18
    v_dot2_f32_bf16 v43, v117, s43, v18
    v_dot2_f32_bf16 v44, v118, s42, v18
    v_dot2_f32_bf16 v45, v118, s43, v18
    v_dot2_f32_bf16 v46, v119, s42, v18
    v_dot2_f32_bf16 v47, v119, s43, v18
    v_cvt_pk_bf16_f32 v112, v32, v33
    v_cvt_pk_bf16_f32 v113, v34, v35
    v_cvt_pk_bf16_f32 v114, v36, v37
    v_cvt_pk_bf16_f32 v115, v38, v39
    s_add_u32 m0, s59, 4096
    s_nop 0
    buffer_load_dwordx4 v68, s[4:7], s24 offen offset:0 lds
    v_dot2_f32_bf16 v32, v120, s42, v18
    v_dot2_f32_bf16 v33, v120, s43, v18
    v_dot2_f32_bf16 v34, v121, s42, v18
    v_dot2_f32_bf16 v35, v121, s43, v18
    v_dot2_f32_bf16 v36, v122, s42, v18
    v_dot2_f32_bf16 v37, v122, s43, v18
    v_dot2_f32_bf16 v38, v123, s42, v18
    v_dot2_f32_bf16 v39, v123, s43, v18
    v_cvt_pk_bf16_f32 v116, v40, v41
    v_cvt_pk_bf16_f32 v117, v42, v43
    v_cvt_pk_bf16_f32 v118, v44, v45
    v_cvt_pk_bf16_f32 v119, v46, v47
    v_accvgpr_write_b32 a64, v112
    v_accvgpr_write_b32 a65, v113
    v_accvgpr_write_b32 a66, v114
    v_accvgpr_write_b32 a67, v115
    v_dot2_f32_bf16 v40, v124, s42, v18
    v_dot2_f32_bf16 v41, v124, s43, v18
    v_dot2_f32_bf16 v42, v125, s42, v18
    v_dot2_f32_bf16 v43, v125, s43, v18
    v_dot2_f32_bf16 v44, v126, s42, v18
    v_dot2_f32_bf16 v45, v126, s43, v18
    v_dot2_f32_bf16 v46, v127, s42, v18
    v_dot2_f32_bf16 v47, v127, s43, v18
    v_cvt_pk_bf16_f32 v120, v32, v33
    v_cvt_pk_bf16_f32 v121, v34, v35
    v_cvt_pk_bf16_f32 v122, v36, v37
    v_cvt_pk_bf16_f32 v123, v38, v39
    v_accvgpr_write_b32 a68, v116
    v_accvgpr_write_b32 a69, v117
    v_accvgpr_write_b32 a70, v118
    v_accvgpr_write_b32 a71, v119
    buffer_load_dwordx4 v69, s[4:7], s24 offen offset:1024 lds
    s_add_u32 s24, s24, s26
    v_dot2_f32_bf16 v32, v128, s42, v18
    v_dot2_f32_bf16 v33, v128, s43, v18
    v_dot2_f32_bf16 v34, v129, s42, v18
    v_dot2_f32_bf16 v35, v129, s43, v18
    v_dot2_f32_bf16 v36, v130, s42, v18
    v_dot2_f32_bf16 v37, v130, s43, v18
    v_dot2_f32_bf16 v38, v131, s42, v18
    v_dot2_f32_bf16 v39, v131, s43, v18
    v_cvt_pk_bf16_f32 v124, v40, v41
    v_cvt_pk_bf16_f32 v125, v42, v43
    v_cvt_pk_bf16_f32 v126, v44, v45
    v_cvt_pk_bf16_f32 v127, v46, v47
    v_accvgpr_write_b32 a72, v120
    v_accvgpr_write_b32 a73, v121
    v_accvgpr_write_b32 a74, v122
    v_accvgpr_write_b32 a75, v123
    s_add_u32 m0, s59, 24576
    s_nop 0
    buffer_load_dwordx4 v64, s[4:7], s24 offen offset:0 lds
    v_dot2_f32_bf16 v40, v132, s42, v18
    v_dot2_f32_bf16 v41, v132, s43, v18
    v_dot2_f32_bf16 v42, v133, s42, v18
    v_dot2_f32_bf16 v43, v133, s43, v18
    v_dot2_f32_bf16 v44, v134, s42, v18
    v_dot2_f32_bf16 v45, v134, s43, v18
    v_dot2_f32_bf16 v46, v135, s42, v18
    v_dot2_f32_bf16 v47, v135, s43, v18
    v_cvt_pk_bf16_f32 v128, v32, v33
    v_cvt_pk_bf16_f32 v129, v34, v35
    v_cvt_pk_bf16_f32 v130, v36, v37
    v_cvt_pk_bf16_f32 v131, v38, v39
    v_accvgpr_write_b32 a76, v124
    v_accvgpr_write_b32 a77, v125
    v_accvgpr_write_b32 a78, v126
    v_accvgpr_write_b32 a79, v127
    v_dot2_f32_bf16 v32, v136, s42, v18
    v_dot2_f32_bf16 v33, v136, s43, v18
    v_dot2_f32_bf16 v34, v137, s42, v18
    v_dot2_f32_bf16 v35, v137, s43, v18
    v_dot2_f32_bf16 v36, v138, s42, v18
    v_dot2_f32_bf16 v37, v138, s43, v18
    v_dot2_f32_bf16 v38, v139, s42, v18
    v_dot2_f32_bf16 v39, v139, s43, v18
    v_cvt_pk_bf16_f32 v132, v40, v41
    v_cvt_pk_bf16_f32 v133, v42, v43
    v_cvt_pk_bf16_f32 v134, v44, v45
    v_cvt_pk_bf16_f32 v135, v46, v47
    v_accvgpr_write_b32 a80, v128
    v_accvgpr_write_b32 a81, v129
    v_accvgpr_write_b32 a82, v130
    v_accvgpr_write_b32 a83, v131
    buffer_load_dwordx4 v65, s[4:7], s24 offen offset:1024 lds
    v_dot2_f32_bf16 v40, v140, s42, v18
    v_dot2_f32_bf16 v41, v140, s43, v18
    v_dot2_f32_bf16 v42, v141, s42, v18
    v_dot2_f32_bf16 v43, v141, s43, v18
    v_dot2_f32_bf16 v44, v142, s42, v18
    v_dot2_f32_bf16 v45, v142, s43, v18
    v_dot2_f32_bf16 v46, v143, s42, v18
    v_dot2_f32_bf16 v47, v143, s43, v18
    v_cvt_pk_bf16_f32 v136, v32, v33
    v_cvt_pk_bf16_f32 v137, v34, v35
    v_cvt_pk_bf16_f32 v138, v36, v37
    v_cvt_pk_bf16_f32 v139, v38, v39
    v_accvgpr_write_b32 a84, v132
    v_accvgpr_write_b32 a85, v133
    v_accvgpr_write_b32 a86, v134
    v_accvgpr_write_b32 a87, v135
    buffer_load_dwordx4 v66, s[4:7], s24 offen offset:2048 lds
    v_dot2_f32_bf16 v32, v144, s42, v18
    v_dot2_f32_bf16 v33, v144, s43, v18
    v_dot2_f32_bf16 v34, v145, s42, v18
    v_dot2_f32_bf16 v35, v145, s43, v18
    v_dot2_f32_bf16 v36, v146, s42, v18
    v_dot2_f32_bf16 v37, v146, s43, v18
    v_dot2_f32_bf16 v38, v147, s42, v18
    v_dot2_f32_bf16 v39, v147, s43, v18
    v_cvt_pk_bf16_f32 v140, v40, v41
    v_cvt_pk_bf16_f32 v141, v42, v43
    v_cvt_pk_bf16_f32 v142, v44, v45
    v_cvt_pk_bf16_f32 v143, v46, v47
    v_accvgpr_write_b32 a88, v136
    v_accvgpr_write_b32 a89, v137
    v_accvgpr_write_b32 a90, v138
    v_accvgpr_write_b32 a91, v139
    v_dot2_f32_bf16 v40, v148, s42, v18
    v_dot2_f32_bf16 v41, v148, s43, v18
    v_dot2_f32_bf16 v42, v149, s42, v18
    v_dot2_f32_bf16 v43, v149, s43, v18
    v_dot2_f32_bf16 v44, v150, s42, v18
    v_dot2_f32_bf16 v45, v150, s43, v18
    v_dot2_f32_bf16 v46, v151, s42, v18
    v_dot2_f32_bf16 v47, v151, s43, v18
    v_cvt_pk_bf16_f32 v144, v32, v33
    v_cvt_pk_bf16_f32 v145, v34, v35
    v_cvt_pk_bf16_f32 v146, v36, v37
    v_cvt_pk_bf16_f32 v147, v38, v39
    v_accvgpr_write_b32 a92, v140
    v_accvgpr_write_b32 a93, v141
    v_accvgpr_write_b32 a94, v142
    v_accvgpr_write_b32 a95, v143
    buffer_load_dwordx4 v67, s[4:7], s24 offen offset:3072 lds
    v_dot2_f32_bf16 v32, v152, s42, v18
    v_dot2_f32_bf16 v33, v152, s43, v18
    v_dot2_f32_bf16 v34, v153, s42, v18
    v_dot2_f32_bf16 v35, v153, s43, v18
    v_dot2_f32_bf16 v36, v154, s42, v18
    v_dot2_f32_bf16 v37, v154, s43, v18
    v_dot2_f32_bf16 v38, v155, s42, v18
    v_dot2_f32_bf16 v39, v155, s43, v18
    v_cvt_pk_bf16_f32 v148, v40, v41
    v_cvt_pk_bf16_f32 v149, v42, v43
    v_cvt_pk_bf16_f32 v150, v44, v45
    v_cvt_pk_bf16_f32 v151, v46, v47
    v_accvgpr_write_b32 a96, v144
    v_accvgpr_write_b32 a97, v145
    v_accvgpr_write_b32 a98, v146
    v_accvgpr_write_b32 a99, v147
    s_add_u32 m0, s59, 28672
    s_nop 0
    buffer_load_dwordx4 v68, s[4:7], s24 offen offset:0 lds
    v_dot2_f32_bf16 v40, v156, s42, v18
    v_dot2_f32_bf16 v41, v156, s43, v18
    v_dot2_f32_bf16 v42, v157, s42, v18
    v_dot2_f32_bf16 v43, v157, s43, v18
    v_dot2_f32_bf16 v44, v158, s42, v18
    v_dot2_f32_bf16 v45, v158, s43, v18
    v_dot2_f32_bf16 v46, v159, s42, v18
    v_dot2_f32_bf16 v47, v159, s43, v18
    v_cvt_pk_bf16_f32 v152, v32, v33
    v_cvt_pk_bf16_f32 v153, v34, v35
    v_cvt_pk_bf16_f32 v154, v36, v37
    v_cvt_pk_bf16_f32 v155, v38, v39
    v_accvgpr_write_b32 a100, v148
    v_accvgpr_write_b32 a101, v149
    v_accvgpr_write_b32 a102, v150
    v_accvgpr_write_b32 a103, v151
    v_dot2_f32_bf16 v32, v160, s42, v18
    v_dot2_f32_bf16 v33, v160, s43, v18
    v_dot2_f32_bf16 v34, v161, s42, v18
    v_dot2_f32_bf16 v35, v161, s43, v18
    v_dot2_f32_bf16 v36, v162, s42, v18
    v_dot2_f32_bf16 v37, v162, s43, v18
    v_dot2_f32_bf16 v38, v163, s42, v18
    v_dot2_f32_bf16 v39, v163, s43, v18
    v_cvt_pk_bf16_f32 v156, v40, v41
    v_cvt_pk_bf16_f32 v157, v42, v43
    v_cvt_pk_bf16_f32 v158, v44, v45
    v_cvt_pk_bf16_f32 v159, v46, v47
    v_accvgpr_write_b32 a104, v152
    v_accvgpr_write_b32 a105, v153
    v_accvgpr_write_b32 a106, v154
    v_accvgpr_write_b32 a107, v155
    buffer_load_dwordx4 v69, s[4:7], s24 offen offset:1024 lds
    s_add_u32 s24, s24, s26
    v_dot2_f32_bf16 v40, v164, s42, v18
    v_dot2_f32_bf16 v41, v164, s43, v18
    v_dot2_f32_bf16 v42, v165, s42, v18
    v_dot2_f32_bf16 v43, v165, s43, v18
    v_dot2_f32_bf16 v44, v166, s42, v18
    v_dot2_f32_bf16 v45, v166, s43, v18
    v_dot2_f32_bf16 v46, v167, s42, v18
    v_dot2_f32_bf16 v47, v167, s43, v18
    v_cvt_pk_bf16_f32 v160, v32, v33
    v_cvt_pk_bf16_f32 v161, v34, v35
    v_cvt_pk_bf16_f32 v162, v36, v37
    v_cvt_pk_bf16_f32 v163, v38, v39
    v_accvgpr_write_b32 a108, v156
    v_accvgpr_write_b32 a109, v157
    v_accvgpr_write_b32 a110, v158
    v_accvgpr_write_b32 a111, v159
    s_add_u32 m0, s59, 49152
    s_nop 0
    buffer_load_dwordx4 v64, s[4:7], s24 offen offset:0 lds
    v_add_u32 v64, v64, v76
    v_dot2_f32_bf16 v32, v168, s42, v18
    v_dot2_f32_bf16 v33, v168, s43, v18
    v_dot2_f32_bf16 v34, v169, s42, v18
    v_dot2_f32_bf16 v35, v169, s43, v18
    v_dot2_f32_bf16 v36, v170, s42, v18
    v_dot2_f32_bf16 v37, v170, s43, v18
    v_dot2_f32_bf16 v38, v171, s42, v18
    v_dot2_f32_bf16 v39, v171, s43, v18
    v_cvt_pk_bf16_f32 v164, v40, v41
    v_cvt_pk_bf16_f32 v165, v42, v43
    v_cvt_pk_bf16_f32 v166, v44, v45
    v_cvt_pk_bf16_f32 v167, v46, v47
    v_accvgpr_write_b32 a112, v160
    v_accvgpr_write_b32 a113, v161
    v_accvgpr_write_b32 a114, v162
    v_accvgpr_write_b32 a115, v163
    v_dot2_f32_bf16 v40, v172, s42, v18
    v_dot2_f32_bf16 v41, v172, s43, v18
    v_dot2_f32_bf16 v42, v173, s42, v18
    v_dot2_f32_bf16 v43, v173, s43, v18
    v_dot2_f32_bf16 v44, v174, s42, v18
    v_dot2_f32_bf16 v45, v174, s43, v18
    v_dot2_f32_bf16 v46, v175, s42, v18
    v_dot2_f32_bf16 v47, v175, s43, v18
    v_cvt_pk_bf16_f32 v168, v32, v33
    v_cvt_pk_bf16_f32 v169, v34, v35
    v_cvt_pk_bf16_f32 v170, v36, v37
    v_cvt_pk_bf16_f32 v171, v38, v39
    v_accvgpr_write_b32 a116, v164
    v_accvgpr_write_b32 a117, v165
    v_accvgpr_write_b32 a118, v166
    v_accvgpr_write_b32 a119, v167
    buffer_load_dwordx4 v65, s[4:7], s24 offen offset:1024 lds
    v_add_u32 v65, v65, v76
    v_dot2_f32_bf16 v32, v176, s42, v18
    v_dot2_f32_bf16 v33, v176, s43, v18
    v_dot2_f32_bf16 v34, v177, s42, v18
    v_dot2_f32_bf16 v35, v177, s43, v18
    v_dot2_f32_bf16 v36, v178, s42, v18
    v_dot2_f32_bf16 v37, v178, s43, v18
    v_dot2_f32_bf16 v38, v179, s42, v18
    v_dot2_f32_bf16 v39, v179, s43, v18
    v_cvt_pk_bf16_f32 v172, v40, v41
    v_cvt_pk_bf16_f32 v173, v42, v43
    v_cvt_pk_bf16_f32 v174, v44, v45
    v_cvt_pk_bf16_f32 v175, v46, v47
    v_accvgpr_write_b32 a120, v168
    v_accvgpr_write_b32 a121, v169
    v_accvgpr_write_b32 a122, v170
    v_accvgpr_write_b32 a123, v171
    buffer_load_dwordx4 v66, s[4:7], s24 offen offset:2048 lds
    v_add_u32 v66, v66, v76
    v_dot2_f32_bf16 v40, v180, s42, v18
    v_dot2_f32_bf16 v41, v180, s43, v18
    v_dot2_f32_bf16 v42, v181, s42, v18
    v_dot2_f32_bf16 v43, v181, s43, v18
    v_dot2_f32_bf16 v44, v182, s42, v18
    v_dot2_f32_bf16 v45, v182, s43, v18
    v_dot2_f32_bf16 v46, v183, s42, v18
    v_dot2_f32_bf16 v47, v183, s43, v18
    v_cvt_pk_bf16_f32 v176, v32, v33
    v_cvt_pk_bf16_f32 v177, v34, v35
    v_cvt_pk_bf16_f32 v178, v36, v37
    v_cvt_pk_bf16_f32 v179, v38, v39
    v_accvgpr_write_b32 a124, v172
    v_accvgpr_write_b32 a125, v173
    v_accvgpr_write_b32 a126, v174
    v_accvgpr_write_b32 a127, v175
    v_dot2_f32_bf16 v32, v184, s42, v18
    v_dot2_f32_bf16 v33, v184, s43, v18
    v_dot2_f32_bf16 v34, v185, s42, v18
    v_dot2_f32_bf16 v35, v185, s43, v18
    v_dot2_f32_bf16 v36, v186, s42, v18
    v_dot2_f32_bf16 v37, v186, s43, v18
    v_dot2_f32_bf16 v38, v187, s42, v18
    v_dot2_f32_bf16 v39, v187, s43, v18
    v_cvt_pk_bf16_f32 v180, v40, v41
    v_cvt_pk_bf16_f32 v181, v42, v43
    v_cvt_pk_bf16_f32 v182, v44, v45
    v_cvt_pk_bf16_f32 v183, v46, v47
    v_accvgpr_write_b32 a128, v176
    v_accvgpr_write_b32 a129, v177
    v_accvgpr_write_b32 a130, v178
    v_accvgpr_write_b32 a131, v179
    buffer_load_dwordx4 v67, s[4:7], s24 offen offset:3072 lds
    v_add_u32 v67, v67, v76
    v_dot2_f32_bf16 v40, v188, s42, v18
    v_dot2_f32_bf16 v41, v188, s43, v18
    v_dot2_f32_bf16 v42, v189, s42, v18
    v_dot2_f32_bf16 v43, v189, s43, v18
    v_dot2_f32_bf16 v44, v190, s42, v18
    v_dot2_f32_bf16 v45, v190, s43, v18
    v_dot2_f32_bf16 v46, v191, s42, v18
    v_dot2_f32_bf16 v47, v191, s43, v18
    v_cvt_pk_bf16_f32 v184, v32, v33
    v_cvt_pk_bf16_f32 v185, v34, v35
    v_cvt_pk_bf16_f32 v186, v36, v37
    v_cvt_pk_bf16_f32 v187, v38, v39
    v_accvgpr_write_b32 a132, v180
    v_accvgpr_write_b32 a133, v181
    v_accvgpr_write_b32 a134, v182
    v_accvgpr_write_b32 a135, v183
    s_add_u32 m0, s59, 53248
    s_nop 0
    buffer_load_dwordx4 v68, s[4:7], s24 offen offset:0 lds
    v_add_u32 v68, v68, v76
    v_dot2_f32_bf16 v32, v192, s42, v18
    v_dot2_f32_bf16 v33, v192, s43, v18
    v_dot2_f32_bf16 v34, v193, s42, v18
    v_dot2_f32_bf16 v35, v193, s43, v18
    v_dot2_f32_bf16 v36, v194, s42, v18
    v_dot2_f32_bf16 v37, v194, s43, v18
    v_dot2_f32_bf16 v38, v195, s42, v18
    v_dot2_f32_bf16 v39, v195, s43, v18
    v_cvt_pk_bf16_f32 v188, v40, v41
    v_cvt_pk_bf16_f32 v189, v42, v43
    v_cvt_pk_bf16_f32 v190, v44, v45
    v_cvt_pk_bf16_f32 v191, v46, v47
    v_accvgpr_write_b32 a136, v184
    v_accvgpr_write_b32 a137, v185
    v_accvgpr_write_b32 a138, v186
    v_accvgpr_write_b32 a139, v187
    v_dot2_f32_bf16 v40, v196, s42, v18
    v_dot2_f32_bf16 v41, v196, s43, v18
    v_dot2_f32_bf16 v42, v197, s42, v18
    v_dot2_f32_bf16 v43, v197, s43, v18
    v_dot2_f32_bf16 v44, v198, s42, v18
    v_dot2_f32_bf16 v45, v198, s43, v18
    v_dot2_f32_bf16 v46, v199, s42, v18
    v_dot2_f32_bf16 v47, v199, s43, v18
    v_cvt_pk_bf16_f32 v192, v32, v33
    v_cvt_pk_bf16_f32 v193, v34, v35
    v_cvt_pk_bf16_f32 v194, v36, v37
    v_cvt_pk_bf16_f32 v195, v38, v39
    v_accvgpr_write_b32 a140, v188
    v_accvgpr_write_b32 a141, v189
    v_accvgpr_write_b32 a142, v190
    v_accvgpr_write_b32 a143, v191
    buffer_load_dwordx4 v69, s[4:7], s24 offen offset:1024 lds
    v_add_u32 v69, v69, v76
    s_add_u32 s24, s24, s25
    v_dot2_f32_bf16 v32, v200, s42, v18
    v_dot2_f32_bf16 v33, v200, s43, v18
    v_dot2_f32_bf16 v34, v201, s42, v18
    v_dot2_f32_bf16 v35, v201, s43, v18
    v_dot2_f32_bf16 v36, v202, s42, v18
    v_dot2_f32_bf16 v37, v202, s43, v18
    v_dot2_f32_bf16 v38, v203, s42, v18
    v_dot2_f32_bf16 v39, v203, s43, v18
    v_cvt_pk_bf16_f32 v196, v40, v41
    v_cvt_pk_bf16_f32 v197, v42, v43
    v_cvt_pk_bf16_f32 v198, v44, v45
    v_cvt_pk_bf16_f32 v199, v46, v47
    s_add_u32 m0, s59, 73728
    s_nop 0
    buffer_load_dwordx4 v64, s[4:7], s24 offen offset:0 lds
    v_dot2_f32_bf16 v40, v204, s42, v18
    v_dot2_f32_bf16 v41, v204, s43, v18
    v_dot2_f32_bf16 v42, v205, s42, v18
    v_dot2_f32_bf16 v43, v205, s43, v18
    v_dot2_f32_bf16 v44, v206, s42, v18
    v_dot2_f32_bf16 v45, v206, s43, v18
    v_dot2_f32_bf16 v46, v207, s42, v18
    v_dot2_f32_bf16 v47, v207, s43, v18
    v_cvt_pk_bf16_f32 v200, v32, v33
    v_cvt_pk_bf16_f32 v201, v34, v35
    v_cvt_pk_bf16_f32 v202, v36, v37
    v_cvt_pk_bf16_f32 v203, v38, v39
    v_dot2_f32_bf16 v32, v208, s42, v18
    v_dot2_f32_bf16 v33, v208, s43, v18
    v_dot2_f32_bf16 v34, v209, s42, v18
    v_dot2_f32_bf16 v35, v209, s43, v18
    v_dot2_f32_bf16 v36, v210, s42, v18
    v_dot2_f32_bf16 v37, v210, s43, v18
    v_dot2_f32_bf16 v38, v211, s42, v18
    v_dot2_f32_bf16 v39, v211, s43, v18
    v_cvt_pk_bf16_f32 v204, v40, v41
    v_cvt_pk_bf16_f32 v205, v42, v43
    v_cvt_pk_bf16_f32 v206, v44, v45
    v_cvt_pk_bf16_f32 v207, v46, v47
    buffer_load_dwordx4 v65, s[4:7], s24 offen offset:1024 lds
    v_dot2_f32_bf16 v40, v212, s42, v18
    v_dot2_f32_bf16 v41, v212, s43, v18
    v_dot2_f32_bf16 v42, v213, s42, v18
    v_dot2_f32_bf16 v43, v213, s43, v18
    v_dot2_f32_bf16 v44, v214, s42, v18
    v_dot2_f32_bf16 v45, v214, s43, v18
    v_dot2_f32_bf16 v46, v215, s42, v18
    v_dot2_f32_bf16 v47, v215, s43, v18
    v_cvt_pk_bf16_f32 v208, v32, v33
    v_cvt_pk_bf16_f32 v209, v34, v35
    v_cvt_pk_bf16_f32 v210, v36, v37
    v_cvt_pk_bf16_f32 v211, v38, v39
    buffer_load_dwordx4 v66, s[4:7], s24 offen offset:2048 lds
    v_dot2_f32_bf16 v32, v216, s42, v18
    v_dot2_f32_bf16 v33, v216, s43, v18
    v_dot2_f32_bf16 v34, v217, s42, v18
    v_dot2_f32_bf16 v35, v217, s43, v18
    v_dot2_f32_bf16 v36, v218, s42, v18
    v_dot2_f32_bf16 v37, v218, s43, v18
    v_dot2_f32_bf16 v38, v219, s42, v18
    v_dot2_f32_bf16 v39, v219, s43, v18
    v_cvt_pk_bf16_f32 v212, v40, v41
    v_cvt_pk_bf16_f32 v213, v42, v43
    v_cvt_pk_bf16_f32 v214, v44, v45
    v_cvt_pk_bf16_f32 v215, v46, v47
    v_dot2_f32_bf16 v40, v220, s42, v18
    v_dot2_f32_bf16 v41, v220, s43, v18
    v_dot2_f32_bf16 v42, v221, s42, v18
    v_dot2_f32_bf16 v43, v221, s43, v18
    v_dot2_f32_bf16 v44, v222, s42, v18
    v_dot2_f32_bf16 v45, v222, s43, v18
    v_dot2_f32_bf16 v46, v223, s42, v18
    v_dot2_f32_bf16 v47, v223, s43, v18
    v_cvt_pk_bf16_f32 v216, v32, v33
    v_cvt_pk_bf16_f32 v217, v34, v35
    v_cvt_pk_bf16_f32 v218, v36, v37
    v_cvt_pk_bf16_f32 v219, v38, v39
    buffer_load_dwordx4 v67, s[4:7], s24 offen offset:3072 lds
    v_dot2_f32_bf16 v32, v224, s42, v18
    v_dot2_f32_bf16 v33, v224, s43, v18
    v_dot2_f32_bf16 v34, v225, s42, v18
    v_dot2_f32_bf16 v35, v225, s43, v18
    v_dot2_f32_bf16 v36, v226, s42, v18
    v_dot2_f32_bf16 v37, v226, s43, v18
    v_dot2_f32_bf16 v38, v227, s42, v18
    v_dot2_f32_bf16 v39, v227, s43, v18
    v_cvt_pk_bf16_f32 v220, v40, v41
    v_cvt_pk_bf16_f32 v221, v42, v43
    v_cvt_pk_bf16_f32 v222, v44, v45
    v_cvt_pk_bf16_f32 v223, v46, v47
    s_add_u32 m0, s59, 77824
    s_nop 0
    buffer_load_dwordx4 v68, s[4:7], s24 offen offset:0 lds
    v_dot2_f32_bf16 v40, v228, s42, v18
    v_dot2_f32_bf16 v41, v228, s43, v18
    v_dot2_f32_bf16 v42, v229, s42, v18
    v_dot2_f32_bf16 v43, v229, s43, v18
    v_dot2_f32_bf16 v44, v230, s42, v18
    v_dot2_f32_bf16 v45, v230, s43, v18
    v_dot2_f32_bf16 v46, v231, s42, v18
    v_dot2_f32_bf16 v47, v231, s43, v18
    v_cvt_pk_bf16_f32 v224, v32, v33
    v_cvt_pk_bf16_f32 v225, v34, v35
    v_cvt_pk_bf16_f32 v226, v36, v37
    v_cvt_pk_bf16_f32 v227, v38, v39
    v_dot2_f32_bf16 v32, v232, s42, v18
    v_dot2_f32_bf16 v33, v232, s43, v18
    v_dot2_f32_bf16 v34, v233, s42, v18
    v_dot2_f32_bf16 v35, v233, s43, v18
    v_dot2_f32_bf16 v36, v234, s42, v18
    v_dot2_f32_bf16 v37, v234, s43, v18
    v_dot2_f32_bf16 v38, v235, s42, v18
    v_dot2_f32_bf16 v39, v235, s43, v18
    v_cvt_pk_bf16_f32 v228, v40, v41
    v_cvt_pk_bf16_f32 v229, v42, v43
    v_cvt_pk_bf16_f32 v230, v44, v45
    v_cvt_pk_bf16_f32 v231, v46, v47
    buffer_load_dwordx4 v69, s[4:7], s24 offen offset:1024 lds
    s_add_u32 s24, s24, s26
    v_dot2_f32_bf16 v40, v236, s42, v18
    v_dot2_f32_bf16 v41, v236, s43, v18
    v_dot2_f32_bf16 v42, v237, s42, v18
    v_dot2_f32_bf16 v43, v237, s43, v18
    v_dot2_f32_bf16 v44, v238, s42, v18
    v_dot2_f32_bf16 v45, v238, s43, v18
    v_dot2_f32_bf16 v46, v239, s42, v18
    v_dot2_f32_bf16 v47, v239, s43, v18
    v_cvt_pk_bf16_f32 v232, v32, v33
    v_cvt_pk_bf16_f32 v233, v34, v35
    v_cvt_pk_bf16_f32 v234, v36, v37
    v_cvt_pk_bf16_f32 v235, v38, v39
    s_add_u32 m0, s59, 98304
    s_nop 0
    buffer_load_dwordx4 v64, s[4:7], s24 offen offset:0 lds
    v_dot2_f32_bf16 v32, v240, s42, v18
    v_dot2_f32_bf16 v33, v240, s43, v18
    v_dot2_f32_bf16 v34, v241, s42, v18
    v_dot2_f32_bf16 v35, v241, s43, v18
    v_dot2_f32_bf16 v36, v242, s42, v18
    v_dot2_f32_bf16 v37, v242, s43, v18
    v_dot2_f32_bf16 v38, v243, s42, v18
    v_dot2_f32_bf16 v39, v243, s43, v18
    v_cvt_pk_bf16_f32 v236, v40, v41
    v_cvt_pk_bf16_f32 v237, v42, v43
    v_cvt_pk_bf16_f32 v238, v44, v45
    v_cvt_pk_bf16_f32 v239, v46, v47
    v_dot2_f32_bf16 v40, v244, s42, v18
    v_dot2_f32_bf16 v41, v244, s43, v18
    v_dot2_f32_bf16 v42, v245, s42, v18
    v_dot2_f32_bf16 v43, v245, s43, v18
    v_dot2_f32_bf16 v44, v246, s42, v18
    v_dot2_f32_bf16 v45, v246, s43, v18
    v_dot2_f32_bf16 v46, v247, s42, v18
    v_dot2_f32_bf16 v47, v247, s43, v18
    v_cvt_pk_bf16_f32 v240, v32, v33
    v_cvt_pk_bf16_f32 v241, v34, v35
    v_cvt_pk_bf16_f32 v242, v36, v37
    v_cvt_pk_bf16_f32 v243, v38, v39
    buffer_load_dwordx4 v65, s[4:7], s24 offen offset:1024 lds
    v_dot2_f32_bf16 v32, v248, s42, v18
    v_dot2_f32_bf16 v33, v248, s43, v18
    v_dot2_f32_bf16 v34, v249, s42, v18
    v_dot2_f32_bf16 v35, v249, s43, v18
    v_dot2_f32_bf16 v36, v250, s42, v18
    v_dot2_f32_bf16 v37, v250, s43, v18
    v_dot2_f32_bf16 v38, v251, s42, v18
    v_dot2_f32_bf16 v39, v251, s43, v18
    v_cvt_pk_bf16_f32 v244, v40, v41
    v_cvt_pk_bf16_f32 v245, v42, v43
    v_cvt_pk_bf16_f32 v246, v44, v45
    v_cvt_pk_bf16_f32 v247, v46, v47
    buffer_load_dwordx4 v66, s[4:7], s24 offen offset:2048 lds
    v_dot2_f32_bf16 v40, v252, s42, v18
    v_dot2_f32_bf16 v41, v252, s43, v18
    v_dot2_f32_bf16 v42, v253, s42, v18
    v_dot2_f32_bf16 v43, v253, s43, v18
    v_dot2_f32_bf16 v44, v254, s42, v18
    v_dot2_f32_bf16 v45, v254, s43, v18
    v_dot2_f32_bf16 v46, v255, s42, v18
    v_dot2_f32_bf16 v47, v255, s43, v18
    v_cvt_pk_bf16_f32 v248, v32, v33
    v_cvt_pk_bf16_f32 v249, v34, v35
    v_cvt_pk_bf16_f32 v250, v36, v37
    v_cvt_pk_bf16_f32 v251, v38, v39
    s_nop 2
    v_cvt_pk_bf16_f32 v252, v40, v41
    v_cvt_pk_bf16_f32 v253, v42, v43
    v_cvt_pk_bf16_f32 v254, v44, v45
    v_cvt_pk_bf16_f32 v255, v46, v47
    s_nop 2
    s_waitcnt vmcnt(21)
    s_barrier
    ds_read_b64_tr_b16 a[0:1], v4 offset:0
    ds_read_b64_tr_b16 a[2:3], v4 offset:512
    ds_read_b64_tr_b16 a[4:5], v4 offset:2048
    ds_read_b64_tr_b16 a[6:7], v4 offset:2560
    ds_read_b64_tr_b16 a[8:9], v4 offset:4096
    ds_read_b64_tr_b16 a[10:11], v4 offset:4608
    ds_read_b64_tr_b16 a[12:13], v4 offset:6144
    ds_read_b64_tr_b16 a[14:15], v4 offset:6656
    ds_read_b64_tr_b16 a[16:17], v4 offset:8192
    ds_read_b64_tr_b16 a[18:19], v4 offset:8704
    ds_read_b64_tr_b16 a[20:21], v4 offset:10240
    ds_read_b64_tr_b16 a[22:23], v4 offset:10752
    s_cmp_lt_u32 s20, 2
    s_cbranch_scc0 Lno3
    buffer_load_dwordx4 v67, s[4:7], s24 offen offset:3072 lds
Lno3:
    v_lshlrev_b32 v77, 8, v1
    v_mov_b32 v78, 1
    buffer_store_byte v78, v77, s[16:19], s62 offen sc0 sc1
    s_lshl_b32 s54, s23, 2
    s_add_u32 s54, s54, s20
    s_cmp_eq_u32 s54, 1
    s_cbranch_scc1 Lp1_f1
    s_cmp_eq_u32 s54, 2
    s_cbranch_scc1 Lp1_f2
    s_cmp_eq_u32 s54, 3
    s_cbranch_scc1 Lp1_f3
    s_cmp_eq_u32 s54, 4
    s_cbranch_scc1 Lp1_a0
    s_cmp_eq_u32 s54, 5
    s_cbranch_scc1 Lp1_a1
    s_cmp_eq_u32 s54, 6
    s_cbranch_scc1 Lp1_a2
    s_cmp_eq_u32 s54, 7
    s_cbranch_scc1 Lp1_a3
    .p2align 6
Lp1_f0:
    ds_read_b64_tr_b16 a[24:25], v4 offset:12288
    ds_read_b64_tr_b16 a[26:27], v4 offset:12800
    s_waitcnt lgkmcnt(10)
    v_mfma_f32_32x32x16_bf16 v[16:31], a[0:3], a[64:67], 0
    ds_read_b64_tr_b16 a[28:29], v4 offset:14336
    ds_read_b64_tr_b16 a[30:31], v4 offset:14848
    v_mfma_f32_32x32x16_bf16 v[16:31], a[4:7], a[68:71], v[16:31]
    s_add_u32 m0, s29, 28672
    v_cvt_pk_bf16_f32 v56, v32, v33
    ds_read_b64_tr_b16 a[0:1], v4 offset:16384
    ds_read_b64_tr_b16 a[2:3], v4 offset:16896
    s_waitcnt lgkmcnt(10)
    v_mfma_f32_32x32x16_bf16 v[16:31], a[8:11], a[72:75], v[16:31]
    buffer_load_dwordx4 v68, s[4:7], s24 offen offset:0 lds
    ds_read_b64_tr_b16 a[4:5], v4 offset:18432
    ds_read_b64_tr_b16 a[6:7], v4 offset:18944
    v_mfma_f32_32x32x16_bf16 v[16:31], a[12:15], a[76:79], v[16:31]
    v_cvt_pk_bf16_f32 v57, v34, v35
    v_cvt_pk_bf16_f32 v58, v36, v37
    ds_read_b64_tr_b16 a[8:9], v4 offset:20480
    ds_read_b64_tr_b16 a[10:11], v4 offset:20992
    s_waitcnt lgkmcnt(10)
    v_mfma_f32_32x32x16_bf16 v[16:31], a[16:19], a[80:83], v[16:31]
    v_cvt_pk_bf16_f32 v59, v38, v39
    v_cvt_pk_bf16_f32 v60, v40, v41
    v_cvt_pk_bf16_f32 v61, v42, v43
    ds_read_b64_tr_b16 a[12:13], v4 offset:22528
    ds_read_b64_tr_b16 a[14:15], v4 offset:23040
    v_mfma_f32_32x32x16_bf16 v[16:31], a[20:23], a[84:87], v[16:31]
    v_cvt_pk_bf16_f32 v62, v44, v45
    v_cvt_pk_bf16_f32 v63, v46, v47
    ds_read_b64_tr_b16 a[16:17], v5 offset:0
    ds_read_b64_tr_b16 a[18:19], v5 offset:512
    s_waitcnt lgkmcnt(10)
    v_mfma_f32_32x32x16_bf16 v[16:31], a[24:27], a[88:91], v[16:31]
    buffer_load_dwordx4 v69, s[4:7], s24 offen offset:1024 lds
    ds_read_b64_tr_b16 a[20:21], v5 offset:2048
    ds_read_b64_tr_b16 a[22:23], v5 offset:2560
    v_mfma_f32_32x32x16_bf16 v[16:31], a[28:31], a[92:95], v[16:31]
    s_add_u32 s24, s24, s27
    ds_read_b64_tr_b16 a[24:25], v5 offset:4096
    ds_read_b64_tr_b16 a[26:27], v5 offset:4608
    s_waitcnt lgkmcnt(10)
    v_mfma_f32_32x32x16_bf16 v[16:31], a[0:3], a[96:99], v[16:31]
    ds_read_b64_tr_b16 a[28:29], v5 offset:6144
    ds_read_b64_tr_b16 a[30:31], v5 offset:6656
    v_mfma_f32_32x32x16_bf16 v[16:31], a[4:7], a[100:103], v[16:31]
    s_add_u32 m0, s29, 49152
    s_waitcnt vmcnt(19)
    s_barrier
    ds_read_b64_tr_b16 a[0:1], v5 offset:8192
    ds_read_b64_tr_b16 a[2:3], v5 offset:8704
    s_waitcnt lgkmcnt(10)
    v_mfma_f32_32x32x16_bf16 v[16:31], a[8:11], a[104:107], v[16:31]
    buffer_load_dwordx4 v64, s[4:7], s24 offen offset:0 lds
    ds_read_b64_tr_b16 a[4:5], v5 offset:10240
    ds_read_b64_tr_b16 a[6:7], v5 offset:10752
    v_mfma_f32_32x32x16_bf16 v[16:31], a[12:15], a[108:111], v[16:31]
    ds_read_b64_tr_b16 a[8:9], v5 offset:12288
    ds_read_b64_tr_b16 a[10:11], v5 offset:12800
    s_waitcnt lgkmcnt(10)
    v_mfma_f32_32x32x16_bf16 v[32:47], a[16:19], a[64:67], 0
    ds_read_b64_tr_b16 a[12:13], v5 offset:14336
    ds_read_b64_tr_b16 a[14:15], v5 offset:14848
    v_mfma_f32_32x32x16_bf16 v[32:47], a[20:23], a[68:71], v[32:47]
    ds_read_b64_tr_b16 a[16:17], v5 offset:16384
    ds_read_b64_tr_b16 a[18:19], v5 offset:16896
    s_waitcnt lgkmcnt(10)
    v_mfma_f32_32x32x16_bf16 v[32:47], a[24:27], a[72:75], v[32:47]
    buffer_load_dwordx4 v65, s[4:7], s24 offen offset:1024 lds
    ds_read_b64_tr_b16 a[20:21], v5 offset:18432
    ds_read_b64_tr_b16 a[22:23], v5 offset:18944
    v_mfma_f32_32x32x16_bf16 v[32:47], a[28:31], a[76:79], v[32:47]
    ds_read_b64_tr_b16 a[24:25], v5 offset:20480
    ds_read_b64_tr_b16 a[26:27], v5 offset:20992
    s_waitcnt lgkmcnt(10)
    v_mfma_f32_32x32x16_bf16 v[32:47], a[0:3], a[80:83], v[32:47]
    buffer_load_dword a63, v79, s[44:47], s52 offen
    ds_read_b64_tr_b16 a[28:29], v5 offset:22528
    ds_read_b64_tr_b16 a[30:31], v5 offset:23040
    v_mfma_f32_32x32x16_bf16 v[32:47], a[4:7], a[84:87], v[32:47]
    s_add_u32 s52, s52, 1792
    ds_read_b64_tr_b16 a[0:1], v4 offset:24576
    ds_read_b64_tr_b16 a[2:3], v4 offset:25088
    s_waitcnt lgkmcnt(10)
    v_mfma_f32_32x32x16_bf16 v[32:47], a[8:11], a[88:91], v[32:47]
    buffer_load_dwordx4 v66, s[4:7], s24 offen offset:2048 lds
    ds_read_b64_tr_b16 a[4:5], v4 offset:26624
    ds_read_b64_tr_b16 a[6:7], v4 offset:27136
    v_mfma_f32_32x32x16_bf16 v[32:47], a[12:15], a[92:95], v[32:47]
    s_cmp_ge_u32 s31, 2
    s_cselect_b32 s46, 0, s46
    ds_read_b64_tr_b16 a[8:9], v4 offset:28672
    ds_read_b64_tr_b16 a[10:11], v4 offset:29184
    s_waitcnt lgkmcnt(10)
    v_mfma_f32_32x32x16_bf16 v[32:47], a[16:19], a[96:99], v[32:47]
    ds_read_b64_tr_b16 a[12:13], v4 offset:30720
    ds_read_b64_tr_b16 a[14:15], v4 offset:31232
    v_mfma_f32_32x32x16_bf16 v[32:47], a[20:23], a[100:103], v[32:47]
    ds_read_b64_tr_b16 a[16:17], v4 offset:32768
    ds_read_b64_tr_b16 a[18:19], v4 offset:33280
    s_waitcnt lgkmcnt(10)
    v_mfma_f32_32x32x16_bf16 v[32:47], a[24:27], a[104:107], v[32:47]
    buffer_load_dwordx4 v67, s[4:7], s24 offen offset:3072 lds
    ds_read_b64_tr_b16 a[20:21], v4 offset:34816
    ds_read_b64_tr_b16 a[22:23], v4 offset:35328
    v_mfma_f32_32x32x16_bf16 v[32:47], a[28:31], a[108:111], v[32:47]
    ds_read_b64_tr_b16 a[24:25], v4 offset:36864
    ds_read_b64_tr_b16 a[26:27], v4 offset:37376
    s_waitcnt lgkmcnt(10)
    v_mfma_f32_32x32x16_bf16 v[16:31], a[0:3], a[112:115], v[16:31]
    ds_read_b64_tr_b16 a[28:29], v4 offset:38912
    ds_read_b64_tr_b16 a[30:31], v4 offset:39424
    v_mfma_f32_32x32x16_bf16 v[16:31], a[4:7], a[116:119], v[16:31]
    s_set_gpr_idx_on s32, 0x8
    s_nop 0
    v_pk_max_i16 v80, v48, 0
    v_pk_max_i16 v81, v49, 0
    v_pk_max_i16 v82, v50, 0
    v_pk_max_i16 v83, v51, 0
    v_pk_max_i16 v84, v52, 0
    v_pk_max_i16 v85, v53, 0
    v_pk_max_i16 v86, v54, 0
    v_pk_max_i16 v87, v55, 0
    s_set_gpr_idx_off
    s_add_u32 m0, s29, 53248
    ds_read_b64_tr_b16 a[0:1], v4 offset:40960
    ds_read_b64_tr_b16 a[2:3], v4 offset:41472
    s_waitcnt lgkmcnt(10)
    v_mfma_f32_32x32x16_bf16 v[16:31], a[8:11], a[120:123], v[16:31]
    buffer_load_dwordx4 v68, s[4:7], s24 offen offset:0 lds
    ds_read_b64_tr_b16 a[4:5], v4 offset:43008
    ds_read_b64_tr_b16 a[6:7], v4 offset:43520
    v_mfma_f32_32x32x16_bf16 v[16:31], a[12:15], a[124:127], v[16:31]
    ds_read_b64_tr_b16 a[8:9], v4 offset:45056
    ds_read_b64_tr_b16 a[10:11], v4 offset:45568
    s_waitcnt lgkmcnt(10)
    v_mfma_f32_32x32x16_bf16 v[16:31], a[16:19], a[128:131], v[16:31]
    ds_read_b64_tr_b16 a[12:13], v4 offset:47104
    ds_read_b64_tr_b16 a[14:15], v4 offset:47616
    v_mfma_f32_32x32x16_bf16 v[16:31], a[20:23], a[132:135], v[16:31]
    ds_read_b64_tr_b16 a[16:17], v5 offset:24576
    ds_read_b64_tr_b16 a[18:19], v5 offset:25088
    s_waitcnt lgkmcnt(10)
    v_mfma_f32_32x32x16_bf16 v[16:31], a[24:27], a[136:139], v[16:31]
    buffer_load_dwordx4 v69, s[4:7], s24 offen offset:1024 lds
    ds_read_b64_tr_b16 a[20:21], v5 offset:26624
    ds_read_b64_tr_b16 a[22:23], v5 offset:27136
    v_mfma_f32_32x32x16_bf16 v[16:31], a[28:31], a[140:143], v[16:31]
    s_add_u32 s24, s24, s25
    ds_read_b64_tr_b16 a[24:25], v5 offset:28672
    ds_read_b64_tr_b16 a[26:27], v5 offset:29184
    s_waitcnt lgkmcnt(10)
    v_mfma_f32_32x32x16_bf16 v[16:31], a[0:3], v[192:195], v[16:31]
    s_cmp_ge_u32 s31, 4
    s_cbranch_scc1 Lsw_f0
Lswr_f0:
    ds_read_b64_tr_b16 a[28:29], v5 offset:30720
    ds_read_b64_tr_b16 a[30:31], v5 offset:31232
    v_mfma_f32_32x32x16_bf16 v[16:31], a[4:7], v[196:199], v[16:31]
    s_add_u32 m0, s28, 0
    s_waitcnt vmcnt(19)
    s_barrier
    ds_read_b64_tr_b16 a[0:1], v5 offset:32768
    ds_read_b64_tr_b16 a[2:3], v5 offset:33280
    s_waitcnt lgkmcnt(10)
    v_mfma_f32_32x32x16_bf16 v[16:31], a[8:11], v[200:203], v[16:31]
    buffer_load_dwordx4 v64, s[4:7], s24 offen offset:0 lds
    ds_read_b64_tr_b16 a[4:5], v5 offset:34816
    ds_read_b64_tr_b16 a[6:7], v5 offset:35328
    v_mfma_f32_32x32x16_bf16 v[16:31], a[12:15], v[204:207], v[16:31]
    ds_read_b64_tr_b16 a[8:9], v5 offset:36864
    ds_read_b64_tr_b16 a[10:11], v5 offset:37376
    s_waitcnt lgkmcnt(10)
    v_mfma_f32_32x32x16_bf16 v[32:47], a[16:19], a[112:115], v[32:47]
    v_xor_b32 v4, v8, v4
    ds_read_b64_tr_b16 a[12:13], v5 offset:38912
    ds_read_b64_tr_b16 a[14:15], v5 offset:39424
    v_mfma_f32_32x32x16_bf16 v[32:47], a[20:23], a[116:119], v[32:47]
    ds_read_b64_tr_b16 a[16:17], v5 offset:40960
    ds_read_b64_tr_b16 a[18:19], v5 offset:41472
    s_waitcnt lgkmcnt(10)
    v_mfma_f32_32x32x16_bf16 v[32:47], a[24:27], a[120:123], v[32:47]
    buffer_load_dwordx4 v65, s[4:7], s24 offen offset:1024 lds
    ds_read_b64_tr_b16 a[20:21], v5 offset:43008
    ds_read_b64_tr_b16 a[22:23], v5 offset:43520
    v_mfma_f32_32x32x16_bf16 v[32:47], a[28:31], a[124:127], v[32:47]
    ds_read_b64_tr_b16 a[24:25], v5 offset:45056
    ds_read_b64_tr_b16 a[26:27], v5 offset:45568
    s_waitcnt lgkmcnt(10)
    v_mfma_f32_32x32x16_bf16 v[32:47], a[0:3], a[128:131], v[32:47]
    ds_read_b64_tr_b16 a[28:29], v5 offset:47104
    ds_read_b64_tr_b16 a[30:31], v5 offset:47616
    v_mfma_f32_32x32x16_bf16 v[32:47], a[4:7], a[132:135], v[32:47]
    ds_read_b64_tr_b16 a[0:1], v6 offset:0
    ds_read_b64_tr_b16 a[2:3], v6 offset:512
    s_waitcnt lgkmcnt(10)
    v_mfma_f32_32x32x16_bf16 v[32:47], a[8:11], a[136:139], v[32:47]
    buffer_load_dwordx4 v66, s[4:7], s24 offen offset:2048 lds
    ds_read_b64_tr_b16 a[4:5], v6 offset:2048
    ds_read_b64_tr_b16 a[6:7], v6 offset:2560
    v_mfma_f32_32x32x16_bf16 v[32:47], a[12:15], a[140:143], v[32:47]
    v_xor_b32 v5, 73728, v5
    ds_read_b64_tr_b16 a[8:9], v6 offset:4096
    ds_read_b64_tr_b16 a[10:11], v6 offset:4608
    s_waitcnt lgkmcnt(10)
    v_mfma_f32_32x32x16_bf16 v[32:47], a[16:19], v[192:195], v[32:47]
    ds_read_b64_tr_b16 a[12:13], v6 offset:6144
    ds_read_b64_tr_b16 a[14:15], v6 offset:6656
    v_mfma_f32_32x32x16_bf16 v[32:47], a[20:23], v[196:199], v[32:47]
    ds_read_b64_tr_b16 a[16:17], v6 offset:8192
    ds_read_b64_tr_b16 a[18:19], v6 offset:8704
    s_waitcnt lgkmcnt(10)
    v_mfma_f32_32x32x16_bf16 v[32:47], a[24:27], v[200:203], v[32:47]
    buffer_load_dwordx4 v67, s[4:7], s24 offen offset:3072 lds
    ds_read_b64_tr_b16 a[20:21], v6 offset:10240
    ds_read_b64_tr_b16 a[22:23], v6 offset:10752
    v_mfma_f32_32x32x16_bf16 v[32:47], a[28:31], v[204:207], v[32:47]
    ds_read_b64_tr_b16 a[24:25], v6 offset:12288
    ds_read_b64_tr_b16 a[26:27], v6 offset:12800
    s_waitcnt lgkmcnt(10)
    v_mfma_f32_32x32x16_bf16 v[16:31], a[0:3], v[208:211], v[16:31]
    ds_read_b64_tr_b16 a[28:29], v6 offset:14336
    ds_read_b64_tr_b16 a[30:31], v6 offset:14848
    v_mfma_f32_32x32x16_bf16 v[16:31], a[4:7], v[212:215], v[16:31]
    s_set_gpr_idx_on s32, 0x8
    s_nop 0
    v_pk_max_i16 v88, v56, 0
    v_pk_max_i16 v89, v57, 0
    v_pk_max_i16 v90, v58, 0
    v_pk_max_i16 v91, v59, 0
    v_pk_max_i16 v92, v60, 0
    v_pk_max_i16 v93, v61, 0
    v_pk_max_i16 v94, v62, 0
    v_pk_max_i16 v95, v63, 0
    s_set_gpr_idx_off
    s_add_u32 s32, s32, s33
    s_mov_b32 s33, 16
    s_add_u32 m0, s28, 4096
    ds_read_b64_tr_b16 a[0:1], v6 offset:16384
    ds_read_b64_tr_b16 a[2:3], v6 offset:16896
    s_waitcnt lgkmcnt(10)
    v_mfma_f32_32x32x16_bf16 v[16:31], a[8:11], v[216:219], v[16:31]
    buffer_load_dwordx4 v68, s[4:7], s24 offen offset:0 lds
    ds_read_b64_tr_b16 a[4:5], v6 offset:18432
    ds_read_b64_tr_b16 a[6:7], v6 offset:18944
    v_mfma_f32_32x32x16_bf16 v[16:31], a[12:15], v[220:223], v[16:31]
    ds_read_b64_tr_b16 a[8:9], v6 offset:20480
    ds_read_b64_tr_b16 a[10:11], v6 offset:20992
    s_waitcnt lgkmcnt(10)
    v_mfma_f32_32x32x16_bf16 v[16:31], a[16:19], v[224:227], v[16:31]
    ds_read_b64_tr_b16 a[12:13], v6 offset:22528
    ds_read_b64_tr_b16 a[14:15], v6 offset:23040
    v_mfma_f32_32x32x16_bf16 v[16:31], a[20:23], v[228:231], v[16:31]
    ds_read_b64_tr_b16 a[16:17], v7 offset:0
    ds_read_b64_tr_b16 a[18:19], v7 offset:512
    s_waitcnt lgkmcnt(10)
    v_mfma_f32_32x32x16_bf16 v[16:31], a[24:27], v[232:235], v[16:31]
    buffer_load_dwordx4 v69, s[4:7], s24 offen offset:1024 lds
    ds_read_b64_tr_b16 a[20:21], v7 offset:2048
    ds_read_b64_tr_b16 a[22:23], v7 offset:2560
    v_mfma_f32_32x32x16_bf16 v[16:31], a[28:31], v[236:239], v[16:31]
    s_add_u32 s24, s24, s26
    v_xor_b32 v6, 73728, v6
    ds_read_b64_tr_b16 a[24:25], v7 offset:4096
    ds_read_b64_tr_b16 a[26:27], v7 offset:4608
    s_waitcnt lgkmcnt(10)
    v_mfma_f32_32x32x16_bf16 v[16:31], a[0:3], v[240:243], v[16:31]
    ds_read_b64_tr_b16 a[28:29], v7 offset:6144
    ds_read_b64_tr_b16 a[30:31], v7 offset:6656
    v_mfma_f32_32x32x16_bf16 v[16:31], a[4:7], v[244:247], v[16:31]
    s_add_u32 m0, s28, 24576
    s_waitcnt vmcnt(19)
    s_barrier
    ds_read_b64_tr_b16 a[0:1], v7 offset:8192
    ds_read_b64_tr_b16 a[2:3], v7 offset:8704
    s_waitcnt lgkmcnt(10)
    v_mfma_f32_32x32x16_bf16 v[16:31], a[8:11], v[248:251], v[16:31]
    buffer_load_dwordx4 v64, s[4:7], s24 offen offset:0 lds
    ds_read_b64_tr_b16 a[4:5], v7 offset:10240
    ds_read_b64_tr_b16 a[6:7], v7 offset:10752
    v_mfma_f32_32x32x16_bf16 v[16:31], a[12:15], v[252:255], v[16:31]
    ds_read_b64_tr_b16 a[8:9], v7 offset:12288
    ds_read_b64_tr_b16 a[10:11], v7 offset:12800
    s_waitcnt lgkmcnt(10)
    v_mfma_f32_32x32x16_bf16 v[32:47], a[16:19], v[208:211], v[32:47]
    ds_read_b64_tr_b16 a[12:13], v7 offset:14336
    ds_read_b64_tr_b16 a[14:15], v7 offset:14848
    v_mfma_f32_32x32x16_bf16 v[32:47], a[20:23], v[212:215], v[32:47]
    v_cvt_pk_bf16_f32 v48, v16, v17
    v_cvt_pk_bf16_f32 v49, v18, v19
    ds_read_b64_tr_b16 a[16:17], v7 offset:16384
    ds_read_b64_tr_b16 a[18:19], v7 offset:16896
    s_waitcnt lgkmcnt(10)
    v_mfma_f32_32x32x16_bf16 v[32:47], a[24:27], v[216:219], v[32:47]
    buffer_load_dwordx4 v65, s[4:7], s24 offen offset:1024 lds
    ds_read_b64_tr_b16 a[20:21], v7 offset:18432
    ds_read_b64_tr_b16 a[22:23], v7 offset:18944
    v_mfma_f32_32x32x16_bf16 v[32:47], a[28:31], v[220:223], v[32:47]
    v_cvt_pk_bf16_f32 v50, v20, v21
    v_cvt_pk_bf16_f32 v51, v22, v23
    ds_read_b64_tr_b16 a[24:25], v7 offset:20480
    ds_read_b64_tr_b16 a[26:27], v7 offset:20992
    s_waitcnt lgkmcnt(10)
    v_mfma_f32_32x32x16_bf16 v[32:47], a[0:3], v[224:227], v[32:47]
    v_cvt_pk_bf16_f32 v52, v24, v25
    v_cvt_pk_bf16_f32 v53, v26, v27
    v_cvt_pk_bf16_f32 v54, v28, v29
    ds_read_b64_tr_b16 a[28:29], v7 offset:22528
    ds_read_b64_tr_b16 a[30:31], v7 offset:23040
    v_mfma_f32_32x32x16_bf16 v[32:47], a[4:7], v[228:231], v[32:47]
    v_cvt_pk_bf16_f32 v55, v30, v31
    ds_read_b64_tr_b16 a[0:1], v4 offset:0
    ds_read_b64_tr_b16 a[2:3], v4 offset:512
    s_waitcnt lgkmcnt(10)
    v_mfma_f32_32x32x16_bf16 v[32:47], a[8:11], v[232:235], v[32:47]
    buffer_load_dwordx4 v66, s[4:7], s24 offen offset:2048 lds
    ds_read_b64_tr_b16 a[4:5], v4 offset:2048
    ds_read_b64_tr_b16 a[6:7], v4 offset:2560
    v_mfma_f32_32x32x16_bf16 v[32:47], a[12:15], v[236:239], v[32:47]
    v_xor_b32 v7, 73728, v7
    ds_read_b64_tr_b16 a[8:9], v4 offset:4096
    ds_read_b64_tr_b16 a[10:11], v4 offset:4608
    s_waitcnt lgkmcnt(10)
    v_mfma_f32_32x32x16_bf16 v[32:47], a[16:19], v[240:243], v[32:47]
    ds_read_b64_tr_b16 a[12:13], v4 offset:6144
    ds_read_b64_tr_b16 a[14:15], v4 offset:6656
    v_mfma_f32_32x32x16_bf16 v[32:47], a[20:23], v[244:247], v[32:47]
    ds_read_b64_tr_b16 a[16:17], v4 offset:8192
    ds_read_b64_tr_b16 a[18:19], v4 offset:8704
    s_waitcnt lgkmcnt(10)
    v_mfma_f32_32x32x16_bf16 v[32:47], a[24:27], v[248:251], v[32:47]
    buffer_load_dwordx4 v67, s[4:7], s24 offen offset:3072 lds
    ds_read_b64_tr_b16 a[20:21], v4 offset:10240
    ds_read_b64_tr_b16 a[22:23], v4 offset:10752
    v_mfma_f32_32x32x16_bf16 v[32:47], a[28:31], v[252:255], v[32:47]
    s_xor_b32 s28, s28, 73728
    s_xor_b32 s29, s29, 73728
    s_add_u32 s31, s31, 1
    s_cmp_lt_u32 s31, 6
    s_cbranch_scc1 Lp1_f0
    s_mov_b32 s56, 0x40000000
    v_pk_max_i16 v160, v48, 0
    v_pk_max_i16 v161, v49, 0
    v_pk_max_i16 v162, v50, 0
    v_pk_max_i16 v163, v51, 0
    v_pk_max_i16 v164, v52, 0
    v_pk_max_i16 v165, v53, 0
    v_pk_max_i16 v166, v54, 0
    v_pk_max_i16 v167, v55, 0
    s_lshl_b32 s62, s21, 4
    buffer_load_dword a60, off, s[16:19], s62 sc0 sc1
    buffer_store_dwordx4 v[48:51], v11, s[12:15], s56 offen
    buffer_store_dwordx4 v[48:51], v11, s[12:15], s56 offen
    buffer_store_dwordx4 v[48:51], v11, s[12:15], s56 offen
    v_xor_b32 v6, 64, v14
    v_xor_b32 v5, 64, v14
    s_mov_b32 s31, 0
    s_mov_b32 s30, 0
    s_mov_b32 s28, 0
    s_mov_b32 s29, 98304
    s_nop 3
    v_cvt_pk_bf16_f32 v56, v32, v33
    v_cvt_pk_bf16_f32 v57, v34, v35
    v_cvt_pk_bf16_f32 v58, v36, v37
    v_cvt_pk_bf16_f32 v59, v38, v39
    v_cvt_pk_bf16_f32 v60, v40, v41
    v_cvt_pk_bf16_f32 v61, v42, v43
    v_cvt_pk_bf16_f32 v62, v44, v45
    v_cvt_pk_bf16_f32 v63, v46, v47
    v_pk_max_i16 v168, v56, 0
    v_pk_max_i16 v169, v57, 0
    v_pk_max_i16 v170, v58, 0
    v_pk_max_i16 v171, v59, 0
    v_pk_max_i16 v172, v60, 0
    v_pk_max_i16 v173, v61, 0
    v_pk_max_i16 v174, v62, 0
    v_pk_max_i16 v175, v63, 0
    s_mul_i32 s62, s21, 1536
    s_lshl_b32 s63, s22, 2
    s_add_u32 s62, s62, s63
    s_add_u32 s62, s62, 38338560
    v_lshlrev_b32 v77, 7, v1
    v_mov_b32 v79, 1073741824
    v_cmp_gt_u32 vcc, 12, v1
    s_nop 1
    v_cndmask_b32 v77, v79, v77, vcc
    .p2align 6
Lp2_0:
    ds_read_b64_tr_b16 a[24:25], v4 offset:12288
    ds_read_b64_tr_b16 a[26:27], v4 offset:12800
    s_waitcnt lgkmcnt(10)
    v_mfma_f32_32x32x16_bf16 v[16:31], a[0:3], v[80:83], 0
    ds_read_b64_tr_b16 a[28:29], v4 offset:14336
    ds_read_b64_tr_b16 a[30:31], v4 offset:14848
    v_mfma_f32_32x32x16_bf16 v[16:31], a[4:7], v[84:87], v[16:31]
    s_add_u32 m0, s29, 4096
    v_cvt_pk_bf16_f32 v56, v32, v33
    v_cvt_pk_bf16_f32 v57, v34, v35
    ds_read_b64_tr_b16 a[0:1], v4 offset:16384
    ds_read_b64_tr_b16 a[2:3], v4 offset:16896
    s_waitcnt lgkmcnt(10)
    v_mfma_f32_32x32x16_bf16 v[16:31], a[8:11], v[88:91], v[16:31]
    buffer_load_dwordx4 v68, s[4:7], s24 offen offset:0 lds
    v_cvt_pk_bf16_f32 v58, v36, v37
    ds_read_b64_tr_b16 a[4:5], v4 offset:18432
    ds_read_b64_tr_b16 a[6:7], v4 offset:18944
    v_mfma_f32_32x32x16_bf16 v[16:31], a[12:15], v[92:95], v[16:31]
    v_cvt_pk_bf16_f32 v59, v38, v39
    v_cvt_pk_bf16_f32 v60, v40, v41
    v_cvt_pk_bf16_f32 v61, v42, v43
    ds_read_b64_tr_b16 a[8:9], v4 offset:20480
    ds_read_b64_tr_b16 a[10:11], v4 offset:20992
    s_waitcnt lgkmcnt(10)
    v_mfma_f32_32x32x16_bf16 v[16:31], a[16:19], v[96:99], v[16:31]
    buffer_store_dwordx4 v[48:51], v11, s[12:15], s56 offen offset:0 sc0 sc1
    v_cvt_pk_bf16_f32 v62, v44, v45
    ds_read_b64_tr_b16 a[12:13], v4 offset:22528
    ds_read_b64_tr_b16 a[14:15], v4 offset:23040
    v_mfma_f32_32x32x16_bf16 v[16:31], a[20:23], v[100:103], v[16:31]
    v_cvt_pk_bf16_f32 v63, v46, v47
    ds_read_b64_tr_b16 a[16:17], v5 offset:0
    ds_read_b64_tr_b16 a[18:19], v5 offset:512
    s_waitcnt lgkmcnt(10)
    v_mfma_f32_32x32x16_bf16 v[16:31], a[24:27], v[104:107], v[16:31]
    buffer_load_dwordx4 v69, s[4:7], s24 offen offset:1024 lds
    ds_read_b64_tr_b16 a[20:21], v5 offset:2048
    ds_read_b64_tr_b16 a[22:23], v5 offset:2560
    v_mfma_f32_32x32x16_bf16 v[16:31], a[28:31], v[108:111], v[16:31]
    s_add_u32 s24, s24, 221184
    ds_read_b64_tr_b16 a[24:25], v5 offset:4096
    ds_read_b64_tr_b16 a[26:27], v5 offset:4608
    s_waitcnt lgkmcnt(10)
    v_mfma_f32_32x32x16_bf16 v[16:31], a[0:3], v[112:115], v[16:31]
    buffer_store_dwordx4 v[52:55], v11, s[12:15], s56 offen offset:1024 sc0 sc1
    ds_read_b64_tr_b16 a[28:29], v5 offset:6144
    ds_read_b64_tr_b16 a[30:31], v5 offset:6656
    v_mfma_f32_32x32x16_bf16 v[16:31], a[4:7], v[116:119], v[16:31]
    s_add_u32 m0, s29, 24576
    s_waitcnt vmcnt(24)
    s_barrier
    ds_read_b64_tr_b16 a[0:1], v5 offset:8192
    ds_read_b64_tr_b16 a[2:3], v5 offset:8704
    s_waitcnt lgkmcnt(10)
    v_mfma_f32_32x32x16_bf16 v[16:31], a[8:11], v[120:123], v[16:31]
    buffer_load_dwordx4 v64, s[4:7], s24 offen offset:0 lds
    ds_read_b64_tr_b16 a[4:5], v5 offset:10240
    ds_read_b64_tr_b16 a[6:7], v5 offset:10752
    v_mfma_f32_32x32x16_bf16 v[16:31], a[12:15], v[124:127], v[16:31]
    v_accvgpr_read_b32 v78, a60
    v_cmp_eq_u32 vcc, 1, v78
    ds_read_b64_tr_b16 a[8:9], v5 offset:12288
    ds_read_b64_tr_b16 a[10:11], v5 offset:12800
    s_waitcnt lgkmcnt(10)
    v_mfma_f32_32x32x16_bf16 v[32:47], a[16:19], v[80:83], 0
    s_cmp_eq_u32 s31, 5
    s_cselect_b32 s63, s62, 1073741824
    ds_read_b64_tr_b16 a[12:13], v5 offset:14336
    ds_read_b64_tr_b16 a[14:15], v5 offset:14848
    v_mfma_f32_32x32x16_bf16 v[32:47], a[20:23], v[84:87], v[32:47]
    s_cmp_eq_u32 s31, 8
    s_cselect_b32 s63, s62, s63
    ds_read_b64_tr_b16 a[16:17], v5 offset:16384
    ds_read_b64_tr_b16 a[18:19], v5 offset:16896
    s_waitcnt lgkmcnt(10)
    v_mfma_f32_32x32x16_bf16 v[32:47], a[24:27], v[88:91], v[32:47]
    buffer_load_dwordx4 v65, s[4:7], s24 offen offset:1024 lds
    ds_read_b64_tr_b16 a[20:21], v5 offset:18432
    ds_read_b64_tr_b16 a[22:23], v5 offset:18944
    v_mfma_f32_32x32x16_bf16 v[32:47], a[28:31], v[92:95], v[32:47]
    ds_read_b64_tr_b16 a[24:25], v5 offset:20480
    ds_read_b64_tr_b16 a[26:27], v5 offset:20992
    s_waitcnt lgkmcnt(10)
    v_mfma_f32_32x32x16_bf16 v[32:47], a[0:3], v[96:99], v[32:47]
    buffer_store_dwordx4 v[56:59], v11, s[12:15], s56 offen offset:2048 sc0 sc1
    ds_read_b64_tr_b16 a[28:29], v5 offset:22528
    ds_read_b64_tr_b16 a[30:31], v5 offset:23040
    v_mfma_f32_32x32x16_bf16 v[32:47], a[4:7], v[100:103], v[32:47]
    ds_read_b64_tr_b16 a[0:1], v4 offset:24576
    ds_read_b64_tr_b16 a[2:3], v4 offset:25088
    s_waitcnt lgkmcnt(10)
    v_mfma_f32_32x32x16_bf16 v[32:47], a[8:11], v[104:107], v[32:47]
    buffer_load_dwordx4 v66, s[4:7], s24 offen offset:2048 lds
    ds_read_b64_tr_b16 a[4:5], v4 offset:26624
    ds_read_b64_tr_b16 a[6:7], v4 offset:27136
    v_mfma_f32_32x32x16_bf16 v[32:47], a[12:15], v[108:111], v[32:47]
    ds_read_b64_tr_b16 a[8:9], v4 offset:28672
    ds_read_b64_tr_b16 a[10:11], v4 offset:29184
    s_waitcnt lgkmcnt(10)
    v_mfma_f32_32x32x16_bf16 v[32:47], a[16:19], v[112:115], v[32:47]
    buffer_store_dwordx4 v[60:63], v11, s[12:15], s56 offen offset:3072 sc0 sc1
    ds_read_b64_tr_b16 a[12:13], v4 offset:30720
    ds_read_b64_tr_b16 a[14:15], v4 offset:31232
    v_mfma_f32_32x32x16_bf16 v[32:47], a[20:23], v[116:119], v[32:47]
    ds_read_b64_tr_b16 a[16:17], v4 offset:32768
    ds_read_b64_tr_b16 a[18:19], v4 offset:33280
    s_waitcnt lgkmcnt(10)
    v_mfma_f32_32x32x16_bf16 v[32:47], a[24:27], v[120:123], v[32:47]
    buffer_load_dwordx4 v67, s[4:7], s24 offen offset:3072 lds
    ds_read_b64_tr_b16 a[20:21], v4 offset:34816
    ds_read_b64_tr_b16 a[22:23], v4 offset:35328
    v_mfma_f32_32x32x16_bf16 v[32:47], a[28:31], v[124:127], v[32:47]
    s_cmp_eq_u32 s31, 8
    s_cselect_b32 s61, 3, 1
    v_mov_b32 v76, s61
    ds_read_b64_tr_b16 a[24:25], v4 offset:36864
    ds_read_b64_tr_b16 a[26:27], v4 offset:37376
    s_waitcnt lgkmcnt(10)
    v_mfma_f32_32x32x16_bf16 v[16:31], a[0:3], v[128:131], v[16:31]
    s_add_u32 s30, s30, 49152
    s_cmp_eq_u32 s30, 147456
    s_cselect_b32 s30, 0, s30
    ds_read_b64_tr_b16 a[28:29], v4 offset:38912
    ds_read_b64_tr_b16 a[30:31], v4 offset:39424
    v_mfma_f32_32x32x16_bf16 v[16:31], a[4:7], v[132:135], v[16:31]
    s_add_u32 m0, s29, 28672
    s_cmp_eq_u32 vcc_lo, -1
    s_cselect_b32 s63, s63, 1073741824
    ds_read_b64_tr_b16 a[0:1], v4 offset:40960
    ds_read_b64_tr_b16 a[2:3], v4 offset:41472
    s_waitcnt lgkmcnt(10)
    v_mfma_f32_32x32x16_bf16 v[16:31], a[8:11], v[136:139], v[16:31]
    buffer_load_dwordx4 v68, s[4:7], s24 offen offset:0 lds
    ds_read_b64_tr_b16 a[4:5], v4 offset:43008
    ds_read_b64_tr_b16 a[6:7], v4 offset:43520
    v_mfma_f32_32x32x16_bf16 v[16:31], a[12:15], v[140:143], v[16:31]
    s_mov_b32 s56, s58
    s_add_u32 s58, s58, 4096
    ds_read_b64_tr_b16 a[8:9], v4 offset:45056
    ds_read_b64_tr_b16 a[10:11], v4 offset:45568
    s_waitcnt lgkmcnt(10)
    v_mfma_f32_32x32x16_bf16 v[16:31], a[16:19], v[144:147], v[16:31]
    buffer_store_dword v76, v77, s[12:15], s63 offen sc0 sc1
    ds_read_b64_tr_b16 a[12:13], v4 offset:47104
    ds_read_b64_tr_b16 a[14:15], v4 offset:47616
    v_mfma_f32_32x32x16_bf16 v[16:31], a[20:23], v[148:151], v[16:31]
    ds_read_b64_tr_b16 a[16:17], v5 offset:24576
    ds_read_b64_tr_b16 a[18:19], v5 offset:25088
    s_waitcnt lgkmcnt(10)
    v_mfma_f32_32x32x16_bf16 v[16:31], a[24:27], v[152:155], v[16:31]
    buffer_load_dwordx4 v69, s[4:7], s24 offen offset:1024 lds
    ds_read_b64_tr_b16 a[20:21], v5 offset:26624
    ds_read_b64_tr_b16 a[22:23], v5 offset:27136
    v_mfma_f32_32x32x16_bf16 v[16:31], a[28:31], v[156:159], v[16:31]
    s_add_u32 s24, s24, 4294746240
    ds_read_b64_tr_b16 a[24:25], v5 offset:28672
    ds_read_b64_tr_b16 a[26:27], v5 offset:29184
    s_waitcnt lgkmcnt(10)
    v_mfma_f32_32x32x16_bf16 v[16:31], a[0:3], v[160:163], v[16:31]
    s_cmp_ge_u32 s31, 6
    s_cselect_b32 s6, 0, s6
    ds_read_b64_tr_b16 a[28:29], v5 offset:30720
    ds_read_b64_tr_b16 a[30:31], v5 offset:31232
    v_mfma_f32_32x32x16_bf16 v[16:31], a[4:7], v[164:167], v[16:31]
    s_add_u32 m0, s28, 0
    s_waitcnt vmcnt(25)
    s_barrier
    ds_read_b64_tr_b16 a[0:1], v5 offset:32768
    ds_read_b64_tr_b16 a[2:3], v5 offset:33280
    s_waitcnt lgkmcnt(10)
    v_mfma_f32_32x32x16_bf16 v[16:31], a[8:11], v[168:171], v[16:31]
    buffer_load_dwordx4 v64, s[4:7], s24 offen offset:0 lds
    ds_read_b64_tr_b16 a[4:5], v5 offset:34816
    ds_read_b64_tr_b16 a[6:7], v5 offset:35328
    v_mfma_f32_32x32x16_bf16 v[16:31], a[12:15], v[172:175], v[16:31]
    v_add_u32 v4, s30, v14
    ds_read_b64_tr_b16 a[8:9], v5 offset:36864
    ds_read_b64_tr_b16 a[10:11], v5 offset:37376
    s_waitcnt lgkmcnt(10)
    v_mfma_f32_32x32x16_bf16 v[32:47], a[16:19], v[128:131], v[32:47]
    ds_read_b64_tr_b16 a[12:13], v5 offset:38912
    ds_read_b64_tr_b16 a[14:15], v5 offset:39424
    v_mfma_f32_32x32x16_bf16 v[32:47], a[20:23], v[132:135], v[32:47]
    v_cvt_pk_bf16_f32 v48, v16, v17
    v_cvt_pk_bf16_f32 v49, v18, v19
    ds_read_b64_tr_b16 a[16:17], v5 offset:40960
    ds_read_b64_tr_b16 a[18:19], v5 offset:41472
    s_waitcnt lgkmcnt(10)
    v_mfma_f32_32x32x16_bf16 v[32:47], a[24:27], v[136:139], v[32:47]
    buffer_load_dwordx4 v65, s[4:7], s24 offen offset:1024 lds
    ds_read_b64_tr_b16 a[20:21], v5 offset:43008
    ds_read_b64_tr_b16 a[22:23], v5 offset:43520
    v_mfma_f32_32x32x16_bf16 v[32:47], a[28:31], v[140:143], v[32:47]
    v_cvt_pk_bf16_f32 v50, v20, v21
    v_cvt_pk_bf16_f32 v51, v22, v23
    ds_read_b64_tr_b16 a[24:25], v5 offset:45056
    ds_read_b64_tr_b16 a[26:27], v5 offset:45568
    s_waitcnt lgkmcnt(10)
    v_mfma_f32_32x32x16_bf16 v[32:47], a[0:3], v[144:147], v[32:47]
    v_cvt_pk_bf16_f32 v52, v24, v25
    v_cvt_pk_bf16_f32 v53, v26, v27
    v_cvt_pk_bf16_f32 v54, v28, v29
    ds_read_b64_tr_b16 a[28:29], v5 offset:47104
    ds_read_b64_tr_b16 a[30:31], v5 offset:47616
    v_mfma_f32_32x32x16_bf16 v[32:47], a[4:7], v[148:151], v[32:47]
    v_cvt_pk_bf16_f32 v55, v30, v31
    ds_read_b64_tr_b16 a[0:1], v4 offset:0
    ds_read_b64_tr_b16 a[2:3], v4 offset:512
    s_waitcnt lgkmcnt(10)
    v_mfma_f32_32x32x16_bf16 v[32:47], a[8:11], v[152:155], v[32:47]
    buffer_load_dwordx4 v66, s[4:7], s24 offen offset:2048 lds
    ds_read_b64_tr_b16 a[4:5], v4 offset:2048
    ds_read_b64_tr_b16 a[6:7], v4 offset:2560
    v_mfma_f32_32x32x16_bf16 v[32:47], a[12:15], v[156:159], v[32:47]
    v_add_u32 v5, s30, v6
    ds_read_b64_tr_b16 a[8:9], v4 offset:4096
    ds_read_b64_tr_b16 a[10:11], v4 offset:4608
    s_waitcnt lgkmcnt(10)
    v_mfma_f32_32x32x16_bf16 v[32:47], a[16:19], v[160:163], v[32:47]
    ds_read_b64_tr_b16 a[12:13], v4 offset:6144
    ds_read_b64_tr_b16 a[14:15], v4 offset:6656
    v_mfma_f32_32x32x16_bf16 v[32:47], a[20:23], v[164:167], v[32:47]
    ds_read_b64_tr_b16 a[16:17], v4 offset:8192
    ds_read_b64_tr_b16 a[18:19], v4 offset:8704
    s_waitcnt lgkmcnt(10)
    v_mfma_f32_32x32x16_bf16 v[32:47], a[24:27], v[168:171], v[32:47]
    buffer_load_dwordx4 v67, s[4:7], s24 offen offset:3072 lds
    ds_read_b64_tr_b16 a[20:21], v4 offset:10240
    ds_read_b64_tr_b16 a[22:23], v4 offset:10752
    v_mfma_f32_32x32x16_bf16 v[32:47], a[28:31], v[172:175], v[32:47]
    s_mov_b32 s29, s28
    s_mov_b32 s28, s30
    s_add_u32 s31, s31, 1
    s_cmp_lt_u32 s31, 9
    s_cbranch_scc1 Lp2_0
    s_branch Lffn_end
    .p2align 6
Lp1_f1:
    ds_read_b64_tr_b16 a[24:25], v4 offset:12288
    ds_read_b64_tr_b16 a[26:27], v4 offset:12800
    s_waitcnt lgkmcnt(10)
    v_mfma_f32_32x32x16_bf16 v[16:31], a[0:3], a[64:67], 0
    ds_read_b64_tr_b16 a[28:29], v4 offset:14336
    ds_read_b64_tr_b16 a[30:31], v4 offset:14848
    v_mfma_f32_32x32x16_bf16 v[16:31], a[4:7], a[68:71], v[16:31]
    v_cvt_pk_bf16_f32 v56, v32, v33
    v_cvt_pk_bf16_f32 v57, v34, v35
    ds_read_b64_tr_b16 a[0:1], v4 offset:16384
    ds_read_b64_tr_b16 a[2:3], v4 offset:16896
    s_waitcnt lgkmcnt(10)
    v_mfma_f32_32x32x16_bf16 v[16:31], a[8:11], a[72:75], v[16:31]
    s_add_u32 m0, s29, 34816
    v_cvt_pk_bf16_f32 v58, v36, v37
    v_cvt_pk_bf16_f32 v59, v38, v39
    ds_read_b64_tr_b16 a[4:5], v4 offset:18432
    ds_read_b64_tr_b16 a[6:7], v4 offset:18944
    v_mfma_f32_32x32x16_bf16 v[16:31], a[12:15], a[76:79], v[16:31]
    buffer_load_dwordx4 v68, s[4:7], s24 offen offset:0 lds
    ds_read_b64_tr_b16 a[8:9], v4 offset:20480
    ds_read_b64_tr_b16 a[10:11], v4 offset:20992
    s_waitcnt lgkmcnt(10)
    v_mfma_f32_32x32x16_bf16 v[16:31], a[16:19], a[80:83], v[16:31]
    v_cvt_pk_bf16_f32 v60, v40, v41
    v_cvt_pk_bf16_f32 v61, v42, v43
    v_cvt_pk_bf16_f32 v62, v44, v45
    ds_read_b64_tr_b16 a[12:13], v4 offset:22528
    ds_read_b64_tr_b16 a[14:15], v4 offset:23040
    v_mfma_f32_32x32x16_bf16 v[16:31], a[20:23], a[84:87], v[16:31]
    v_cvt_pk_bf16_f32 v63, v46, v47
    ds_read_b64_tr_b16 a[16:17], v5 offset:0
    ds_read_b64_tr_b16 a[18:19], v5 offset:512
    s_waitcnt lgkmcnt(10)
    v_mfma_f32_32x32x16_bf16 v[16:31], a[24:27], a[88:91], v[16:31]
    ds_read_b64_tr_b16 a[20:21], v5 offset:2048
    ds_read_b64_tr_b16 a[22:23], v5 offset:2560
    v_mfma_f32_32x32x16_bf16 v[16:31], a[28:31], a[92:95], v[16:31]
    buffer_load_dwordx4 v69, s[4:7], s24 offen offset:1024 lds
    ds_read_b64_tr_b16 a[24:25], v5 offset:4096
    ds_read_b64_tr_b16 a[26:27], v5 offset:4608
    s_waitcnt lgkmcnt(10)
    v_mfma_f32_32x32x16_bf16 v[16:31], a[0:3], a[96:99], v[16:31]
    s_add_u32 s24, s24, s27
    ds_read_b64_tr_b16 a[28:29], v5 offset:6144
    ds_read_b64_tr_b16 a[30:31], v5 offset:6656
    v_mfma_f32_32x32x16_bf16 v[16:31], a[4:7], a[100:103], v[16:31]
    s_waitcnt vmcnt(19)
    s_barrier
    ds_read_b64_tr_b16 a[0:1], v5 offset:8192
    ds_read_b64_tr_b16 a[2:3], v5 offset:8704
    s_waitcnt lgkmcnt(10)
    v_mfma_f32_32x32x16_bf16 v[16:31], a[8:11], a[104:107], v[16:31]
    s_add_u32 m0, s29, 55296
    ds_read_b64_tr_b16 a[4:5], v5 offset:10240
    ds_read_b64_tr_b16 a[6:7], v5 offset:10752
    v_mfma_f32_32x32x16_bf16 v[16:31], a[12:15], a[108:111], v[16:31]
    buffer_load_dwordx4 v64, s[4:7], s24 offen offset:0 lds
    ds_read_b64_tr_b16 a[8:9], v5 offset:12288
    ds_read_b64_tr_b16 a[10:11], v5 offset:12800
    s_waitcnt lgkmcnt(10)
    v_mfma_f32_32x32x16_bf16 v[32:47], a[16:19], a[64:67], 0
    ds_read_b64_tr_b16 a[12:13], v5 offset:14336
    ds_read_b64_tr_b16 a[14:15], v5 offset:14848
    v_mfma_f32_32x32x16_bf16 v[32:47], a[20:23], a[68:71], v[32:47]
    ds_read_b64_tr_b16 a[16:17], v5 offset:16384
    ds_read_b64_tr_b16 a[18:19], v5 offset:16896
    s_waitcnt lgkmcnt(10)
    v_mfma_f32_32x32x16_bf16 v[32:47], a[24:27], a[72:75], v[32:47]
    ds_read_b64_tr_b16 a[20:21], v5 offset:18432
    ds_read_b64_tr_b16 a[22:23], v5 offset:18944
    v_mfma_f32_32x32x16_bf16 v[32:47], a[28:31], a[76:79], v[32:47]
    buffer_load_dwordx4 v65, s[4:7], s24 offen offset:1024 lds
    ds_read_b64_tr_b16 a[24:25], v5 offset:20480
    ds_read_b64_tr_b16 a[26:27], v5 offset:20992
    s_waitcnt lgkmcnt(10)
    v_mfma_f32_32x32x16_bf16 v[32:47], a[0:3], a[80:83], v[32:47]
    ds_read_b64_tr_b16 a[28:29], v5 offset:22528
    ds_read_b64_tr_b16 a[30:31], v5 offset:23040
    v_mfma_f32_32x32x16_bf16 v[32:47], a[4:7], a[84:87], v[32:47]
    buffer_load_dword a63, v79, s[44:47], s52 offen
    ds_read_b64_tr_b16 a[0:1], v4 offset:24576
    ds_read_b64_tr_b16 a[2:3], v4 offset:25088
    s_waitcnt lgkmcnt(10)
    v_mfma_f32_32x32x16_bf16 v[32:47], a[8:11], a[88:91], v[32:47]
    s_add_u32 s52, s52, 1792
    s_cmp_ge_u32 s31, 2
    s_cselect_b32 s46, 0, s46
    ds_read_b64_tr_b16 a[4:5], v4 offset:26624
    ds_read_b64_tr_b16 a[6:7], v4 offset:27136
    v_mfma_f32_32x32x16_bf16 v[32:47], a[12:15], a[92:95], v[32:47]
    buffer_load_dwordx4 v66, s[4:7], s24 offen offset:2048 lds
    ds_read_b64_tr_b16 a[8:9], v4 offset:28672
    ds_read_b64_tr_b16 a[10:11], v4 offset:29184
    s_waitcnt lgkmcnt(10)
    v_mfma_f32_32x32x16_bf16 v[32:47], a[16:19], a[96:99], v[32:47]
    ds_read_b64_tr_b16 a[12:13], v4 offset:30720
    ds_read_b64_tr_b16 a[14:15], v4 offset:31232
    v_mfma_f32_32x32x16_bf16 v[32:47], a[20:23], a[100:103], v[32:47]
    ds_read_b64_tr_b16 a[16:17], v4 offset:32768
    ds_read_b64_tr_b16 a[18:19], v4 offset:33280
    s_waitcnt lgkmcnt(10)
    v_mfma_f32_32x32x16_bf16 v[32:47], a[24:27], a[104:107], v[32:47]
    ds_read_b64_tr_b16 a[20:21], v4 offset:34816
    ds_read_b64_tr_b16 a[22:23], v4 offset:35328
    v_mfma_f32_32x32x16_bf16 v[32:47], a[28:31], a[108:111], v[32:47]
    buffer_load_dwordx4 v67, s[4:7], s24 offen offset:3072 lds
    ds_read_b64_tr_b16 a[24:25], v4 offset:36864
    ds_read_b64_tr_b16 a[26:27], v4 offset:37376
    s_waitcnt lgkmcnt(10)
    v_mfma_f32_32x32x16_bf16 v[16:31], a[0:3], a[112:115], v[16:31]
    ds_read_b64_tr_b16 a[28:29], v4 offset:38912
    ds_read_b64_tr_b16 a[30:31], v4 offset:39424
    v_mfma_f32_32x32x16_bf16 v[16:31], a[4:7], a[116:119], v[16:31]
    ds_read_b64_tr_b16 a[0:1], v4 offset:40960
    ds_read_b64_tr_b16 a[2:3], v4 offset:41472
    s_waitcnt lgkmcnt(10)
    v_mfma_f32_32x32x16_bf16 v[16:31], a[8:11], a[120:123], v[16:31]
    s_set_gpr_idx_on s32, 0x8
    s_nop 0
    v_pk_max_i16 v80, v48, 0
    v_pk_max_i16 v81, v49, 0
    v_pk_max_i16 v82, v50, 0
    v_pk_max_i16 v83, v51, 0
    v_pk_max_i16 v84, v52, 0
    v_pk_max_i16 v85, v53, 0
    v_pk_max_i16 v86, v54, 0
    v_pk_max_i16 v87, v55, 0
    s_set_gpr_idx_off
    s_add_u32 m0, s29, 59392
    ds_read_b64_tr_b16 a[4:5], v4 offset:43008
    ds_read_b64_tr_b16 a[6:7], v4 offset:43520
    v_mfma_f32_32x32x16_bf16 v[16:31], a[12:15], a[124:127], v[16:31]
    buffer_load_dwordx4 v68, s[4:7], s24 offen offset:0 lds
    ds_read_b64_tr_b16 a[8:9], v4 offset:45056
    ds_read_b64_tr_b16 a[10:11], v4 offset:45568
    s_waitcnt lgkmcnt(10)
    v_mfma_f32_32x32x16_bf16 v[16:31], a[16:19], a[128:131], v[16:31]
    ds_read_b64_tr_b16 a[12:13], v4 offset:47104
    ds_read_b64_tr_b16 a[14:15], v4 offset:47616
    v_mfma_f32_32x32x16_bf16 v[16:31], a[20:23], a[132:135], v[16:31]
    ds_read_b64_tr_b16 a[16:17], v5 offset:24576
    ds_read_b64_tr_b16 a[18:19], v5 offset:25088
    s_waitcnt lgkmcnt(10)
    v_mfma_f32_32x32x16_bf16 v[16:31], a[24:27], a[136:139], v[16:31]
    ds_read_b64_tr_b16 a[20:21], v5 offset:26624
    ds_read_b64_tr_b16 a[22:23], v5 offset:27136
    v_mfma_f32_32x32x16_bf16 v[16:31], a[28:31], a[140:143], v[16:31]
    buffer_load_dwordx4 v69, s[4:7], s24 offen offset:1024 lds
    ds_read_b64_tr_b16 a[24:25], v5 offset:28672
    ds_read_b64_tr_b16 a[26:27], v5 offset:29184
    s_waitcnt lgkmcnt(10)
    v_mfma_f32_32x32x16_bf16 v[16:31], a[0:3], v[192:195], v[16:31]
    s_add_u32 s24, s24, s25
    ds_read_b64_tr_b16 a[28:29], v5 offset:30720
    ds_read_b64_tr_b16 a[30:31], v5 offset:31232
    v_mfma_f32_32x32x16_bf16 v[16:31], a[4:7], v[196:199], v[16:31]
    s_waitcnt vmcnt(19)
    s_barrier
    s_cmp_ge_u32 s31, 4
    s_cbranch_scc1 Lsw_f1
Lswr_f1:
    ds_read_b64_tr_b16 a[0:1], v5 offset:32768
    ds_read_b64_tr_b16 a[2:3], v5 offset:33280
    s_waitcnt lgkmcnt(10)
    v_mfma_f32_32x32x16_bf16 v[16:31], a[8:11], v[200:203], v[16:31]
    s_add_u32 m0, s28, 6144
    ds_read_b64_tr_b16 a[4:5], v5 offset:34816
    ds_read_b64_tr_b16 a[6:7], v5 offset:35328
    v_mfma_f32_32x32x16_bf16 v[16:31], a[12:15], v[204:207], v[16:31]
    buffer_load_dwordx4 v64, s[4:7], s24 offen offset:0 lds
    ds_read_b64_tr_b16 a[8:9], v5 offset:36864
    ds_read_b64_tr_b16 a[10:11], v5 offset:37376
    s_waitcnt lgkmcnt(10)
    v_mfma_f32_32x32x16_bf16 v[32:47], a[16:19], a[112:115], v[32:47]
    v_xor_b32 v4, v8, v4
    ds_read_b64_tr_b16 a[12:13], v5 offset:38912
    ds_read_b64_tr_b16 a[14:15], v5 offset:39424
    v_mfma_f32_32x32x16_bf16 v[32:47], a[20:23], a[116:119], v[32:47]
    ds_read_b64_tr_b16 a[16:17], v5 offset:40960
    ds_read_b64_tr_b16 a[18:19], v5 offset:41472
    s_waitcnt lgkmcnt(10)
    v_mfma_f32_32x32x16_bf16 v[32:47], a[24:27], a[120:123], v[32:47]
    ds_read_b64_tr_b16 a[20:21], v5 offset:43008
    ds_read_b64_tr_b16 a[22:23], v5 offset:43520
    v_mfma_f32_32x32x16_bf16 v[32:47], a[28:31], a[124:127], v[32:47]
    buffer_load_dwordx4 v65, s[4:7], s24 offen offset:1024 lds
    ds_read_b64_tr_b16 a[24:25], v5 offset:45056
    ds_read_b64_tr_b16 a[26:27], v5 offset:45568
    s_waitcnt lgkmcnt(10)
    v_mfma_f32_32x32x16_bf16 v[32:47], a[0:3], a[128:131], v[32:47]
    ds_read_b64_tr_b16 a[28:29], v5 offset:47104
    ds_read_b64_tr_b16 a[30:31], v5 offset:47616
    v_mfma_f32_32x32x16_bf16 v[32:47], a[4:7], a[132:135], v[32:47]
    ds_read_b64_tr_b16 a[0:1], v6 offset:0
    ds_read_b64_tr_b16 a[2:3], v6 offset:512
    s_waitcnt lgkmcnt(10)
    v_mfma_f32_32x32x16_bf16 v[32:47], a[8:11], a[136:139], v[32:47]
    v_xor_b32 v5, 73728, v5
    ds_read_b64_tr_b16 a[4:5], v6 offset:2048
    ds_read_b64_tr_b16 a[6:7], v6 offset:2560
    v_mfma_f32_32x32x16_bf16 v[32:47], a[12:15], a[140:143], v[32:47]
    buffer_load_dwordx4 v66, s[4:7], s24 offen offset:2048 lds
    ds_read_b64_tr_b16 a[8:9], v6 offset:4096
    ds_read_b64_tr_b16 a[10:11], v6 offset:4608
    s_waitcnt lgkmcnt(10)
    v_mfma_f32_32x32x16_bf16 v[32:47], a[16:19], v[192:195], v[32:47]
    ds_read_b64_tr_b16 a[12:13], v6 offset:6144
    ds_read_b64_tr_b16 a[14:15], v6 offset:6656
    v_mfma_f32_32x32x16_bf16 v[32:47], a[20:23], v[196:199], v[32:47]
    ds_read_b64_tr_b16 a[16:17], v6 offset:8192
    ds_read_b64_tr_b16 a[18:19], v6 offset:8704
    s_waitcnt lgkmcnt(10)
    v_mfma_f32_32x32x16_bf16 v[32:47], a[24:27], v[200:203], v[32:47]
    ds_read_b64_tr_b16 a[20:21], v6 offset:10240
    ds_read_b64_tr_b16 a[22:23], v6 offset:10752
    v_mfma_f32_32x32x16_bf16 v[32:47], a[28:31], v[204:207], v[32:47]
    buffer_load_dwordx4 v67, s[4:7], s24 offen offset:3072 lds
    ds_read_b64_tr_b16 a[24:25], v6 offset:12288
    ds_read_b64_tr_b16 a[26:27], v6 offset:12800
    s_waitcnt lgkmcnt(10)
    v_mfma_f32_32x32x16_bf16 v[16:31], a[0:3], v[208:211], v[16:31]
    ds_read_b64_tr_b16 a[28:29], v6 offset:14336
    ds_read_b64_tr_b16 a[30:31], v6 offset:14848
    v_mfma_f32_32x32x16_bf16 v[16:31], a[4:7], v[212:215], v[16:31]
    ds_read_b64_tr_b16 a[0:1], v6 offset:16384
    ds_read_b64_tr_b16 a[2:3], v6 offset:16896
    s_waitcnt lgkmcnt(10)
    v_mfma_f32_32x32x16_bf16 v[16:31], a[8:11], v[216:219], v[16:31]
    s_set_gpr_idx_on s32, 0x8
    s_nop 0
    v_pk_max_i16 v88, v56, 0
    v_pk_max_i16 v89, v57, 0
    v_pk_max_i16 v90, v58, 0
    v_pk_max_i16 v91, v59, 0
    v_pk_max_i16 v92, v60, 0
    v_pk_max_i16 v93, v61, 0
    v_pk_max_i16 v94, v62, 0
    v_pk_max_i16 v95, v63, 0
    s_set_gpr_idx_off
    s_add_u32 s32, s32, s33
    s_mov_b32 s33, 16
    s_add_u32 m0, s28, 10240
    ds_read_b64_tr_b16 a[4:5], v6 offset:18432
    ds_read_b64_tr_b16 a[6:7], v6 offset:18944
    v_mfma_f32_32x32x16_bf16 v[16:31], a[12:15], v[220:223], v[16:31]
    buffer_load_dwordx4 v68, s[4:7], s24 offen offset:0 lds
    ds_read_b64_tr_b16 a[8:9], v6 offset:20480
    ds_read_b64_tr_b16 a[10:11], v6 offset:20992
    s_waitcnt lgkmcnt(10)
    v_mfma_f32_32x32x16_bf16 v[16:31], a[16:19], v[224:227], v[16:31]
    ds_read_b64_tr_b16 a[12:13], v6 offset:22528
    ds_read_b64_tr_b16 a[14:15], v6 offset:23040
    v_mfma_f32_32x32x16_bf16 v[16:31], a[20:23], v[228:231], v[16:31]
    ds_read_b64_tr_b16 a[16:17], v7 offset:0
    ds_read_b64_tr_b16 a[18:19], v7 offset:512
    s_waitcnt lgkmcnt(10)
    v_mfma_f32_32x32x16_bf16 v[16:31], a[24:27], v[232:235], v[16:31]
    v_xor_b32 v6, 73728, v6
    ds_read_b64_tr_b16 a[20:21], v7 offset:2048
    ds_read_b64_tr_b16 a[22:23], v7 offset:2560
    v_mfma_f32_32x32x16_bf16 v[16:31], a[28:31], v[236:239], v[16:31]
    buffer_load_dwordx4 v69, s[4:7], s24 offen offset:1024 lds
    ds_read_b64_tr_b16 a[24:25], v7 offset:4096
    ds_read_b64_tr_b16 a[26:27], v7 offset:4608
    s_waitcnt lgkmcnt(10)
    v_mfma_f32_32x32x16_bf16 v[16:31], a[0:3], v[240:243], v[16:31]
    s_add_u32 s24, s24, s26
    ds_read_b64_tr_b16 a[28:29], v7 offset:6144
    ds_read_b64_tr_b16 a[30:31], v7 offset:6656
    v_mfma_f32_32x32x16_bf16 v[16:31], a[4:7], v[244:247], v[16:31]
    s_waitcnt vmcnt(19)
    s_barrier
    ds_read_b64_tr_b16 a[0:1], v7 offset:8192
    ds_read_b64_tr_b16 a[2:3], v7 offset:8704
    s_waitcnt lgkmcnt(10)
    v_mfma_f32_32x32x16_bf16 v[16:31], a[8:11], v[248:251], v[16:31]
    s_add_u32 m0, s28, 30720
    ds_read_b64_tr_b16 a[4:5], v7 offset:10240
    ds_read_b64_tr_b16 a[6:7], v7 offset:10752
    v_mfma_f32_32x32x16_bf16 v[16:31], a[12:15], v[252:255], v[16:31]
    buffer_load_dwordx4 v64, s[4:7], s24 offen offset:0 lds
    ds_read_b64_tr_b16 a[8:9], v7 offset:12288
    ds_read_b64_tr_b16 a[10:11], v7 offset:12800
    s_waitcnt lgkmcnt(10)
    v_mfma_f32_32x32x16_bf16 v[32:47], a[16:19], v[208:211], v[32:47]
    ds_read_b64_tr_b16 a[12:13], v7 offset:14336
    ds_read_b64_tr_b16 a[14:15], v7 offset:14848
    v_mfma_f32_32x32x16_bf16 v[32:47], a[20:23], v[212:215], v[32:47]
    v_cvt_pk_bf16_f32 v48, v16, v17
    v_cvt_pk_bf16_f32 v49, v18, v19
    ds_read_b64_tr_b16 a[16:17], v7 offset:16384
    ds_read_b64_tr_b16 a[18:19], v7 offset:16896
    s_waitcnt lgkmcnt(10)
    v_mfma_f32_32x32x16_bf16 v[32:47], a[24:27], v[216:219], v[32:47]
    v_cvt_pk_bf16_f32 v50, v20, v21
    v_cvt_pk_bf16_f32 v51, v22, v23
    v_cvt_pk_bf16_f32 v52, v24, v25
    ds_read_b64_tr_b16 a[20:21], v7 offset:18432
    ds_read_b64_tr_b16 a[22:23], v7 offset:18944
    v_mfma_f32_32x32x16_bf16 v[32:47], a[28:31], v[220:223], v[32:47]
    buffer_load_dwordx4 v65, s[4:7], s24 offen offset:1024 lds
    ds_read_b64_tr_b16 a[24:25], v7 offset:20480
    ds_read_b64_tr_b16 a[26:27], v7 offset:20992
    s_waitcnt lgkmcnt(10)
    v_mfma_f32_32x32x16_bf16 v[32:47], a[0:3], v[224:227], v[32:47]
    v_cvt_pk_bf16_f32 v53, v26, v27
    v_cvt_pk_bf16_f32 v54, v28, v29
    v_cvt_pk_bf16_f32 v55, v30, v31
    ds_read_b64_tr_b16 a[28:29], v7 offset:22528
    ds_read_b64_tr_b16 a[30:31], v7 offset:23040
    v_mfma_f32_32x32x16_bf16 v[32:47], a[4:7], v[228:231], v[32:47]
    ds_read_b64_tr_b16 a[0:1], v4 offset:0
    ds_read_b64_tr_b16 a[2:3], v4 offset:512
    s_waitcnt lgkmcnt(10)
    v_mfma_f32_32x32x16_bf16 v[32:47], a[8:11], v[232:235], v[32:47]
    v_xor_b32 v7, 73728, v7
    ds_read_b64_tr_b16 a[4:5], v4 offset:2048
    ds_read_b64_tr_b16 a[6:7], v4 offset:2560
    v_mfma_f32_32x32x16_bf16 v[32:47], a[12:15], v[236:239], v[32:47]
    buffer_load_dwordx4 v66, s[4:7], s24 offen offset:2048 lds
    ds_read_b64_tr_b16 a[8:9], v4 offset:4096
    ds_read_b64_tr_b16 a[10:11], v4 offset:4608
    s_waitcnt lgkmcnt(10)
    v_mfma_f32_32x32x16_bf16 v[32:47], a[16:19], v[240:243], v[32:47]
    ds_read_b64_tr_b16 a[12:13], v4 offset:6144
    ds_read_b64_tr_b16 a[14:15], v4 offset:6656
    v_mfma_f32_32x32x16_bf16 v[32:47], a[20:23], v[244:247], v[32:47]
    ds_read_b64_tr_b16 a[16:17], v4 offset:8192
    ds_read_b64_tr_b16 a[18:19], v4 offset:8704
    s_waitcnt lgkmcnt(10)
    v_mfma_f32_32x32x16_bf16 v[32:47], a[24:27], v[248:251], v[32:47]
    ds_read_b64_tr_b16 a[20:21], v4 offset:10240
    ds_read_b64_tr_b16 a[22:23], v4 offset:10752
    v_mfma_f32_32x32x16_bf16 v[32:47], a[28:31], v[252:255], v[32:47]
    buffer_load_dwordx4 v67, s[4:7], s24 offen offset:3072 lds
    s_xor_b32 s28, s28, 73728
    s_xor_b32 s29, s29, 73728
    s_add_u32 s31, s31, 1
    s_cmp_lt_u32 s31, 6
    s_cbranch_scc1 Lp1_f1
    s_mov_b32 s56, 0x40000000
    v_pk_max_i16 v160, v48, 0
    v_pk_max_i16 v161, v49, 0
    v_pk_max_i16 v162, v50, 0
    v_pk_max_i16 v163, v51, 0
    v_pk_max_i16 v164, v52, 0
    v_pk_max_i16 v165, v53, 0
    v_pk_max_i16 v166, v54, 0
    v_pk_max_i16 v167, v55, 0
    buffer_store_dwordx4 v[48:51], v11, s[12:15], s56 offen
    buffer_store_dwordx4 v[48:51], v11, s[12:15], s56 offen
    buffer_store_dwordx4 v[48:51], v11, s[12:15], s56 offen
    buffer_store_dwordx4 v[48:51], v11, s[12:15], s56 offen
    v_xor_b32 v6, 64, v14
    v_xor_b32 v5, 64, v14
    s_mov_b32 s31, 0
    s_mov_b32 s30, 0
    s_mov_b32 s28, 0
    s_mov_b32 s29, 98304
    s_nop 3
    v_cvt_pk_bf16_f32 v56, v32, v33
    v_cvt_pk_bf16_f32 v57, v34, v35
    v_cvt_pk_bf16_f32 v58, v36, v37
    v_cvt_pk_bf16_f32 v59, v38, v39
    v_cvt_pk_bf16_f32 v60, v40, v41
    v_cvt_pk_bf16_f32 v61, v42, v43
    v_cvt_pk_bf16_f32 v62, v44, v45
    v_cvt_pk_bf16_f32 v63, v46, v47
    v_pk_max_i16 v168, v56, 0
    v_pk_max_i16 v169, v57, 0
    v_pk_max_i16 v170, v58, 0
    v_pk_max_i16 v171, v59, 0
    v_pk_max_i16 v172, v60, 0
    v_pk_max_i16 v173, v61, 0
    v_pk_max_i16 v174, v62, 0
    v_pk_max_i16 v175, v63, 0
    .p2align 6
Lp2_1:
    ds_read_b64_tr_b16 a[24:25], v4 offset:12288
    ds_read_b64_tr_b16 a[26:27], v4 offset:12800
    s_waitcnt lgkmcnt(10)
    v_mfma_f32_32x32x16_bf16 v[16:31], a[0:3], v[80:83], 0
    ds_read_b64_tr_b16 a[28:29], v4 offset:14336
    ds_read_b64_tr_b16 a[30:31], v4 offset:14848
    v_mfma_f32_32x32x16_bf16 v[16:31], a[4:7], v[84:87], v[16:31]
    v_cvt_pk_bf16_f32 v56, v32, v33
    v_cvt_pk_bf16_f32 v57, v34, v35
    ds_read_b64_tr_b16 a[0:1], v4 offset:16384
    ds_read_b64_tr_b16 a[2:3], v4 offset:16896
    s_waitcnt lgkmcnt(10)
    v_mfma_f32_32x32x16_bf16 v[16:31], a[8:11], v[88:91], v[16:31]
    s_add_u32 m0, s29, 10240
    v_cvt_pk_bf16_f32 v58, v36, v37
    v_cvt_pk_bf16_f32 v59, v38, v39
    ds_read_b64_tr_b16 a[4:5], v4 offset:18432
    ds_read_b64_tr_b16 a[6:7], v4 offset:18944
    v_mfma_f32_32x32x16_bf16 v[16:31], a[12:15], v[92:95], v[16:31]
    buffer_load_dwordx4 v68, s[4:7], s24 offen offset:0 lds
    ds_read_b64_tr_b16 a[8:9], v4 offset:20480
    ds_read_b64_tr_b16 a[10:11], v4 offset:20992
    s_waitcnt lgkmcnt(10)
    v_mfma_f32_32x32x16_bf16 v[16:31], a[16:19], v[96:99], v[16:31]
    v_cvt_pk_bf16_f32 v60, v40, v41
    v_cvt_pk_bf16_f32 v61, v42, v43
    v_cvt_pk_bf16_f32 v62, v44, v45
    ds_read_b64_tr_b16 a[12:13], v4 offset:22528
    ds_read_b64_tr_b16 a[14:15], v4 offset:23040
    v_mfma_f32_32x32x16_bf16 v[16:31], a[20:23], v[100:103], v[16:31]
    buffer_store_dwordx4 v[48:51], v11, s[12:15], s56 offen offset:0 sc0 sc1
    ds_read_b64_tr_b16 a[16:17], v5 offset:0
    ds_read_b64_tr_b16 a[18:19], v5 offset:512
    s_waitcnt lgkmcnt(10)
    v_mfma_f32_32x32x16_bf16 v[16:31], a[24:27], v[104:107], v[16:31]
    v_cvt_pk_bf16_f32 v63, v46, v47
    ds_read_b64_tr_b16 a[20:21], v5 offset:2048
    ds_read_b64_tr_b16 a[22:23], v5 offset:2560
    v_mfma_f32_32x32x16_bf16 v[16:31], a[28:31], v[108:111], v[16:31]
    buffer_load_dwordx4 v69, s[4:7], s24 offen offset:1024 lds
    ds_read_b64_tr_b16 a[24:25], v5 offset:4096
    ds_read_b64_tr_b16 a[26:27], v5 offset:4608
    s_waitcnt lgkmcnt(10)
    v_mfma_f32_32x32x16_bf16 v[16:31], a[0:3], v[112:115], v[16:31]
    s_add_u32 s24, s24, 221184
    ds_read_b64_tr_b16 a[28:29], v5 offset:6144
    ds_read_b64_tr_b16 a[30:31], v5 offset:6656
    v_mfma_f32_32x32x16_bf16 v[16:31], a[4:7], v[116:119], v[16:31]
    buffer_store_dwordx4 v[52:55], v11, s[12:15], s56 offen offset:1024 sc0 sc1
    s_waitcnt vmcnt(24)
    s_barrier
    ds_read_b64_tr_b16 a[0:1], v5 offset:8192
    ds_read_b64_tr_b16 a[2:3], v5 offset:8704
    s_waitcnt lgkmcnt(10)
    v_mfma_f32_32x32x16_bf16 v[16:31], a[8:11], v[120:123], v[16:31]
    s_add_u32 m0, s29, 30720
    ds_read_b64_tr_b16 a[4:5], v5 offset:10240
    ds_read_b64_tr_b16 a[6:7], v5 offset:10752
    v_mfma_f32_32x32x16_bf16 v[16:31], a[12:15], v[124:127], v[16:31]
    buffer_load_dwordx4 v64, s[4:7], s24 offen offset:0 lds
    ds_read_b64_tr_b16 a[8:9], v5 offset:12288
    ds_read_b64_tr_b16 a[10:11], v5 offset:12800
    s_waitcnt lgkmcnt(10)
    v_mfma_f32_32x32x16_bf16 v[32:47], a[16:19], v[80:83], 0
    ds_read_b64_tr_b16 a[12:13], v5 offset:14336
    ds_read_b64_tr_b16 a[14:15], v5 offset:14848
    v_mfma_f32_32x32x16_bf16 v[32:47], a[20:23], v[84:87], v[32:47]
    ds_read_b64_tr_b16 a[16:17], v5 offset:16384
    ds_read_b64_tr_b16 a[18:19], v5 offset:16896
    s_waitcnt lgkmcnt(10)
    v_mfma_f32_32x32x16_bf16 v[32:47], a[24:27], v[88:91], v[32:47]
    ds_read_b64_tr_b16 a[20:21], v5 offset:18432
    ds_read_b64_tr_b16 a[22:23], v5 offset:18944
    v_mfma_f32_32x32x16_bf16 v[32:47], a[28:31], v[92:95], v[32:47]
    buffer_load_dwordx4 v65, s[4:7], s24 offen offset:1024 lds
    ds_read_b64_tr_b16 a[24:25], v5 offset:20480
    ds_read_b64_tr_b16 a[26:27], v5 offset:20992
    s_waitcnt lgkmcnt(10)
    v_mfma_f32_32x32x16_bf16 v[32:47], a[0:3], v[96:99], v[32:47]
    ds_read_b64_tr_b16 a[28:29], v5 offset:22528
    ds_read_b64_tr_b16 a[30:31], v5 offset:23040
    v_mfma_f32_32x32x16_bf16 v[32:47], a[4:7], v[100:103], v[32:47]
    buffer_store_dwordx4 v[56:59], v11, s[12:15], s56 offen offset:2048 sc0 sc1
    ds_read_b64_tr_b16 a[0:1], v4 offset:24576
    ds_read_b64_tr_b16 a[2:3], v4 offset:25088
    s_waitcnt lgkmcnt(10)
    v_mfma_f32_32x32x16_bf16 v[32:47], a[8:11], v[104:107], v[32:47]
    ds_read_b64_tr_b16 a[4:5], v4 offset:26624
    ds_read_b64_tr_b16 a[6:7], v4 offset:27136
    v_mfma_f32_32x32x16_bf16 v[32:47], a[12:15], v[108:111], v[32:47]
    buffer_load_dwordx4 v66, s[4:7], s24 offen offset:2048 lds
    ds_read_b64_tr_b16 a[8:9], v4 offset:28672
    ds_read_b64_tr_b16 a[10:11], v4 offset:29184
    s_waitcnt lgkmcnt(10)
    v_mfma_f32_32x32x16_bf16 v[32:47], a[16:19], v[112:115], v[32:47]
    ds_read_b64_tr_b16 a[12:13], v4 offset:30720
    ds_read_b64_tr_b16 a[14:15], v4 offset:31232
    v_mfma_f32_32x32x16_bf16 v[32:47], a[20:23], v[116:119], v[32:47]
    buffer_store_dwordx4 v[60:63], v11, s[12:15], s56 offen offset:3072 sc0 sc1
    ds_read_b64_tr_b16 a[16:17], v4 offset:32768
    ds_read_b64_tr_b16 a[18:19], v4 offset:33280
    s_waitcnt lgkmcnt(10)
    v_mfma_f32_32x32x16_bf16 v[32:47], a[24:27], v[120:123], v[32:47]
    ds_read_b64_tr_b16 a[20:21], v4 offset:34816
    ds_read_b64_tr_b16 a[22:23], v4 offset:35328
    v_mfma_f32_32x32x16_bf16 v[32:47], a[28:31], v[124:127], v[32:47]
    buffer_load_dwordx4 v67, s[4:7], s24 offen offset:3072 lds
    ds_read_b64_tr_b16 a[24:25], v4 offset:36864
    ds_read_b64_tr_b16 a[26:27], v4 offset:37376
    s_waitcnt lgkmcnt(10)
    v_mfma_f32_32x32x16_bf16 v[16:31], a[0:3], v[128:131], v[16:31]
    s_add_u32 s30, s30, 49152
    s_cmp_eq_u32 s30, 147456
    s_cselect_b32 s30, 0, s30
    ds_read_b64_tr_b16 a[28:29], v4 offset:38912
    ds_read_b64_tr_b16 a[30:31], v4 offset:39424
    v_mfma_f32_32x32x16_bf16 v[16:31], a[4:7], v[132:135], v[16:31]
    s_mov_b32 s56, s58
    s_add_u32 s58, s58, 4096
    ds_read_b64_tr_b16 a[0:1], v4 offset:40960
    ds_read_b64_tr_b16 a[2:3], v4 offset:41472
    s_waitcnt lgkmcnt(10)
    v_mfma_f32_32x32x16_bf16 v[16:31], a[8:11], v[136:139], v[16:31]
    s_add_u32 m0, s29, 34816
    ds_read_b64_tr_b16 a[4:5], v4 offset:43008
    ds_read_b64_tr_b16 a[6:7], v4 offset:43520
    v_mfma_f32_32x32x16_bf16 v[16:31], a[12:15], v[140:143], v[16:31]
    buffer_load_dwordx4 v68, s[4:7], s24 offen offset:0 lds
    ds_read_b64_tr_b16 a[8:9], v4 offset:45056
    ds_read_b64_tr_b16 a[10:11], v4 offset:45568
    s_waitcnt lgkmcnt(10)
    v_mfma_f32_32x32x16_bf16 v[16:31], a[16:19], v[144:147], v[16:31]
    ds_read_b64_tr_b16 a[12:13], v4 offset:47104
    ds_read_b64_tr_b16 a[14:15], v4 offset:47616
    v_mfma_f32_32x32x16_bf16 v[16:31], a[20:23], v[148:151], v[16:31]
    ds_read_b64_tr_b16 a[16:17], v5 offset:24576
    ds_read_b64_tr_b16 a[18:19], v5 offset:25088
    s_waitcnt lgkmcnt(10)
    v_mfma_f32_32x32x16_bf16 v[16:31], a[24:27], v[152:155], v[16:31]
    ds_read_b64_tr_b16 a[20:21], v5 offset:26624
    ds_read_b64_tr_b16 a[22:23], v5 offset:27136
    v_mfma_f32_32x32x16_bf16 v[16:31], a[28:31], v[156:159], v[16:31]
    buffer_load_dwordx4 v69, s[4:7], s24 offen offset:1024 lds
    ds_read_b64_tr_b16 a[24:25], v5 offset:28672
    ds_read_b64_tr_b16 a[26:27], v5 offset:29184
    s_waitcnt lgkmcnt(10)
    v_mfma_f32_32x32x16_bf16 v[16:31], a[0:3], v[160:163], v[16:31]
    s_add_u32 s24, s24, 4294746240
    ds_read_b64_tr_b16 a[28:29], v5 offset:30720
    ds_read_b64_tr_b16 a[30:31], v5 offset:31232
    v_mfma_f32_32x32x16_bf16 v[16:31], a[4:7], v[164:167], v[16:31]
    s_cmp_ge_u32 s31, 6
    s_cselect_b32 s6, 0, s6
    s_waitcnt vmcnt(25)
    s_barrier
    ds_read_b64_tr_b16 a[0:1], v5 offset:32768
    ds_read_b64_tr_b16 a[2:3], v5 offset:33280
    s_waitcnt lgkmcnt(10)
    v_mfma_f32_32x32x16_bf16 v[16:31], a[8:11], v[168:171], v[16:31]
    s_add_u32 m0, s28, 6144
    ds_read_b64_tr_b16 a[4:5], v5 offset:34816
    ds_read_b64_tr_b16 a[6:7], v5 offset:35328
    v_mfma_f32_32x32x16_bf16 v[16:31], a[12:15], v[172:175], v[16:31]
    buffer_load_dwordx4 v64, s[4:7], s24 offen offset:0 lds
    ds_read_b64_tr_b16 a[8:9], v5 offset:36864
    ds_read_b64_tr_b16 a[10:11], v5 offset:37376
    s_waitcnt lgkmcnt(10)
    v_mfma_f32_32x32x16_bf16 v[32:47], a[16:19], v[128:131], v[32:47]
    v_add_u32 v4, s30, v14
    ds_read_b64_tr_b16 a[12:13], v5 offset:38912
    ds_read_b64_tr_b16 a[14:15], v5 offset:39424
    v_mfma_f32_32x32x16_bf16 v[32:47], a[20:23], v[132:135], v[32:47]
    v_cvt_pk_bf16_f32 v48, v16, v17
    v_cvt_pk_bf16_f32 v49, v18, v19
    ds_read_b64_tr_b16 a[16:17], v5 offset:40960
    ds_read_b64_tr_b16 a[18:19], v5 offset:41472
    s_waitcnt lgkmcnt(10)
    v_mfma_f32_32x32x16_bf16 v[32:47], a[24:27], v[136:139], v[32:47]
    v_cvt_pk_bf16_f32 v50, v20, v21
    v_cvt_pk_bf16_f32 v51, v22, v23
    v_cvt_pk_bf16_f32 v52, v24, v25
    ds_read_b64_tr_b16 a[20:21], v5 offset:43008
    ds_read_b64_tr_b16 a[22:23], v5 offset:43520
    v_mfma_f32_32x32x16_bf16 v[32:47], a[28:31], v[140:143], v[32:47]
    buffer_load_dwordx4 v65, s[4:7], s24 offen offset:1024 lds
    ds_read_b64_tr_b16 a[24:25], v5 offset:45056
    ds_read_b64_tr_b16 a[26:27], v5 offset:45568
    s_waitcnt lgkmcnt(10)
    v_mfma_f32_32x32x16_bf16 v[32:47], a[0:3], v[144:147], v[32:47]
    v_cvt_pk_bf16_f32 v53, v26, v27
    v_cvt_pk_bf16_f32 v54, v28, v29
    v_cvt_pk_bf16_f32 v55, v30, v31
    ds_read_b64_tr_b16 a[28:29], v5 offset:47104
    ds_read_b64_tr_b16 a[30:31], v5 offset:47616
    v_mfma_f32_32x32x16_bf16 v[32:47], a[4:7], v[148:151], v[32:47]
    ds_read_b64_tr_b16 a[0:1], v4 offset:0
    ds_read_b64_tr_b16 a[2:3], v4 offset:512
    s_waitcnt lgkmcnt(10)
    v_mfma_f32_32x32x16_bf16 v[32:47], a[8:11], v[152:155], v[32:47]
    v_add_u32 v5, s30, v6
    ds_read_b64_tr_b16 a[4:5], v4 offset:2048
    ds_read_b64_tr_b16 a[6:7], v4 offset:2560
    v_mfma_f32_32x32x16_bf16 v[32:47], a[12:15], v[156:159], v[32:47]
    buffer_load_dwordx4 v66, s[4:7], s24 offen offset:2048 lds
    ds_read_b64_tr_b16 a[8:9], v4 offset:4096
    ds_read_b64_tr_b16 a[10:11], v4 offset:4608
    s_waitcnt lgkmcnt(10)
    v_mfma_f32_32x32x16_bf16 v[32:47], a[16:19], v[160:163], v[32:47]
    ds_read_b64_tr_b16 a[12:13], v4 offset:6144
    ds_read_b64_tr_b16 a[14:15], v4 offset:6656
    v_mfma_f32_32x32x16_bf16 v[32:47], a[20:23], v[164:167], v[32:47]
    ds_read_b64_tr_b16 a[16:17], v4 offset:8192
    ds_read_b64_tr_b16 a[18:19], v4 offset:8704
    s_waitcnt lgkmcnt(10)
    v_mfma_f32_32x32x16_bf16 v[32:47], a[24:27], v[168:171], v[32:47]
    ds_read_b64_tr_b16 a[20:21], v4 offset:10240
    ds_read_b64_tr_b16 a[22:23], v4 offset:10752
    v_mfma_f32_32x32x16_bf16 v[32:47], a[28:31], v[172:175], v[32:47]
    buffer_load_dwordx4 v67, s[4:7], s24 offen offset:3072 lds
    s_mov_b32 s29, s28
    s_mov_b32 s28, s30
    s_add_u32 s31, s31, 1
    s_cmp_lt_u32 s31, 9
    s_cbranch_scc1 Lp2_1
    s_branch Lffn_end
    .p2align 6
Lp1_f2:
    ds_read_b64_tr_b16 a[24:25], v4 offset:12288
    ds_read_b64_tr_b16 a[26:27], v4 offset:12800
    s_waitcnt lgkmcnt(10)
    v_mfma_f32_32x32x16_bf16 v[16:31], a[0:3], a[64:67], 0
    buffer_load_dwordx4 v67, s[4:7], s24 offen offset:3072 lds
    ds_read_b64_tr_b16 a[28:29], v4 offset:14336
    ds_read_b64_tr_b16 a[30:31], v4 offset:14848
    v_mfma_f32_32x32x16_bf16 v[16:31], a[4:7], a[68:71], v[16:31]
    v_cvt_pk_bf16_f32 v56, v32, v33
    v_cvt_pk_bf16_f32 v57, v34, v35
    ds_read_b64_tr_b16 a[0:1], v4 offset:16384
    ds_read_b64_tr_b16 a[2:3], v4 offset:16896
    s_waitcnt lgkmcnt(10)
    v_mfma_f32_32x32x16_bf16 v[16:31], a[8:11], a[72:75], v[16:31]
    v_cvt_pk_bf16_f32 v58, v36, v37
    v_cvt_pk_bf16_f32 v59, v38, v39
    v_cvt_pk_bf16_f32 v60, v40, v41
    ds_read_b64_tr_b16 a[4:5], v4 offset:18432
    ds_read_b64_tr_b16 a[6:7], v4 offset:18944
    v_mfma_f32_32x32x16_bf16 v[16:31], a[12:15], a[76:79], v[16:31]
    s_add_u32 m0, s29, 40960
    v_cvt_pk_bf16_f32 v61, v42, v43
    ds_read_b64_tr_b16 a[8:9], v4 offset:20480
    ds_read_b64_tr_b16 a[10:11], v4 offset:20992
    s_waitcnt lgkmcnt(10)
    v_mfma_f32_32x32x16_bf16 v[16:31], a[16:19], a[80:83], v[16:31]
    buffer_load_dwordx4 v68, s[4:7], s24 offen offset:0 lds
    ds_read_b64_tr_b16 a[12:13], v4 offset:22528
    ds_read_b64_tr_b16 a[14:15], v4 offset:23040
    v_mfma_f32_32x32x16_bf16 v[16:31], a[20:23], a[84:87], v[16:31]
    v_cvt_pk_bf16_f32 v62, v44, v45
    v_cvt_pk_bf16_f32 v63, v46, v47
    ds_read_b64_tr_b16 a[16:17], v5 offset:0
    ds_read_b64_tr_b16 a[18:19], v5 offset:512
    s_waitcnt lgkmcnt(10)
    v_mfma_f32_32x32x16_bf16 v[16:31], a[24:27], a[88:91], v[16:31]
    ds_read_b64_tr_b16 a[20:21], v5 offset:2048
    ds_read_b64_tr_b16 a[22:23], v5 offset:2560
    v_mfma_f32_32x32x16_bf16 v[16:31], a[28:31], a[92:95], v[16:31]
    ds_read_b64_tr_b16 a[24:25], v5 offset:4096
    ds_read_b64_tr_b16 a[26:27], v5 offset:4608
    s_waitcnt lgkmcnt(10)
    v_mfma_f32_32x32x16_bf16 v[16:31], a[0:3], a[96:99], v[16:31]
    buffer_load_dwordx4 v69, s[4:7], s24 offen offset:1024 lds
    ds_read_b64_tr_b16 a[28:29], v5 offset:6144
    ds_read_b64_tr_b16 a[30:31], v5 offset:6656
    v_mfma_f32_32x32x16_bf16 v[16:31], a[4:7], a[100:103], v[16:31]
    s_add_u32 s24, s24, s27
    s_waitcnt vmcnt(19)
    s_barrier
    ds_read_b64_tr_b16 a[0:1], v5 offset:8192
    ds_read_b64_tr_b16 a[2:3], v5 offset:8704
    s_waitcnt lgkmcnt(10)
    v_mfma_f32_32x32x16_bf16 v[16:31], a[8:11], a[104:107], v[16:31]
    ds_read_b64_tr_b16 a[4:5], v5 offset:10240
    ds_read_b64_tr_b16 a[6:7], v5 offset:10752
    v_mfma_f32_32x32x16_bf16 v[16:31], a[12:15], a[108:111], v[16:31]
    s_add_u32 m0, s29, 61440
    ds_read_b64_tr_b16 a[8:9], v5 offset:12288
    ds_read_b64_tr_b16 a[10:11], v5 offset:12800
    s_waitcnt lgkmcnt(10)
    v_mfma_f32_32x32x16_bf16 v[32:47], a[16:19], a[64:67], 0
    buffer_load_dwordx4 v64, s[4:7], s24 offen offset:0 lds
    ds_read_b64_tr_b16 a[12:13], v5 offset:14336
    ds_read_b64_tr_b16 a[14:15], v5 offset:14848
    v_mfma_f32_32x32x16_bf16 v[32:47], a[20:23], a[68:71], v[32:47]
    ds_read_b64_tr_b16 a[16:17], v5 offset:16384
    ds_read_b64_tr_b16 a[18:19], v5 offset:16896
    s_waitcnt lgkmcnt(10)
    v_mfma_f32_32x32x16_bf16 v[32:47], a[24:27], a[72:75], v[32:47]
    buffer_load_dword a63, v79, s[44:47], s52 offen
    ds_read_b64_tr_b16 a[20:21], v5 offset:18432
    ds_read_b64_tr_b16 a[22:23], v5 offset:18944
    v_mfma_f32_32x32x16_bf16 v[32:47], a[28:31], a[76:79], v[32:47]
    s_add_u32 s52, s52, 1792
    ds_read_b64_tr_b16 a[24:25], v5 offset:20480
    ds_read_b64_tr_b16 a[26:27], v5 offset:20992
    s_waitcnt lgkmcnt(10)
    v_mfma_f32_32x32x16_bf16 v[32:47], a[0:3], a[80:83], v[32:47]
    buffer_load_dwordx4 v65, s[4:7], s24 offen offset:1024 lds
    ds_read_b64_tr_b16 a[28:29], v5 offset:22528
    ds_read_b64_tr_b16 a[30:31], v5 offset:23040
    v_mfma_f32_32x32x16_bf16 v[32:47], a[4:7], a[84:87], v[32:47]
    s_cmp_ge_u32 s31, 2
    s_cselect_b32 s46, 0, s46
    ds_read_b64_tr_b16 a[0:1], v4 offset:24576
    ds_read_b64_tr_b16 a[2:3], v4 offset:25088
    s_waitcnt lgkmcnt(10)
    v_mfma_f32_32x32x16_bf16 v[32:47], a[8:11], a[88:91], v[32:47]
    ds_read_b64_tr_b16 a[4:5], v4 offset:26624
    ds_read_b64_tr_b16 a[6:7], v4 offset:27136
    v_mfma_f32_32x32x16_bf16 v[32:47], a[12:15], a[92:95], v[32:47]
    ds_read_b64_tr_b16 a[8:9], v4 offset:28672
    ds_read_b64_tr_b16 a[10:11], v4 offset:29184
    s_waitcnt lgkmcnt(10)
    v_mfma_f32_32x32x16_bf16 v[32:47], a[16:19], a[96:99], v[32:47]
    buffer_load_dwordx4 v66, s[4:7], s24 offen offset:2048 lds
    ds_read_b64_tr_b16 a[12:13], v4 offset:30720
    ds_read_b64_tr_b16 a[14:15], v4 offset:31232
    v_mfma_f32_32x32x16_bf16 v[32:47], a[20:23], a[100:103], v[32:47]
    ds_read_b64_tr_b16 a[16:17], v4 offset:32768
    ds_read_b64_tr_b16 a[18:19], v4 offset:33280
    s_waitcnt lgkmcnt(10)
    v_mfma_f32_32x32x16_bf16 v[32:47], a[24:27], a[104:107], v[32:47]
    ds_read_b64_tr_b16 a[20:21], v4 offset:34816
    ds_read_b64_tr_b16 a[22:23], v4 offset:35328
    v_mfma_f32_32x32x16_bf16 v[32:47], a[28:31], a[108:111], v[32:47]
    ds_read_b64_tr_b16 a[24:25], v4 offset:36864
    ds_read_b64_tr_b16 a[26:27], v4 offset:37376
    s_waitcnt lgkmcnt(10)
    v_mfma_f32_32x32x16_bf16 v[16:31], a[0:3], a[112:115], v[16:31]
    buffer_load_dwordx4 v67, s[4:7], s24 offen offset:3072 lds
    ds_read_b64_tr_b16 a[28:29], v4 offset:38912
    ds_read_b64_tr_b16 a[30:31], v4 offset:39424
    v_mfma_f32_32x32x16_bf16 v[16:31], a[4:7], a[116:119], v[16:31]
    ds_read_b64_tr_b16 a[0:1], v4 offset:40960
    ds_read_b64_tr_b16 a[2:3], v4 offset:41472
    s_waitcnt lgkmcnt(10)
    v_mfma_f32_32x32x16_bf16 v[16:31], a[8:11], a[120:123], v[16:31]
    ds_read_b64_tr_b16 a[4:5], v4 offset:43008
    ds_read_b64_tr_b16 a[6:7], v4 offset:43520
    v_mfma_f32_32x32x16_bf16 v[16:31], a[12:15], a[124:127], v[16:31]
    s_set_gpr_idx_on s32, 0x8
    s_nop 0
    v_pk_max_i16 v80, v48, 0
    v_pk_max_i16 v81, v49, 0
    v_pk_max_i16 v82, v50, 0
    v_pk_max_i16 v83, v51, 0
    v_pk_max_i16 v84, v52, 0
    v_pk_max_i16 v85, v53, 0
    v_pk_max_i16 v86, v54, 0
    v_pk_max_i16 v87, v55, 0
    s_set_gpr_idx_off
    s_add_u32 m0, s29, 65536
    ds_read_b64_tr_b16 a[8:9], v4 offset:45056
    ds_read_b64_tr_b16 a[10:11], v4 offset:45568
    s_waitcnt lgkmcnt(10)
    v_mfma_f32_32x32x16_bf16 v[16:31], a[16:19], a[128:131], v[16:31]
    buffer_load_dwordx4 v68, s[4:7], s24 offen offset:0 lds
    ds_read_b64_tr_b16 a[12:13], v4 offset:47104
    ds_read_b64_tr_b16 a[14:15], v4 offset:47616
    v_mfma_f32_32x32x16_bf16 v[16:31], a[20:23], a[132:135], v[16:31]
    ds_read_b64_tr_b16 a[16:17], v5 offset:24576
    ds_read_b64_tr_b16 a[18:19], v5 offset:25088
    s_waitcnt lgkmcnt(10)
    v_mfma_f32_32x32x16_bf16 v[16:31], a[24:27], a[136:139], v[16:31]
    ds_read_b64_tr_b16 a[20:21], v5 offset:26624
    ds_read_b64_tr_b16 a[22:23], v5 offset:27136
    v_mfma_f32_32x32x16_bf16 v[16:31], a[28:31], a[140:143], v[16:31]
    ds_read_b64_tr_b16 a[24:25], v5 offset:28672
    ds_read_b64_tr_b16 a[26:27], v5 offset:29184
    s_waitcnt lgkmcnt(10)
    v_mfma_f32_32x32x16_bf16 v[16:31], a[0:3], v[192:195], v[16:31]
    buffer_load_dwordx4 v69, s[4:7], s24 offen offset:1024 lds
    ds_read_b64_tr_b16 a[28:29], v5 offset:30720
    ds_read_b64_tr_b16 a[30:31], v5 offset:31232
    v_mfma_f32_32x32x16_bf16 v[16:31], a[4:7], v[196:199], v[16:31]
    s_add_u32 s24, s24, s25
    s_waitcnt vmcnt(19)
    s_barrier
    ds_read_b64_tr_b16 a[0:1], v5 offset:32768
    ds_read_b64_tr_b16 a[2:3], v5 offset:33280
    s_waitcnt lgkmcnt(10)
    v_mfma_f32_32x32x16_bf16 v[16:31], a[8:11], v[200:203], v[16:31]
    s_cmp_ge_u32 s31, 4
    s_cbranch_scc1 Lsw_f2
Lswr_f2:
    ds_read_b64_tr_b16 a[4:5], v5 offset:34816
    ds_read_b64_tr_b16 a[6:7], v5 offset:35328
    v_mfma_f32_32x32x16_bf16 v[16:31], a[12:15], v[204:207], v[16:31]
    s_add_u32 m0, s28, 12288
    ds_read_b64_tr_b16 a[8:9], v5 offset:36864
    ds_read_b64_tr_b16 a[10:11], v5 offset:37376
    s_waitcnt lgkmcnt(10)
    v_mfma_f32_32x32x16_bf16 v[32:47], a[16:19], a[112:115], v[32:47]
    buffer_load_dwordx4 v64, s[4:7], s24 offen offset:0 lds
    ds_read_b64_tr_b16 a[12:13], v5 offset:38912
    ds_read_b64_tr_b16 a[14:15], v5 offset:39424
    v_mfma_f32_32x32x16_bf16 v[32:47], a[20:23], a[116:119], v[32:47]
    v_xor_b32 v4, v8, v4
    ds_read_b64_tr_b16 a[16:17], v5 offset:40960
    ds_read_b64_tr_b16 a[18:19], v5 offset:41472
    s_waitcnt lgkmcnt(10)
    v_mfma_f32_32x32x16_bf16 v[32:47], a[24:27], a[120:123], v[32:47]
    ds_read_b64_tr_b16 a[20:21], v5 offset:43008
    ds_read_b64_tr_b16 a[22:23], v5 offset:43520
    v_mfma_f32_32x32x16_bf16 v[32:47], a[28:31], a[124:127], v[32:47]
    ds_read_b64_tr_b16 a[24:25], v5 offset:45056
    ds_read_b64_tr_b16 a[26:27], v5 offset:45568
    s_waitcnt lgkmcnt(10)
    v_mfma_f32_32x32x16_bf16 v[32:47], a[0:3], a[128:131], v[32:47]
    buffer_load_dwordx4 v65, s[4:7], s24 offen offset:1024 lds
    ds_read_b64_tr_b16 a[28:29], v5 offset:47104
    ds_read_b64_tr_b16 a[30:31], v5 offset:47616
    v_mfma_f32_32x32x16_bf16 v[32:47], a[4:7], a[132:135], v[32:47]
    ds_read_b64_tr_b16 a[0:1], v6 offset:0
    ds_read_b64_tr_b16 a[2:3], v6 offset:512
    s_waitcnt lgkmcnt(10)
    v_mfma_f32_32x32x16_bf16 v[32:47], a[8:11], a[136:139], v[32:47]
    v_xor_b32 v5, 73728, v5
    ds_read_b64_tr_b16 a[4:5], v6 offset:2048
    ds_read_b64_tr_b16 a[6:7], v6 offset:2560
    v_mfma_f32_32x32x16_bf16 v[32:47], a[12:15], a[140:143], v[32:47]
    ds_read_b64_tr_b16 a[8:9], v6 offset:4096
    ds_read_b64_tr_b16 a[10:11], v6 offset:4608
    s_waitcnt lgkmcnt(10)
    v_mfma_f32_32x32x16_bf16 v[32:47], a[16:19], v[192:195], v[32:47]
    buffer_load_dwordx4 v66, s[4:7], s24 offen offset:2048 lds
    ds_read_b64_tr_b16 a[12:13], v6 offset:6144
    ds_read_b64_tr_b16 a[14:15], v6 offset:6656
    v_mfma_f32_32x32x16_bf16 v[32:47], a[20:23], v[196:199], v[32:47]
    ds_read_b64_tr_b16 a[16:17], v6 offset:8192
    ds_read_b64_tr_b16 a[18:19], v6 offset:8704
    s_waitcnt lgkmcnt(10)
    v_mfma_f32_32x32x16_bf16 v[32:47], a[24:27], v[200:203], v[32:47]
    ds_read_b64_tr_b16 a[20:21], v6 offset:10240
    ds_read_b64_tr_b16 a[22:23], v6 offset:10752
    v_mfma_f32_32x32x16_bf16 v[32:47], a[28:31], v[204:207], v[32:47]
    ds_read_b64_tr_b16 a[24:25], v6 offset:12288
    ds_read_b64_tr_b16 a[26:27], v6 offset:12800
    s_waitcnt lgkmcnt(10)
    v_mfma_f32_32x32x16_bf16 v[16:31], a[0:3], v[208:211], v[16:31]
    buffer_load_dwordx4 v67, s[4:7], s24 offen offset:3072 lds
    ds_read_b64_tr_b16 a[28:29], v6 offset:14336
    ds_read_b64_tr_b16 a[30:31], v6 offset:14848
    v_mfma_f32_32x32x16_bf16 v[16:31], a[4:7], v[212:215], v[16:31]
    ds_read_b64_tr_b16 a[0:1], v6 offset:16384
    ds_read_b64_tr_b16 a[2:3], v6 offset:16896
    s_waitcnt lgkmcnt(10)
    v_mfma_f32_32x32x16_bf16 v[16:31], a[8:11], v[216:219], v[16:31]
    ds_read_b64_tr_b16 a[4:5], v6 offset:18432
    ds_read_b64_tr_b16 a[6:7], v6 offset:18944
    v_mfma_f32_32x32x16_bf16 v[16:31], a[12:15], v[220:223], v[16:31]
    s_set_gpr_idx_on s32, 0x8
    s_nop 0
    v_pk_max_i16 v88, v56, 0
    v_pk_max_i16 v89, v57, 0
    v_pk_max_i16 v90, v58, 0
    v_pk_max_i16 v91, v59, 0
    v_pk_max_i16 v92, v60, 0
    v_pk_max_i16 v93, v61, 0
    v_pk_max_i16 v94, v62, 0
    v_pk_max_i16 v95, v63, 0
    s_set_gpr_idx_off
    s_add_u32 s32, s32, s33
    s_mov_b32 s33, 16
    s_add_u32 m0, s28, 16384
    ds_read_b64_tr_b16 a[8:9], v6 offset:20480
    ds_read_b64_tr_b16 a[10:11], v6 offset:20992
    s_waitcnt lgkmcnt(10)
    v_mfma_f32_32x32x16_bf16 v[16:31], a[16:19], v[224:227], v[16:31]
    buffer_load_dwordx4 v68, s[4:7], s24 offen offset:0 lds
    ds_read_b64_tr_b16 a[12:13], v6 offset:22528
    ds_read_b64_tr_b16 a[14:15], v6 offset:23040
    v_mfma_f32_32x32x16_bf16 v[16:31], a[20:23], v[228:231], v[16:31]
    ds_read_b64_tr_b16 a[16:17], v7 offset:0
    ds_read_b64_tr_b16 a[18:19], v7 offset:512
    s_waitcnt lgkmcnt(10)
    v_mfma_f32_32x32x16_bf16 v[16:31], a[24:27], v[232:235], v[16:31]
    v_xor_b32 v6, 73728, v6
    ds_read_b64_tr_b16 a[20:21], v7 offset:2048
    ds_read_b64_tr_b16 a[22:23], v7 offset:2560
    v_mfma_f32_32x32x16_bf16 v[16:31], a[28:31], v[236:239], v[16:31]
    ds_read_b64_tr_b16 a[24:25], v7 offset:4096
    ds_read_b64_tr_b16 a[26:27], v7 offset:4608
    s_waitcnt lgkmcnt(10)
    v_mfma_f32_32x32x16_bf16 v[16:31], a[0:3], v[240:243], v[16:31]
    buffer_load_dwordx4 v69, s[4:7], s24 offen offset:1024 lds
    ds_read_b64_tr_b16 a[28:29], v7 offset:6144
    ds_read_b64_tr_b16 a[30:31], v7 offset:6656
    v_mfma_f32_32x32x16_bf16 v[16:31], a[4:7], v[244:247], v[16:31]
    s_add_u32 s24, s24, s26
    s_waitcnt vmcnt(19)
    s_barrier
    ds_read_b64_tr_b16 a[0:1], v7 offset:8192
    ds_read_b64_tr_b16 a[2:3], v7 offset:8704
    s_waitcnt lgkmcnt(10)
    v_mfma_f32_32x32x16_bf16 v[16:31], a[8:11], v[248:251], v[16:31]
    ds_read_b64_tr_b16 a[4:5], v7 offset:10240
    ds_read_b64_tr_b16 a[6:7], v7 offset:10752
    v_mfma_f32_32x32x16_bf16 v[16:31], a[12:15], v[252:255], v[16:31]
    s_add_u32 m0, s28, 36864
    ds_read_b64_tr_b16 a[8:9], v7 offset:12288
    ds_read_b64_tr_b16 a[10:11], v7 offset:12800
    s_waitcnt lgkmcnt(10)
    v_mfma_f32_32x32x16_bf16 v[32:47], a[16:19], v[208:211], v[32:47]
    buffer_load_dwordx4 v64, s[4:7], s24 offen offset:0 lds
    ds_read_b64_tr_b16 a[12:13], v7 offset:14336
    ds_read_b64_tr_b16 a[14:15], v7 offset:14848
    v_mfma_f32_32x32x16_bf16 v[32:47], a[20:23], v[212:215], v[32:47]
    v_cvt_pk_bf16_f32 v48, v16, v17
    v_cvt_pk_bf16_f32 v49, v18, v19
    ds_read_b64_tr_b16 a[16:17], v7 offset:16384
    ds_read_b64_tr_b16 a[18:19], v7 offset:16896
    s_waitcnt lgkmcnt(10)
    v_mfma_f32_32x32x16_bf16 v[32:47], a[24:27], v[216:219], v[32:47]
    v_cvt_pk_bf16_f32 v50, v20, v21
    v_cvt_pk_bf16_f32 v51, v22, v23
    v_cvt_pk_bf16_f32 v52, v24, v25
    ds_read_b64_tr_b16 a[20:21], v7 offset:18432
    ds_read_b64_tr_b16 a[22:23], v7 offset:18944
    v_mfma_f32_32x32x16_bf16 v[32:47], a[28:31], v[220:223], v[32:47]
    v_cvt_pk_bf16_f32 v53, v26, v27
    v_cvt_pk_bf16_f32 v54, v28, v29
    ds_read_b64_tr_b16 a[24:25], v7 offset:20480
    ds_read_b64_tr_b16 a[26:27], v7 offset:20992
    s_waitcnt lgkmcnt(10)
    v_mfma_f32_32x32x16_bf16 v[32:47], a[0:3], v[224:227], v[32:47]
    buffer_load_dwordx4 v65, s[4:7], s24 offen offset:1024 lds
    ds_read_b64_tr_b16 a[28:29], v7 offset:22528
    ds_read_b64_tr_b16 a[30:31], v7 offset:23040
    v_mfma_f32_32x32x16_bf16 v[32:47], a[4:7], v[228:231], v[32:47]
    v_cvt_pk_bf16_f32 v55, v30, v31
    ds_read_b64_tr_b16 a[0:1], v4 offset:0
    ds_read_b64_tr_b16 a[2:3], v4 offset:512
    s_waitcnt lgkmcnt(10)
    v_mfma_f32_32x32x16_bf16 v[32:47], a[8:11], v[232:235], v[32:47]
    v_xor_b32 v7, 73728, v7
    ds_read_b64_tr_b16 a[4:5], v4 offset:2048
    ds_read_b64_tr_b16 a[6:7], v4 offset:2560
    v_mfma_f32_32x32x16_bf16 v[32:47], a[12:15], v[236:239], v[32:47]
    ds_read_b64_tr_b16 a[8:9], v4 offset:4096
    ds_read_b64_tr_b16 a[10:11], v4 offset:4608
    s_waitcnt lgkmcnt(10)
    v_mfma_f32_32x32x16_bf16 v[32:47], a[16:19], v[240:243], v[32:47]
    buffer_load_dwordx4 v66, s[4:7], s24 offen offset:2048 lds
    ds_read_b64_tr_b16 a[12:13], v4 offset:6144
    ds_read_b64_tr_b16 a[14:15], v4 offset:6656
    v_mfma_f32_32x32x16_bf16 v[32:47], a[20:23], v[244:247], v[32:47]
    ds_read_b64_tr_b16 a[16:17], v4 offset:8192
    ds_read_b64_tr_b16 a[18:19], v4 offset:8704
    s_waitcnt lgkmcnt(10)
    v_mfma_f32_32x32x16_bf16 v[32:47], a[24:27], v[248:251], v[32:47]
    ds_read_b64_tr_b16 a[20:21], v4 offset:10240
    ds_read_b64_tr_b16 a[22:23], v4 offset:10752
    v_mfma_f32_32x32x16_bf16 v[32:47], a[28:31], v[252:255], v[32:47]
    s_xor_b32 s28, s28, 73728
    s_xor_b32 s29, s29, 73728
    s_add_u32 s31, s31, 1
    s_cmp_lt_u32 s31, 6
    s_cbranch_scc1 Lp1_f2
    s_mov_b32 s56, 0x40000000
    v_pk_max_i16 v160, v48, 0
    v_pk_max_i16 v161, v49, 0
    v_pk_max_i16 v162, v50, 0
    v_pk_max_i16 v163, v51, 0
    v_pk_max_i16 v164, v52, 0
    v_pk_max_i16 v165, v53, 0
    v_pk_max_i16 v166, v54, 0
    v_pk_max_i16 v167, v55, 0
    buffer_store_dwordx4 v[48:51], v11, s[12:15], s56 offen
    buffer_store_dwordx4 v[48:51], v11, s[12:15], s56 offen
    buffer_store_dwordx4 v[48:51], v11, s[12:15], s56 offen
    buffer_store_dwordx4 v[48:51], v11, s[12:15], s56 offen
    v_xor_b32 v6, 64, v14
    v_xor_b32 v5, 64, v14
    s_mov_b32 s31, 0
    s_mov_b32 s30, 0
    s_mov_b32 s28, 0
    s_mov_b32 s29, 98304
    s_nop 3
    v_cvt_pk_bf16_f32 v56, v32, v33
    v_cvt_pk_bf16_f32 v57, v34, v35
    v_cvt_pk_bf16_f32 v58, v36, v37
    v_cvt_pk_bf16_f32 v59, v38, v39
    v_cvt_pk_bf16_f32 v60, v40, v41
    v_cvt_pk_bf16_f32 v61, v42, v43
    v_cvt_pk_bf16_f32 v62, v44, v45
    v_cvt_pk_bf16_f32 v63, v46, v47
    v_pk_max_i16 v168, v56, 0
    v_pk_max_i16 v169, v57, 0
    v_pk_max_i16 v170, v58, 0
    v_pk_max_i16 v171, v59, 0
    v_pk_max_i16 v172, v60, 0
    v_pk_max_i16 v173, v61, 0
    v_pk_max_i16 v174, v62, 0
    v_pk_max_i16 v175, v63, 0
    .p2align 6
Lp2_2:
    ds_read_b64_tr_b16 a[24:25], v4 offset:12288
    ds_read_b64_tr_b16 a[26:27], v4 offset:12800
    s_waitcnt lgkmcnt(10)
    v_mfma_f32_32x32x16_bf16 v[16:31], a[0:3], v[80:83], 0
    buffer_load_dwordx4 v67, s[4:7], s24 offen offset:3072 lds
    ds_read_b64_tr_b16 a[28:29], v4 offset:14336
    ds_read_b64_tr_b16 a[30:31], v4 offset:14848
    v_mfma_f32_32x32x16_bf16 v[16:31], a[4:7], v[84:87], v[16:31]
    v_cvt_pk_bf16_f32 v56, v32, v33
    v_cvt_pk_bf16_f32 v57, v34, v35
    ds_read_b64_tr_b16 a[0:1], v4 offset:16384
    ds_read_b64_tr_b16 a[2:3], v4 offset:16896
    s_waitcnt lgkmcnt(10)
    v_mfma_f32_32x32x16_bf16 v[16:31], a[8:11], v[88:91], v[16:31]
    buffer_store_dwordx4 v[48:51], v11, s[12:15], s56 offen offset:0 sc0 sc1
    ds_read_b64_tr_b16 a[4:5], v4 offset:18432
    ds_read_b64_tr_b16 a[6:7], v4 offset:18944
    v_mfma_f32_32x32x16_bf16 v[16:31], a[12:15], v[92:95], v[16:31]
    s_add_u32 m0, s29, 16384
    v_cvt_pk_bf16_f32 v58, v36, v37
    ds_read_b64_tr_b16 a[8:9], v4 offset:20480
    ds_read_b64_tr_b16 a[10:11], v4 offset:20992
    s_waitcnt lgkmcnt(10)
    v_mfma_f32_32x32x16_bf16 v[16:31], a[16:19], v[96:99], v[16:31]
    buffer_load_dwordx4 v68, s[4:7], s24 offen offset:0 lds
    ds_read_b64_tr_b16 a[12:13], v4 offset:22528
    ds_read_b64_tr_b16 a[14:15], v4 offset:23040
    v_mfma_f32_32x32x16_bf16 v[16:31], a[20:23], v[100:103], v[16:31]
    v_cvt_pk_bf16_f32 v59, v38, v39
    v_cvt_pk_bf16_f32 v60, v40, v41
    ds_read_b64_tr_b16 a[16:17], v5 offset:0
    ds_read_b64_tr_b16 a[18:19], v5 offset:512
    s_waitcnt lgkmcnt(10)
    v_mfma_f32_32x32x16_bf16 v[16:31], a[24:27], v[104:107], v[16:31]
    buffer_store_dwordx4 v[52:55], v11, s[12:15], s56 offen offset:1024 sc0 sc1
    ds_read_b64_tr_b16 a[20:21], v5 offset:2048
    ds_read_b64_tr_b16 a[22:23], v5 offset:2560
    v_mfma_f32_32x32x16_bf16 v[16:31], a[28:31], v[108:111], v[16:31]
    v_cvt_pk_bf16_f32 v61, v42, v43
    v_cvt_pk_bf16_f32 v62, v44, v45
    ds_read_b64_tr_b16 a[24:25], v5 offset:4096
    ds_read_b64_tr_b16 a[26:27], v5 offset:4608
    s_waitcnt lgkmcnt(10)
    v_mfma_f32_32x32x16_bf16 v[16:31], a[0:3], v[112:115], v[16:31]
    buffer_load_dwordx4 v69, s[4:7], s24 offen offset:1024 lds
    ds_read_b64_tr_b16 a[28:29], v5 offset:6144
    ds_read_b64_tr_b16 a[30:31], v5 offset:6656
    v_mfma_f32_32x32x16_bf16 v[16:31], a[4:7], v[116:119], v[16:31]
    s_add_u32 s24, s24, 221184
    s_waitcnt vmcnt(24)
    s_barrier
    ds_read_b64_tr_b16 a[0:1], v5 offset:8192
    ds_read_b64_tr_b16 a[2:3], v5 offset:8704
    s_waitcnt lgkmcnt(10)
    v_mfma_f32_32x32x16_bf16 v[16:31], a[8:11], v[120:123], v[16:31]
    v_cvt_pk_bf16_f32 v63, v46, v47
    ds_read_b64_tr_b16 a[4:5], v5 offset:10240
    ds_read_b64_tr_b16 a[6:7], v5 offset:10752
    v_mfma_f32_32x32x16_bf16 v[16:31], a[12:15], v[124:127], v[16:31]
    s_add_u32 m0, s29, 36864
    ds_read_b64_tr_b16 a[8:9], v5 offset:12288
    ds_read_b64_tr_b16 a[10:11], v5 offset:12800
    s_waitcnt lgkmcnt(10)
    v_mfma_f32_32x32x16_bf16 v[32:47], a[16:19], v[80:83], 0
    buffer_load_dwordx4 v64, s[4:7], s24 offen offset:0 lds
    ds_read_b64_tr_b16 a[12:13], v5 offset:14336
    ds_read_b64_tr_b16 a[14:15], v5 offset:14848
    v_mfma_f32_32x32x16_bf16 v[32:47], a[20:23], v[84:87], v[32:47]
    ds_read_b64_tr_b16 a[16:17], v5 offset:16384
    ds_read_b64_tr_b16 a[18:19], v5 offset:16896
    s_waitcnt lgkmcnt(10)
    v_mfma_f32_32x32x16_bf16 v[32:47], a[24:27], v[88:91], v[32:47]
    buffer_store_dwordx4 v[56:59], v11, s[12:15], s56 offen offset:2048 sc0 sc1
    ds_read_b64_tr_b16 a[20:21], v5 offset:18432
    ds_read_b64_tr_b16 a[22:23], v5 offset:18944
    v_mfma_f32_32x32x16_bf16 v[32:47], a[28:31], v[92:95], v[32:47]
    ds_read_b64_tr_b16 a[24:25], v5 offset:20480
    ds_read_b64_tr_b16 a[26:27], v5 offset:20992
    s_waitcnt lgkmcnt(10)
    v_mfma_f32_32x32x16_bf16 v[32:47], a[0:3], v[96:99], v[32:47]
    buffer_load_dwordx4 v65, s[4:7], s24 offen offset:1024 lds
    ds_read_b64_tr_b16 a[28:29], v5 offset:22528
    ds_read_b64_tr_b16 a[30:31], v5 offset:23040
    v_mfma_f32_32x32x16_bf16 v[32:47], a[4:7], v[100:103], v[32:47]
    ds_read_b64_tr_b16 a[0:1], v4 offset:24576
    ds_read_b64_tr_b16 a[2:3], v4 offset:25088
    s_waitcnt lgkmcnt(10)
    v_mfma_f32_32x32x16_bf16 v[32:47], a[8:11], v[104:107], v[32:47]
    buffer_store_dwordx4 v[60:63], v11, s[12:15], s56 offen offset:3072 sc0 sc1
    ds_read_b64_tr_b16 a[4:5], v4 offset:26624
    ds_read_b64_tr_b16 a[6:7], v4 offset:27136
    v_mfma_f32_32x32x16_bf16 v[32:47], a[12:15], v[108:111], v[32:47]
    ds_read_b64_tr_b16 a[8:9], v4 offset:28672
    ds_read_b64_tr_b16 a[10:11], v4 offset:29184
    s_waitcnt lgkmcnt(10)
    v_mfma_f32_32x32x16_bf16 v[32:47], a[16:19], v[112:115], v[32:47]
    buffer_load_dwordx4 v66, s[4:7], s24 offen offset:2048 lds
    ds_read_b64_tr_b16 a[12:13], v4 offset:30720
    ds_read_b64_tr_b16 a[14:15], v4 offset:31232
    v_mfma_f32_32x32x16_bf16 v[32:47], a[20:23], v[116:119], v[32:47]
    ds_read_b64_tr_b16 a[16:17], v4 offset:32768
    ds_read_b64_tr_b16 a[18:19], v4 offset:33280
    s_waitcnt lgkmcnt(10)
    v_mfma_f32_32x32x16_bf16 v[32:47], a[24:27], v[120:123], v[32:47]
    ds_read_b64_tr_b16 a[20:21], v4 offset:34816
    ds_read_b64_tr_b16 a[22:23], v4 offset:35328
    v_mfma_f32_32x32x16_bf16 v[32:47], a[28:31], v[124:127], v[32:47]
    ds_read_b64_tr_b16 a[24:25], v4 offset:36864
    ds_read_b64_tr_b16 a[26:27], v4 offset:37376
    s_waitcnt lgkmcnt(10)
    v_mfma_f32_32x32x16_bf16 v[16:31], a[0:3], v[128:131], v[16:31]
    buffer_load_dwordx4 v67, s[4:7], s24 offen offset:3072 lds
    ds_read_b64_tr_b16 a[28:29], v4 offset:38912
    ds_read_b64_tr_b16 a[30:31], v4 offset:39424
    v_mfma_f32_32x32x16_bf16 v[16:31], a[4:7], v[132:135], v[16:31]
    s_add_u32 s30, s30, 49152
    s_cmp_eq_u32 s30, 147456
    s_cselect_b32 s30, 0, s30
    ds_read_b64_tr_b16 a[0:1], v4 offset:40960
    ds_read_b64_tr_b16 a[2:3], v4 offset:41472
    s_waitcnt lgkmcnt(10)
    v_mfma_f32_32x32x16_bf16 v[16:31], a[8:11], v[136:139], v[16:31]
    s_mov_b32 s56, s58
    s_add_u32 s58, s58, 4096
    ds_read_b64_tr_b16 a[4:5], v4 offset:43008
    ds_read_b64_tr_b16 a[6:7], v4 offset:43520
    v_mfma_f32_32x32x16_bf16 v[16:31], a[12:15], v[140:143], v[16:31]
    s_add_u32 m0, s29, 40960
    ds_read_b64_tr_b16 a[8:9], v4 offset:45056
    ds_read_b64_tr_b16 a[10:11], v4 offset:45568
    s_waitcnt lgkmcnt(10)
    v_mfma_f32_32x32x16_bf16 v[16:31], a[16:19], v[144:147], v[16:31]
    buffer_load_dwordx4 v68, s[4:7], s24 offen offset:0 lds
    ds_read_b64_tr_b16 a[12:13], v4 offset:47104
    ds_read_b64_tr_b16 a[14:15], v4 offset:47616
    v_mfma_f32_32x32x16_bf16 v[16:31], a[20:23], v[148:151], v[16:31]
    ds_read_b64_tr_b16 a[16:17], v5 offset:24576
    ds_read_b64_tr_b16 a[18:19], v5 offset:25088
    s_waitcnt lgkmcnt(10)
    v_mfma_f32_32x32x16_bf16 v[16:31], a[24:27], v[152:155], v[16:31]
    ds_read_b64_tr_b16 a[20:21], v5 offset:26624
    ds_read_b64_tr_b16 a[22:23], v5 offset:27136
    v_mfma_f32_32x32x16_bf16 v[16:31], a[28:31], v[156:159], v[16:31]
    ds_read_b64_tr_b16 a[24:25], v5 offset:28672
    ds_read_b64_tr_b16 a[26:27], v5 offset:29184
    s_waitcnt lgkmcnt(10)
    v_mfma_f32_32x32x16_bf16 v[16:31], a[0:3], v[160:163], v[16:31]
    buffer_load_dwordx4 v69, s[4:7], s24 offen offset:1024 lds
    ds_read_b64_tr_b16 a[28:29], v5 offset:30720
    ds_read_b64_tr_b16 a[30:31], v5 offset:31232
    v_mfma_f32_32x32x16_bf16 v[16:31], a[4:7], v[164:167], v[16:31]
    s_add_u32 s24, s24, 4294746240
    s_waitcnt vmcnt(24)
    s_barrier
    ds_read_b64_tr_b16 a[0:1], v5 offset:32768
    ds_read_b64_tr_b16 a[2:3], v5 offset:33280
    s_waitcnt lgkmcnt(10)
    v_mfma_f32_32x32x16_bf16 v[16:31], a[8:11], v[168:171], v[16:31]
    s_cmp_ge_u32 s31, 6
    s_cselect_b32 s6, 0, s6
    ds_read_b64_tr_b16 a[4:5], v5 offset:34816
    ds_read_b64_tr_b16 a[6:7], v5 offset:35328
    v_mfma_f32_32x32x16_bf16 v[16:31], a[12:15], v[172:175], v[16:31]
    s_add_u32 m0, s28, 12288
    v_add_u32 v4, s30, v14
    ds_read_b64_tr_b16 a[8:9], v5 offset:36864
    ds_read_b64_tr_b16 a[10:11], v5 offset:37376
    s_waitcnt lgkmcnt(10)
    v_mfma_f32_32x32x16_bf16 v[32:47], a[16:19], v[128:131], v[32:47]
    buffer_load_dwordx4 v64, s[4:7], s24 offen offset:0 lds
    ds_read_b64_tr_b16 a[12:13], v5 offset:38912
    ds_read_b64_tr_b16 a[14:15], v5 offset:39424
    v_mfma_f32_32x32x16_bf16 v[32:47], a[20:23], v[132:135], v[32:47]
    v_cvt_pk_bf16_f32 v48, v16, v17
    v_cvt_pk_bf16_f32 v49, v18, v19
    ds_read_b64_tr_b16 a[16:17], v5 offset:40960
    ds_read_b64_tr_b16 a[18:19], v5 offset:41472
    s_waitcnt lgkmcnt(10)
    v_mfma_f32_32x32x16_bf16 v[32:47], a[24:27], v[136:139], v[32:47]
    v_cvt_pk_bf16_f32 v50, v20, v21
    v_cvt_pk_bf16_f32 v51, v22, v23
    v_cvt_pk_bf16_f32 v52, v24, v25
    ds_read_b64_tr_b16 a[20:21], v5 offset:43008
    ds_read_b64_tr_b16 a[22:23], v5 offset:43520
    v_mfma_f32_32x32x16_bf16 v[32:47], a[28:31], v[140:143], v[32:47]
    v_cvt_pk_bf16_f32 v53, v26, v27
    v_cvt_pk_bf16_f32 v54, v28, v29
    ds_read_b64_tr_b16 a[24:25], v5 offset:45056
    ds_read_b64_tr_b16 a[26:27], v5 offset:45568
    s_waitcnt lgkmcnt(10)
    v_mfma_f32_32x32x16_bf16 v[32:47], a[0:3], v[144:147], v[32:47]
    buffer_load_dwordx4 v65, s[4:7], s24 offen offset:1024 lds
    ds_read_b64_tr_b16 a[28:29], v5 offset:47104
    ds_read_b64_tr_b16 a[30:31], v5 offset:47616
    v_mfma_f32_32x32x16_bf16 v[32:47], a[4:7], v[148:151], v[32:47]
    v_cvt_pk_bf16_f32 v55, v30, v31
    ds_read_b64_tr_b16 a[0:1], v4 offset:0
    ds_read_b64_tr_b16 a[2:3], v4 offset:512
    s_waitcnt lgkmcnt(10)
    v_mfma_f32_32x32x16_bf16 v[32:47], a[8:11], v[152:155], v[32:47]
    v_add_u32 v5, s30, v6
    ds_read_b64_tr_b16 a[4:5], v4 offset:2048
    ds_read_b64_tr_b16 a[6:7], v4 offset:2560
    v_mfma_f32_32x32x16_bf16 v[32:47], a[12:15], v[156:159], v[32:47]
    ds_read_b64_tr_b16 a[8:9], v4 offset:4096
    ds_read_b64_tr_b16 a[10:11], v4 offset:4608
    s_waitcnt lgkmcnt(10)
    v_mfma_f32_32x32x16_bf16 v[32:47], a[16:19], v[160:163], v[32:47]
    buffer_load_dwordx4 v66, s[4:7], s24 offen offset:2048 lds
    ds_read_b64_tr_b16 a[12:13], v4 offset:6144
    ds_read_b64_tr_b16 a[14:15], v4 offset:6656
    v_mfma_f32_32x32x16_bf16 v[32:47], a[20:23], v[164:167], v[32:47]
    ds_read_b64_tr_b16 a[16:17], v4 offset:8192
    ds_read_b64_tr_b16 a[18:19], v4 offset:8704
    s_waitcnt lgkmcnt(10)
    v_mfma_f32_32x32x16_bf16 v[32:47], a[24:27], v[168:171], v[32:47]
    ds_read_b64_tr_b16 a[20:21], v4 offset:10240
    ds_read_b64_tr_b16 a[22:23], v4 offset:10752
    v_mfma_f32_32x32x16_bf16 v[32:47], a[28:31], v[172:175], v[32:47]
    s_mov_b32 s29, s28
    s_mov_b32 s28, s30
    s_add_u32 s31, s31, 1
    s_cmp_lt_u32 s31, 9
    s_cbranch_scc1 Lp2_2
    s_branch Lffn_end
    .p2align 6
Lp1_f3:
    ds_read_b64_tr_b16 a[24:25], v4 offset:12288
    ds_read_b64_tr_b16 a[26:27], v4 offset:12800
    s_waitcnt lgkmcnt(10)
    v_mfma_f32_32x32x16_bf16 v[16:31], a[0:3], a[64:67], 0
    ds_read_b64_tr_b16 a[28:29], v4 offset:14336
    ds_read_b64_tr_b16 a[30:31], v4 offset:14848
    v_mfma_f32_32x32x16_bf16 v[16:31], a[4:7], a[68:71], v[16:31]
    buffer_load_dwordx4 v67, s[4:7], s24 offen offset:3072 lds
    ds_read_b64_tr_b16 a[0:1], v4 offset:16384
    ds_read_b64_tr_b16 a[2:3], v4 offset:16896
    s_waitcnt lgkmcnt(10)
    v_mfma_f32_32x32x16_bf16 v[16:31], a[8:11], a[72:75], v[16:31]
    v_cvt_pk_bf16_f32 v56, v32, v33
    v_cvt_pk_bf16_f32 v57, v34, v35
    v_cvt_pk_bf16_f32 v58, v36, v37
    ds_read_b64_tr_b16 a[4:5], v4 offset:18432
    ds_read_b64_tr_b16 a[6:7], v4 offset:18944
    v_mfma_f32_32x32x16_bf16 v[16:31], a[12:15], a[76:79], v[16:31]
    v_cvt_pk_bf16_f32 v59, v38, v39
    v_cvt_pk_bf16_f32 v60, v40, v41
    ds_read_b64_tr_b16 a[8:9], v4 offset:20480
    ds_read_b64_tr_b16 a[10:11], v4 offset:20992
    s_waitcnt lgkmcnt(10)
    v_mfma_f32_32x32x16_bf16 v[16:31], a[16:19], a[80:83], v[16:31]
    s_add_u32 m0, s29, 47104
    v_cvt_pk_bf16_f32 v61, v42, v43
    v_cvt_pk_bf16_f32 v62, v44, v45
    ds_read_b64_tr_b16 a[12:13], v4 offset:22528
    ds_read_b64_tr_b16 a[14:15], v4 offset:23040
    v_mfma_f32_32x32x16_bf16 v[16:31], a[20:23], a[84:87], v[16:31]
    buffer_load_dwordx4 v68, s[4:7], s24 offen offset:0 lds
    ds_read_b64_tr_b16 a[16:17], v5 offset:0
    ds_read_b64_tr_b16 a[18:19], v5 offset:512
    s_waitcnt lgkmcnt(10)
    v_mfma_f32_32x32x16_bf16 v[16:31], a[24:27], a[88:91], v[16:31]
    v_cvt_pk_bf16_f32 v63, v46, v47
    ds_read_b64_tr_b16 a[20:21], v5 offset:2048
    ds_read_b64_tr_b16 a[22:23], v5 offset:2560
    v_mfma_f32_32x32x16_bf16 v[16:31], a[28:31], a[92:95], v[16:31]
    ds_read_b64_tr_b16 a[24:25], v5 offset:4096
    ds_read_b64_tr_b16 a[26:27], v5 offset:4608
    s_waitcnt lgkmcnt(10)
    v_mfma_f32_32x32x16_bf16 v[16:31], a[0:3], a[96:99], v[16:31]
    ds_read_b64_tr_b16 a[28:29], v5 offset:6144
    ds_read_b64_tr_b16 a[30:31], v5 offset:6656
    v_mfma_f32_32x32x16_bf16 v[16:31], a[4:7], a[100:103], v[16:31]
    buffer_load_dwordx4 v69, s[4:7], s24 offen offset:1024 lds
    s_waitcnt vmcnt(19)
    s_barrier
    ds_read_b64_tr_b16 a[0:1], v5 offset:8192
    ds_read_b64_tr_b16 a[2:3], v5 offset:8704
    s_waitcnt lgkmcnt(10)
    v_mfma_f32_32x32x16_bf16 v[16:31], a[8:11], a[104:107], v[16:31]
    s_add_u32 s24, s24, s27
    ds_read_b64_tr_b16 a[4:5], v5 offset:10240
    ds_read_b64_tr_b16 a[6:7], v5 offset:10752
    v_mfma_f32_32x32x16_bf16 v[16:31], a[12:15], a[108:111], v[16:31]
    ds_read_b64_tr_b16 a[8:9], v5 offset:12288
    ds_read_b64_tr_b16 a[10:11], v5 offset:12800
    s_waitcnt lgkmcnt(10)
    v_mfma_f32_32x32x16_bf16 v[32:47], a[16:19], a[64:67], 0
    s_add_u32 m0, s29, 67584
    ds_read_b64_tr_b16 a[12:13], v5 offset:14336
    ds_read_b64_tr_b16 a[14:15], v5 offset:14848
    v_mfma_f32_32x32x16_bf16 v[32:47], a[20:23], a[68:71], v[32:47]
    buffer_load_dwordx4 v64, s[4:7], s24 offen offset:0 lds
    ds_read_b64_tr_b16 a[16:17], v5 offset:16384
    ds_read_b64_tr_b16 a[18:19], v5 offset:16896
    s_waitcnt lgkmcnt(10)
    v_mfma_f32_32x32x16_bf16 v[32:47], a[24:27], a[72:75], v[32:47]
    ds_read_b64_tr_b16 a[20:21], v5 offset:18432
    ds_read_b64_tr_b16 a[22:23], v5 offset:18944
    v_mfma_f32_32x32x16_bf16 v[32:47], a[28:31], a[76:79], v[32:47]
    buffer_load_dword a63, v79, s[44:47], s52 offen
    ds_read_b64_tr_b16 a[24:25], v5 offset:20480
    ds_read_b64_tr_b16 a[26:27], v5 offset:20992
    s_waitcnt lgkmcnt(10)
    v_mfma_f32_32x32x16_bf16 v[32:47], a[0:3], a[80:83], v[32:47]
    s_add_u32 s52, s52, 1792
    s_cmp_ge_u32 s31, 2
    s_cselect_b32 s46, 0, s46
    ds_read_b64_tr_b16 a[28:29], v5 offset:22528
    ds_read_b64_tr_b16 a[30:31], v5 offset:23040
    v_mfma_f32_32x32x16_bf16 v[32:47], a[4:7], a[84:87], v[32:47]
    buffer_load_dwordx4 v65, s[4:7], s24 offen offset:1024 lds
    ds_read_b64_tr_b16 a[0:1], v4 offset:24576
    ds_read_b64_tr_b16 a[2:3], v4 offset:25088
    s_waitcnt lgkmcnt(10)
    v_mfma_f32_32x32x16_bf16 v[32:47], a[8:11], a[88:91], v[32:47]
    ds_read_b64_tr_b16 a[4:5], v4 offset:26624
    ds_read_b64_tr_b16 a[6:7], v4 offset:27136
    v_mfma_f32_32x32x16_bf16 v[32:47], a[12:15], a[92:95], v[32:47]
    ds_read_b64_tr_b16 a[8:9], v4 offset:28672
    ds_read_b64_tr_b16 a[10:11], v4 offset:29184
    s_waitcnt lgkmcnt(10)
    v_mfma_f32_32x32x16_bf16 v[32:47], a[16:19], a[96:99], v[32:47]
    ds_read_b64_tr_b16 a[12:13], v4 offset:30720
    ds_read_b64_tr_b16 a[14:15], v4 offset:31232
    v_mfma_f32_32x32x16_bf16 v[32:47], a[20:23], a[100:103], v[32:47]
    buffer_load_dwordx4 v66, s[4:7], s24 offen offset:2048 lds
    ds_read_b64_tr_b16 a[16:17], v4 offset:32768
    ds_read_b64_tr_b16 a[18:19], v4 offset:33280
    s_waitcnt lgkmcnt(10)
    v_mfma_f32_32x32x16_bf16 v[32:47], a[24:27], a[104:107], v[32:47]
    ds_read_b64_tr_b16 a[20:21], v4 offset:34816
    ds_read_b64_tr_b16 a[22:23], v4 offset:35328
    v_mfma_f32_32x32x16_bf16 v[32:47], a[28:31], a[108:111], v[32:47]
    ds_read_b64_tr_b16 a[24:25], v4 offset:36864
    ds_read_b64_tr_b16 a[26:27], v4 offset:37376
    s_waitcnt lgkmcnt(10)
    v_mfma_f32_32x32x16_bf16 v[16:31], a[0:3], a[112:115], v[16:31]
    ds_read_b64_tr_b16 a[28:29], v4 offset:38912
    ds_read_b64_tr_b16 a[30:31], v4 offset:39424
    v_mfma_f32_32x32x16_bf16 v[16:31], a[4:7], a[116:119], v[16:31]
    buffer_load_dwordx4 v67, s[4:7], s24 offen offset:3072 lds
    ds_read_b64_tr_b16 a[0:1], v4 offset:40960
    ds_read_b64_tr_b16 a[2:3], v4 offset:41472
    s_waitcnt lgkmcnt(10)
    v_mfma_f32_32x32x16_bf16 v[16:31], a[8:11], a[120:123], v[16:31]
    ds_read_b64_tr_b16 a[4:5], v4 offset:43008
    ds_read_b64_tr_b16 a[6:7], v4 offset:43520
    v_mfma_f32_32x32x16_bf16 v[16:31], a[12:15], a[124:127], v[16:31]
    ds_read_b64_tr_b16 a[8:9], v4 offset:45056
    ds_read_b64_tr_b16 a[10:11], v4 offset:45568
    s_waitcnt lgkmcnt(10)
    v_mfma_f32_32x32x16_bf16 v[16:31], a[16:19], a[128:131], v[16:31]
    s_set_gpr_idx_on s32, 0x8
    s_nop 0
    v_pk_max_i16 v80, v48, 0
    v_pk_max_i16 v81, v49, 0
    v_pk_max_i16 v82, v50, 0
    v_pk_max_i16 v83, v51, 0
    v_pk_max_i16 v84, v52, 0
    v_pk_max_i16 v85, v53, 0
    v_pk_max_i16 v86, v54, 0
    v_pk_max_i16 v87, v55, 0
    s_set_gpr_idx_off
    s_add_u32 m0, s29, 71680
    ds_read_b64_tr_b16 a[12:13], v4 offset:47104
    ds_read_b64_tr_b16 a[14:15], v4 offset:47616
    v_mfma_f32_32x32x16_bf16 v[16:31], a[20:23], a[132:135], v[16:31]
    buffer_load_dwordx4 v68, s[4:7], s24 offen offset:0 lds
    ds_read_b64_tr_b16 a[16:17], v5 offset:24576
    ds_read_b64_tr_b16 a[18:19], v5 offset:25088
    s_waitcnt lgkmcnt(10)
    v_mfma_f32_32x32x16_bf16 v[16:31], a[24:27], a[136:139], v[16:31]
    ds_read_b64_tr_b16 a[20:21], v5 offset:26624
    ds_read_b64_tr_b16 a[22:23], v5 offset:27136
    v_mfma_f32_32x32x16_bf16 v[16:31], a[28:31], a[140:143], v[16:31]
    ds_read_b64_tr_b16 a[24:25], v5 offset:28672
    ds_read_b64_tr_b16 a[26:27], v5 offset:29184
    s_waitcnt lgkmcnt(10)
    v_mfma_f32_32x32x16_bf16 v[16:31], a[0:3], v[192:195], v[16:31]
    ds_read_b64_tr_b16 a[28:29], v5 offset:30720
    ds_read_b64_tr_b16 a[30:31], v5 offset:31232
    v_mfma_f32_32x32x16_bf16 v[16:31], a[4:7], v[196:199], v[16:31]
    buffer_load_dwordx4 v69, s[4:7], s24 offen offset:1024 lds
    s_waitcnt vmcnt(19)
    s_barrier
    ds_read_b64_tr_b16 a[0:1], v5 offset:32768
    ds_read_b64_tr_b16 a[2:3], v5 offset:33280
    s_waitcnt lgkmcnt(10)
    v_mfma_f32_32x32x16_bf16 v[16:31], a[8:11], v[200:203], v[16:31]
    s_add_u32 s24, s24, s25
    ds_read_b64_tr_b16 a[4:5], v5 offset:34816
    ds_read_b64_tr_b16 a[6:7], v5 offset:35328
    v_mfma_f32_32x32x16_bf16 v[16:31], a[12:15], v[204:207], v[16:31]
    s_cmp_ge_u32 s31, 4
    s_cbranch_scc1 Lsw_f3
Lswr_f3:
    ds_read_b64_tr_b16 a[8:9], v5 offset:36864
    ds_read_b64_tr_b16 a[10:11], v5 offset:37376
    s_waitcnt lgkmcnt(10)
    v_mfma_f32_32x32x16_bf16 v[32:47], a[16:19], a[112:115], v[32:47]
    s_add_u32 m0, s28, 18432
    v_xor_b32 v4, v8, v4
    ds_read_b64_tr_b16 a[12:13], v5 offset:38912
    ds_read_b64_tr_b16 a[14:15], v5 offset:39424
    v_mfma_f32_32x32x16_bf16 v[32:47], a[20:23], a[116:119], v[32:47]
    buffer_load_dwordx4 v64, s[4:7], s24 offen offset:0 lds
    ds_read_b64_tr_b16 a[16:17], v5 offset:40960
    ds_read_b64_tr_b16 a[18:19], v5 offset:41472
    s_waitcnt lgkmcnt(10)
    v_mfma_f32_32x32x16_bf16 v[32:47], a[24:27], a[120:123], v[32:47]
    ds_read_b64_tr_b16 a[20:21], v5 offset:43008
    ds_read_b64_tr_b16 a[22:23], v5 offset:43520
    v_mfma_f32_32x32x16_bf16 v[32:47], a[28:31], a[124:127], v[32:47]
    ds_read_b64_tr_b16 a[24:25], v5 offset:45056
    ds_read_b64_tr_b16 a[26:27], v5 offset:45568
    s_waitcnt lgkmcnt(10)
    v_mfma_f32_32x32x16_bf16 v[32:47], a[0:3], a[128:131], v[32:47]
    ds_read_b64_tr_b16 a[28:29], v5 offset:47104
    ds_read_b64_tr_b16 a[30:31], v5 offset:47616
    v_mfma_f32_32x32x16_bf16 v[32:47], a[4:7], a[132:135], v[32:47]
    buffer_load_dwordx4 v65, s[4:7], s24 offen offset:1024 lds
    ds_read_b64_tr_b16 a[0:1], v6 offset:0
    ds_read_b64_tr_b16 a[2:3], v6 offset:512
    s_waitcnt lgkmcnt(10)
    v_mfma_f32_32x32x16_bf16 v[32:47], a[8:11], a[136:139], v[32:47]
    v_xor_b32 v5, 73728, v5
    ds_read_b64_tr_b16 a[4:5], v6 offset:2048
    ds_read_b64_tr_b16 a[6:7], v6 offset:2560
    v_mfma_f32_32x32x16_bf16 v[32:47], a[12:15], a[140:143], v[32:47]
    ds_read_b64_tr_b16 a[8:9], v6 offset:4096
    ds_read_b64_tr_b16 a[10:11], v6 offset:4608
    s_waitcnt lgkmcnt(10)
    v_mfma_f32_32x32x16_bf16 v[32:47], a[16:19], v[192:195], v[32:47]
    ds_read_b64_tr_b16 a[12:13], v6 offset:6144
    ds_read_b64_tr_b16 a[14:15], v6 offset:6656
    v_mfma_f32_32x32x16_bf16 v[32:47], a[20:23], v[196:199], v[32:47]
    buffer_load_dwordx4 v66, s[4:7], s24 offen offset:2048 lds
    ds_read_b64_tr_b16 a[16:17], v6 offset:8192
    ds_read_b64_tr_b16 a[18:19], v6 offset:8704
    s_waitcnt lgkmcnt(10)
    v_mfma_f32_32x32x16_bf16 v[32:47], a[24:27], v[200:203], v[32:47]
    ds_read_b64_tr_b16 a[20:21], v6 offset:10240
    ds_read_b64_tr_b16 a[22:23], v6 offset:10752
    v_mfma_f32_32x32x16_bf16 v[32:47], a[28:31], v[204:207], v[32:47]
    ds_read_b64_tr_b16 a[24:25], v6 offset:12288
    ds_read_b64_tr_b16 a[26:27], v6 offset:12800
    s_waitcnt lgkmcnt(10)
    v_mfma_f32_32x32x16_bf16 v[16:31], a[0:3], v[208:211], v[16:31]
    ds_read_b64_tr_b16 a[28:29], v6 offset:14336
    ds_read_b64_tr_b16 a[30:31], v6 offset:14848
    v_mfma_f32_32x32x16_bf16 v[16:31], a[4:7], v[212:215], v[16:31]
    buffer_load_dwordx4 v67, s[4:7], s24 offen offset:3072 lds
    ds_read_b64_tr_b16 a[0:1], v6 offset:16384
    ds_read_b64_tr_b16 a[2:3], v6 offset:16896
    s_waitcnt lgkmcnt(10)
    v_mfma_f32_32x32x16_bf16 v[16:31], a[8:11], v[216:219], v[16:31]
    ds_read_b64_tr_b16 a[4:5], v6 offset:18432
    ds_read_b64_tr_b16 a[6:7], v6 offset:18944
    v_mfma_f32_32x32x16_bf16 v[16:31], a[12:15], v[220:223], v[16:31]
    ds_read_b64_tr_b16 a[8:9], v6 offset:20480
    ds_read_b64_tr_b16 a[10:11], v6 offset:20992
    s_waitcnt lgkmcnt(10)
    v_mfma_f32_32x32x16_bf16 v[16:31], a[16:19], v[224:227], v[16:31]
    s_set_gpr_idx_on s32, 0x8
    s_nop 0
    v_pk_max_i16 v88, v56, 0
    v_pk_max_i16 v89, v57, 0
    v_pk_max_i16 v90, v58, 0
    v_pk_max_i16 v91, v59, 0
    v_pk_max_i16 v92, v60, 0
    v_pk_max_i16 v93, v61, 0
    v_pk_max_i16 v94, v62, 0
    v_pk_max_i16 v95, v63, 0
    s_set_gpr_idx_off
    s_add_u32 s32, s32, s33
    s_mov_b32 s33, 16
    s_add_u32 m0, s28, 22528
    ds_read_b64_tr_b16 a[12:13], v6 offset:22528
    ds_read_b64_tr_b16 a[14:15], v6 offset:23040
    v_mfma_f32_32x32x16_bf16 v[16:31], a[20:23], v[228:231], v[16:31]
    buffer_load_dwordx4 v68, s[4:7], s24 offen offset:0 lds
    ds_read_b64_tr_b16 a[16:17], v7 offset:0
    ds_read_b64_tr_b16 a[18:19], v7 offset:512
    s_waitcnt lgkmcnt(10)
    v_mfma_f32_32x32x16_bf16 v[16:31], a[24:27], v[232:235], v[16:31]
    v_xor_b32 v6, 73728, v6
    ds_read_b64_tr_b16 a[20:21], v7 offset:2048
    ds_read_b64_tr_b16 a[22:23], v7 offset:2560
    v_mfma_f32_32x32x16_bf16 v[16:31], a[28:31], v[236:239], v[16:31]
    ds_read_b64_tr_b16 a[24:25], v7 offset:4096
    ds_read_b64_tr_b16 a[26:27], v7 offset:4608
    s_waitcnt lgkmcnt(10)
    v_mfma_f32_32x32x16_bf16 v[16:31], a[0:3], v[240:243], v[16:31]
    ds_read_b64_tr_b16 a[28:29], v7 offset:6144
    ds_read_b64_tr_b16 a[30:31], v7 offset:6656
    v_mfma_f32_32x32x16_bf16 v[16:31], a[4:7], v[244:247], v[16:31]
    buffer_load_dwordx4 v69, s[4:7], s24 offen offset:1024 lds
    s_waitcnt vmcnt(19)
    s_barrier
    ds_read_b64_tr_b16 a[0:1], v7 offset:8192
    ds_read_b64_tr_b16 a[2:3], v7 offset:8704
    s_waitcnt lgkmcnt(10)
    v_mfma_f32_32x32x16_bf16 v[16:31], a[8:11], v[248:251], v[16:31]
    s_add_u32 s24, s24, s26
    ds_read_b64_tr_b16 a[4:5], v7 offset:10240
    ds_read_b64_tr_b16 a[6:7], v7 offset:10752
    v_mfma_f32_32x32x16_bf16 v[16:31], a[12:15], v[252:255], v[16:31]
    ds_read_b64_tr_b16 a[8:9], v7 offset:12288
    ds_read_b64_tr_b16 a[10:11], v7 offset:12800
    s_waitcnt lgkmcnt(10)
    v_mfma_f32_32x32x16_bf16 v[32:47], a[16:19], v[208:211], v[32:47]
    s_add_u32 m0, s28, 43008
    ds_read_b64_tr_b16 a[12:13], v7 offset:14336
    ds_read_b64_tr_b16 a[14:15], v7 offset:14848
    v_mfma_f32_32x32x16_bf16 v[32:47], a[20:23], v[212:215], v[32:47]
    buffer_load_dwordx4 v64, s[4:7], s24 offen offset:0 lds
    ds_read_b64_tr_b16 a[16:17], v7 offset:16384
    ds_read_b64_tr_b16 a[18:19], v7 offset:16896
    s_waitcnt lgkmcnt(10)
    v_mfma_f32_32x32x16_bf16 v[32:47], a[24:27], v[216:219], v[32:47]
    v_cvt_pk_bf16_f32 v48, v16, v17
    v_cvt_pk_bf16_f32 v49, v18, v19
    v_cvt_pk_bf16_f32 v50, v20, v21
    ds_read_b64_tr_b16 a[20:21], v7 offset:18432
    ds_read_b64_tr_b16 a[22:23], v7 offset:18944
    v_mfma_f32_32x32x16_bf16 v[32:47], a[28:31], v[220:223], v[32:47]
    v_cvt_pk_bf16_f32 v51, v22, v23
    v_cvt_pk_bf16_f32 v52, v24, v25
    ds_read_b64_tr_b16 a[24:25], v7 offset:20480
    ds_read_b64_tr_b16 a[26:27], v7 offset:20992
    s_waitcnt lgkmcnt(10)
    v_mfma_f32_32x32x16_bf16 v[32:47], a[0:3], v[224:227], v[32:47]
    v_cvt_pk_bf16_f32 v53, v26, v27
    v_cvt_pk_bf16_f32 v54, v28, v29
    v_cvt_pk_bf16_f32 v55, v30, v31
    ds_read_b64_tr_b16 a[28:29], v7 offset:22528
    ds_read_b64_tr_b16 a[30:31], v7 offset:23040
    v_mfma_f32_32x32x16_bf16 v[32:47], a[4:7], v[228:231], v[32:47]
    buffer_load_dwordx4 v65, s[4:7], s24 offen offset:1024 lds
    ds_read_b64_tr_b16 a[0:1], v4 offset:0
    ds_read_b64_tr_b16 a[2:3], v4 offset:512
    s_waitcnt lgkmcnt(10)
    v_mfma_f32_32x32x16_bf16 v[32:47], a[8:11], v[232:235], v[32:47]
    v_xor_b32 v7, 73728, v7
    ds_read_b64_tr_b16 a[4:5], v4 offset:2048
    ds_read_b64_tr_b16 a[6:7], v4 offset:2560
    v_mfma_f32_32x32x16_bf16 v[32:47], a[12:15], v[236:239], v[32:47]
    ds_read_b64_tr_b16 a[8:9], v4 offset:4096
    ds_read_b64_tr_b16 a[10:11], v4 offset:4608
    s_waitcnt lgkmcnt(10)
    v_mfma_f32_32x32x16_bf16 v[32:47], a[16:19], v[240:243], v[32:47]
    ds_read_b64_tr_b16 a[12:13], v4 offset:6144
    ds_read_b64_tr_b16 a[14:15], v4 offset:6656
    v_mfma_f32_32x32x16_bf16 v[32:47], a[20:23], v[244:247], v[32:47]
    buffer_load_dwordx4 v66, s[4:7], s24 offen offset:2048 lds
    ds_read_b64_tr_b16 a[16:17], v4 offset:8192
    ds_read_b64_tr_b16 a[18:19], v4 offset:8704
    s_waitcnt lgkmcnt(10)
    v_mfma_f32_32x32x16_bf16 v[32:47], a[24:27], v[248:251], v[32:47]
    ds_read_b64_tr_b16 a[20:21], v4 offset:10240
    ds_read_b64_tr_b16 a[22:23], v4 offset:10752
    v_mfma_f32_32x32x16_bf16 v[32:47], a[28:31], v[252:255], v[32:47]
    s_xor_b32 s28, s28, 73728
    s_xor_b32 s29, s29, 73728
    s_add_u32 s31, s31, 1
    s_cmp_lt_u32 s31, 6
    s_cbranch_scc1 Lp1_f3
    s_mov_b32 s56, 0x40000000
    v_pk_max_i16 v160, v48, 0
    v_pk_max_i16 v161, v49, 0
    v_pk_max_i16 v162, v50, 0
    v_pk_max_i16 v163, v51, 0
    v_pk_max_i16 v164, v52, 0
    v_pk_max_i16 v165, v53, 0
    v_pk_max_i16 v166, v54, 0
    v_pk_max_i16 v167, v55, 0
    buffer_store_dwordx4 v[48:51], v11, s[12:15], s56 offen
    buffer_store_dwordx4 v[48:51], v11, s[12:15], s56 offen
    buffer_store_dwordx4 v[48:51], v11, s[12:15], s56 offen
    buffer_store_dwordx4 v[48:51], v11, s[12:15], s56 offen
    v_xor_b32 v6, 64, v14
    v_xor_b32 v5, 64, v14
    s_mov_b32 s31, 0
    s_mov_b32 s30, 0
    s_mov_b32 s28, 0
    s_mov_b32 s29, 98304
    s_nop 3
    v_cvt_pk_bf16_f32 v56, v32, v33
    v_cvt_pk_bf16_f32 v57, v34, v35
    v_cvt_pk_bf16_f32 v58, v36, v37
    v_cvt_pk_bf16_f32 v59, v38, v39
    v_cvt_pk_bf16_f32 v60, v40, v41
    v_cvt_pk_bf16_f32 v61, v42, v43
    v_cvt_pk_bf16_f32 v62, v44, v45
    v_cvt_pk_bf16_f32 v63, v46, v47
    v_pk_max_i16 v168, v56, 0
    v_pk_max_i16 v169, v57, 0
    v_pk_max_i16 v170, v58, 0
    v_pk_max_i16 v171, v59, 0
    v_pk_max_i16 v172, v60, 0
    v_pk_max_i16 v173, v61, 0
    v_pk_max_i16 v174, v62, 0
    v_pk_max_i16 v175, v63, 0
    .p2align 6
Lp2_3:
    ds_read_b64_tr_b16 a[24:25], v4 offset:12288
    ds_read_b64_tr_b16 a[26:27], v4 offset:12800
    s_waitcnt lgkmcnt(10)
    v_mfma_f32_32x32x16_bf16 v[16:31], a[0:3], v[80:83], 0
    ds_read_b64_tr_b16 a[28:29], v4 offset:14336
    ds_read_b64_tr_b16 a[30:31], v4 offset:14848
    v_mfma_f32_32x32x16_bf16 v[16:31], a[4:7], v[84:87], v[16:31]
    buffer_load_dwordx4 v67, s[4:7], s24 offen offset:3072 lds
    ds_read_b64_tr_b16 a[0:1], v4 offset:16384
    ds_read_b64_tr_b16 a[2:3], v4 offset:16896
    s_waitcnt lgkmcnt(10)
    v_mfma_f32_32x32x16_bf16 v[16:31], a[8:11], v[88:91], v[16:31]
    v_cvt_pk_bf16_f32 v56, v32, v33
    v_cvt_pk_bf16_f32 v57, v34, v35
    v_cvt_pk_bf16_f32 v58, v36, v37
    ds_read_b64_tr_b16 a[4:5], v4 offset:18432
    ds_read_b64_tr_b16 a[6:7], v4 offset:18944
    v_mfma_f32_32x32x16_bf16 v[16:31], a[12:15], v[92:95], v[16:31]
    buffer_store_dwordx4 v[48:51], v11, s[12:15], s56 offen offset:0 sc0 sc1
    ds_read_b64_tr_b16 a[8:9], v4 offset:20480
    ds_read_b64_tr_b16 a[10:11], v4 offset:20992
    s_waitcnt lgkmcnt(10)
    v_mfma_f32_32x32x16_bf16 v[16:31], a[16:19], v[96:99], v[16:31]
    s_add_u32 m0, s29, 22528
    v_cvt_pk_bf16_f32 v59, v38, v39
    v_cvt_pk_bf16_f32 v60, v40, v41
    ds_read_b64_tr_b16 a[12:13], v4 offset:22528
    ds_read_b64_tr_b16 a[14:15], v4 offset:23040
    v_mfma_f32_32x32x16_bf16 v[16:31], a[20:23], v[100:103], v[16:31]
    buffer_load_dwordx4 v68, s[4:7], s24 offen offset:0 lds
    ds_read_b64_tr_b16 a[16:17], v5 offset:0
    ds_read_b64_tr_b16 a[18:19], v5 offset:512
    s_waitcnt lgkmcnt(10)
    v_mfma_f32_32x32x16_bf16 v[16:31], a[24:27], v[104:107], v[16:31]
    v_cvt_pk_bf16_f32 v61, v42, v43
    v_cvt_pk_bf16_f32 v62, v44, v45
    v_cvt_pk_bf16_f32 v63, v46, v47
    ds_read_b64_tr_b16 a[20:21], v5 offset:2048
    ds_read_b64_tr_b16 a[22:23], v5 offset:2560
    v_mfma_f32_32x32x16_bf16 v[16:31], a[28:31], v[108:111], v[16:31]
    buffer_store_dwordx4 v[52:55], v11, s[12:15], s56 offen offset:1024 sc0 sc1
    ds_read_b64_tr_b16 a[24:25], v5 offset:4096
    ds_read_b64_tr_b16 a[26:27], v5 offset:4608
    s_waitcnt lgkmcnt(10)
    v_mfma_f32_32x32x16_bf16 v[16:31], a[0:3], v[112:115], v[16:31]
    ds_read_b64_tr_b16 a[28:29], v5 offset:6144
    ds_read_b64_tr_b16 a[30:31], v5 offset:6656
    v_mfma_f32_32x32x16_bf16 v[16:31], a[4:7], v[116:119], v[16:31]
    buffer_load_dwordx4 v69, s[4:7], s24 offen offset:1024 lds
    s_waitcnt vmcnt(24)
    s_barrier
    ds_read_b64_tr_b16 a[0:1], v5 offset:8192
    ds_read_b64_tr_b16 a[2:3], v5 offset:8704
    s_waitcnt lgkmcnt(10)
    v_mfma_f32_32x32x16_bf16 v[16:31], a[8:11], v[120:123], v[16:31]
    s_add_u32 s24, s24, 221184
    ds_read_b64_tr_b16 a[4:5], v5 offset:10240
    ds_read_b64_tr_b16 a[6:7], v5 offset:10752
    v_mfma_f32_32x32x16_bf16 v[16:31], a[12:15], v[124:127], v[16:31]
    ds_read_b64_tr_b16 a[8:9], v5 offset:12288
    ds_read_b64_tr_b16 a[10:11], v5 offset:12800
    s_waitcnt lgkmcnt(10)
    v_mfma_f32_32x32x16_bf16 v[32:47], a[16:19], v[80:83], 0
    s_add_u32 m0, s29, 43008
    ds_read_b64_tr_b16 a[12:13], v5 offset:14336
    ds_read_b64_tr_b16 a[14:15], v5 offset:14848
    v_mfma_f32_32x32x16_bf16 v[32:47], a[20:23], v[84:87], v[32:47]
    buffer_load_dwordx4 v64, s[4:7], s24 offen offset:0 lds
    ds_read_b64_tr_b16 a[16:17], v5 offset:16384
    ds_read_b64_tr_b16 a[18:19], v5 offset:16896
    s_waitcnt lgkmcnt(10)
    v_mfma_f32_32x32x16_bf16 v[32:47], a[24:27], v[88:91], v[32:47]
    ds_read_b64_tr_b16 a[20:21], v5 offset:18432
    ds_read_b64_tr_b16 a[22:23], v5 offset:18944
    v_mfma_f32_32x32x16_bf16 v[32:47], a[28:31], v[92:95], v[32:47]
    buffer_store_dwordx4 v[56:59], v11, s[12:15], s56 offen offset:2048 sc0 sc1
    ds_read_b64_tr_b16 a[24:25], v5 offset:20480
    ds_read_b64_tr_b16 a[26:27], v5 offset:20992
    s_waitcnt lgkmcnt(10)
    v_mfma_f32_32x32x16_bf16 v[32:47], a[0:3], v[96:99], v[32:47]
    ds_read_b64_tr_b16 a[28:29], v5 offset:22528
    ds_read_b64_tr_b16 a[30:31], v5 offset:23040
    v_mfma_f32_32x32x16_bf16 v[32:47], a[4:7], v[100:103], v[32:47]
    buffer_load_dwordx4 v65, s[4:7], s24 offen offset:1024 lds
    ds_read_b64_tr_b16 a[0:1], v4 offset:24576
    ds_read_b64_tr_b16 a[2:3], v4 offset:25088
    s_waitcnt lgkmcnt(10)
    v_mfma_f32_32x32x16_bf16 v[32:47], a[8:11], v[104:107], v[32:47]
    ds_read_b64_tr_b16 a[4:5], v4 offset:26624
    ds_read_b64_tr_b16 a[6:7], v4 offset:27136
    v_mfma_f32_32x32x16_bf16 v[32:47], a[12:15], v[108:111], v[32:47]
    buffer_store_dwordx4 v[60:63], v11, s[12:15], s56 offen offset:3072 sc0 sc1
    ds_read_b64_tr_b16 a[8:9], v4 offset:28672
    ds_read_b64_tr_b16 a[10:11], v4 offset:29184
    s_waitcnt lgkmcnt(10)
    v_mfma_f32_32x32x16_bf16 v[32:47], a[16:19], v[112:115], v[32:47]
    ds_read_b64_tr_b16 a[12:13], v4 offset:30720
    ds_read_b64_tr_b16 a[14:15], v4 offset:31232
    v_mfma_f32_32x32x16_bf16 v[32:47], a[20:23], v[116:119], v[32:47]
    buffer_load_dwordx4 v66, s[4:7], s24 offen offset:2048 lds
    ds_read_b64_tr_b16 a[16:17], v4 offset:32768
    ds_read_b64_tr_b16 a[18:19], v4 offset:33280
    s_waitcnt lgkmcnt(10)
    v_mfma_f32_32x32x16_bf16 v[32:47], a[24:27], v[120:123], v[32:47]
    ds_read_b64_tr_b16 a[20:21], v4 offset:34816
    ds_read_b64_tr_b16 a[22:23], v4 offset:35328
    v_mfma_f32_32x32x16_bf16 v[32:47], a[28:31], v[124:127], v[32:47]
    ds_read_b64_tr_b16 a[24:25], v4 offset:36864
    ds_read_b64_tr_b16 a[26:27], v4 offset:37376
    s_waitcnt lgkmcnt(10)
    v_mfma_f32_32x32x16_bf16 v[16:31], a[0:3], v[128:131], v[16:31]
    s_add_u32 s30, s30, 49152
    s_cmp_eq_u32 s30, 147456
    s_cselect_b32 s30, 0, s30
    ds_read_b64_tr_b16 a[28:29], v4 offset:38912
    ds_read_b64_tr_b16 a[30:31], v4 offset:39424
    v_mfma_f32_32x32x16_bf16 v[16:31], a[4:7], v[132:135], v[16:31]
    buffer_load_dwordx4 v67, s[4:7], s24 offen offset:3072 lds
    ds_read_b64_tr_b16 a[0:1], v4 offset:40960
    ds_read_b64_tr_b16 a[2:3], v4 offset:41472
    s_waitcnt lgkmcnt(10)
    v_mfma_f32_32x32x16_bf16 v[16:31], a[8:11], v[136:139], v[16:31]
    s_mov_b32 s56, s58
    s_add_u32 s58, s58, 4096
    ds_read_b64_tr_b16 a[4:5], v4 offset:43008
    ds_read_b64_tr_b16 a[6:7], v4 offset:43520
    v_mfma_f32_32x32x16_bf16 v[16:31], a[12:15], v[140:143], v[16:31]
    ds_read_b64_tr_b16 a[8:9], v4 offset:45056
    ds_read_b64_tr_b16 a[10:11], v4 offset:45568
    s_waitcnt lgkmcnt(10)
    v_mfma_f32_32x32x16_bf16 v[16:31], a[16:19], v[144:147], v[16:31]
    s_add_u32 m0, s29, 47104
    ds_read_b64_tr_b16 a[12:13], v4 offset:47104
    ds_read_b64_tr_b16 a[14:15], v4 offset:47616
    v_mfma_f32_32x32x16_bf16 v[16:31], a[20:23], v[148:151], v[16:31]
    buffer_load_dwordx4 v68, s[4:7], s24 offen offset:0 lds
    ds_read_b64_tr_b16 a[16:17], v5 offset:24576
    ds_read_b64_tr_b16 a[18:19], v5 offset:25088
    s_waitcnt lgkmcnt(10)
    v_mfma_f32_32x32x16_bf16 v[16:31], a[24:27], v[152:155], v[16:31]
    ds_read_b64_tr_b16 a[20:21], v5 offset:26624
    ds_read_b64_tr_b16 a[22:23], v5 offset:27136
    v_mfma_f32_32x32x16_bf16 v[16:31], a[28:31], v[156:159], v[16:31]
    ds_read_b64_tr_b16 a[24:25], v5 offset:28672
    ds_read_b64_tr_b16 a[26:27], v5 offset:29184
    s_waitcnt lgkmcnt(10)
    v_mfma_f32_32x32x16_bf16 v[16:31], a[0:3], v[160:163], v[16:31]
    ds_read_b64_tr_b16 a[28:29], v5 offset:30720
    ds_read_b64_tr_b16 a[30:31], v5 offset:31232
    v_mfma_f32_32x32x16_bf16 v[16:31], a[4:7], v[164:167], v[16:31]
    buffer_load_dwordx4 v69, s[4:7], s24 offen offset:1024 lds
    s_waitcnt vmcnt(24)
    s_barrier
    ds_read_b64_tr_b16 a[0:1], v5 offset:32768
    ds_read_b64_tr_b16 a[2:3], v5 offset:33280
    s_waitcnt lgkmcnt(10)
    v_mfma_f32_32x32x16_bf16 v[16:31], a[8:11], v[168:171], v[16:31]
    s_add_u32 s24, s24, 4294746240
    ds_read_b64_tr_b16 a[4:5], v5 offset:34816
    ds_read_b64_tr_b16 a[6:7], v5 offset:35328
    v_mfma_f32_32x32x16_bf16 v[16:31], a[12:15], v[172:175], v[16:31]
    s_cmp_ge_u32 s31, 6
    s_cselect_b32 s6, 0, s6
    ds_read_b64_tr_b16 a[8:9], v5 offset:36864
    ds_read_b64_tr_b16 a[10:11], v5 offset:37376
    s_waitcnt lgkmcnt(10)
    v_mfma_f32_32x32x16_bf16 v[32:47], a[16:19], v[128:131], v[32:47]
    s_add_u32 m0, s28, 18432
    v_add_u32 v4, s30, v14
    ds_read_b64_tr_b16 a[12:13], v5 offset:38912
    ds_read_b64_tr_b16 a[14:15], v5 offset:39424
    v_mfma_f32_32x32x16_bf16 v[32:47], a[20:23], v[132:135], v[32:47]
    buffer_load_dwordx4 v64, s[4:7], s24 offen offset:0 lds
    ds_read_b64_tr_b16 a[16:17], v5 offset:40960
    ds_read_b64_tr_b16 a[18:19], v5 offset:41472
    s_waitcnt lgkmcnt(10)
    v_mfma_f32_32x32x16_bf16 v[32:47], a[24:27], v[136:139], v[32:47]
    v_cvt_pk_bf16_f32 v48, v16, v17
    v_cvt_pk_bf16_f32 v49, v18, v19
    v_cvt_pk_bf16_f32 v50, v20, v21
    ds_read_b64_tr_b16 a[20:21], v5 offset:43008
    ds_read_b64_tr_b16 a[22:23], v5 offset:43520
    v_mfma_f32_32x32x16_bf16 v[32:47], a[28:31], v[140:143], v[32:47]
    v_cvt_pk_bf16_f32 v51, v22, v23
    v_cvt_pk_bf16_f32 v52, v24, v25
    ds_read_b64_tr_b16 a[24:25], v5 offset:45056
    ds_read_b64_tr_b16 a[26:27], v5 offset:45568
    s_waitcnt lgkmcnt(10)
    v_mfma_f32_32x32x16_bf16 v[32:47], a[0:3], v[144:147], v[32:47]
    v_cvt_pk_bf16_f32 v53, v26, v27
    v_cvt_pk_bf16_f32 v54, v28, v29
    v_cvt_pk_bf16_f32 v55, v30, v31
    ds_read_b64_tr_b16 a[28:29], v5 offset:47104
    ds_read_b64_tr_b16 a[30:31], v5 offset:47616
    v_mfma_f32_32x32x16_bf16 v[32:47], a[4:7], v[148:151], v[32:47]
    buffer_load_dwordx4 v65, s[4:7], s24 offen offset:1024 lds
    ds_read_b64_tr_b16 a[0:1], v4 offset:0
    ds_read_b64_tr_b16 a[2:3], v4 offset:512
    s_waitcnt lgkmcnt(10)
    v_mfma_f32_32x32x16_bf16 v[32:47], a[8:11], v[152:155], v[32:47]
    v_add_u32 v5, s30, v6
    ds_read_b64_tr_b16 a[4:5], v4 offset:2048
    ds_read_b64_tr_b16 a[6:7], v4 offset:2560
    v_mfma_f32_32x32x16_bf16 v[32:47], a[12:15], v[156:159], v[32:47]
    ds_read_b64_tr_b16 a[8:9], v4 offset:4096
    ds_read_b64_tr_b16 a[10:11], v4 offset:4608
    s_waitcnt lgkmcnt(10)
    v_mfma_f32_32x32x16_bf16 v[32:47], a[16:19], v[160:163], v[32:47]
    ds_read_b64_tr_b16 a[12:13], v4 offset:6144
    ds_read_b64_tr_b16 a[14:15], v4 offset:6656
    v_mfma_f32_32x32x16_bf16 v[32:47], a[20:23], v[164:167], v[32:47]
    buffer_load_dwordx4 v66, s[4:7], s24 offen offset:2048 lds
    ds_read_b64_tr_b16 a[16:17], v4 offset:8192
    ds_read_b64_tr_b16 a[18:19], v4 offset:8704
    s_waitcnt lgkmcnt(10)
    v_mfma_f32_32x32x16_bf16 v[32:47], a[24:27], v[168:171], v[32:47]
    ds_read_b64_tr_b16 a[20:21], v4 offset:10240
    ds_read_b64_tr_b16 a[22:23], v4 offset:10752
    v_mfma_f32_32x32x16_bf16 v[32:47], a[28:31], v[172:175], v[32:47]
    s_mov_b32 s29, s28
    s_mov_b32 s28, s30
    s_add_u32 s31, s31, 1
    s_cmp_lt_u32 s31, 9
    s_cbranch_scc1 Lp2_3
Lffn_end:
    buffer_store_dwordx4 v[48:51], v11, s[12:15], s56 offen offset:0 sc0 sc1
    buffer_store_dwordx4 v[52:55], v11, s[12:15], s56 offen offset:1024 sc0 sc1
    s_nop 7
    s_nop 3
    v_cvt_pk_bf16_f32 v56, v32, v33
    v_cvt_pk_bf16_f32 v57, v34, v35
    v_cvt_pk_bf16_f32 v58, v36, v37
    v_cvt_pk_bf16_f32 v59, v38, v39
    v_cvt_pk_bf16_f32 v60, v40, v41
    v_cvt_pk_bf16_f32 v61, v42, v43
    v_cvt_pk_bf16_f32 v62, v44, v45
    v_cvt_pk_bf16_f32 v63, v46, v47
    buffer_store_dwordx4 v[56:59], v11, s[12:15], s56 offen offset:2048 sc0 sc1
    buffer_store_dwordx4 v[60:63], v11, s[12:15], s56 offen offset:3072 sc0 sc1
    s_lshl_b32 s54, s21, 2
    s_add_u32 s54, s54, s20
    s_mul_i32 s54, s54, 36864
    v_mul_u32_u24 v4, 1152, v2
    v_lshl_add_u32 v4, v3, 5, v4
    s_add_u32 s56, s22, 0
    s_and_b32 s25, s56, 1
    s_lshl_b32 s25, s25, 4
    s_lshr_b32 s56, s56, 1
    s_lshl_b32 s56, s56, 6
    s_add_u32 s25, s25, s56
    s_add_u32 s25, s25, s54
    s_add_u32 s56, s22, 12
    s_and_b32 s26, s56, 1
    s_lshl_b32 s26, s26, 4
    s_lshr_b32 s56, s56, 1
    s_lshl_b32 s56, s56, 6
    s_add_u32 s26, s26, s56
    s_add_u32 s26, s26, s54
    s_add_u32 s56, s22, 24
    s_and_b32 s27, s56, 1
    s_lshl_b32 s27, s27, 4
    s_lshr_b32 s56, s56, 1
    s_lshl_b32 s56, s56, 6
    s_add_u32 s27, s27, s56
    s_add_u32 s27, s27, s54
    s_mov_b32 s44, s76
    s_and_b32 s45, s77, 0xffff
    s_mov_b32 s46, 2359296
    s_mov_b32 s47, 0x00020000
    s_lshl_b32 s54, s21, 6
    s_add_u32 s54, s54, s20
    s_mul_i32 s24, s54, 36864
    s_lshl_b32 s54, s22, 10
    s_add_u32 s24, s24, s54
    s_waitcnt vmcnt(0)
    s_barrier
    s_cmp_eq_u32 s20, 0
    s_cbranch_scc0 Lnosig_f
    v_accvgpr_read_b32 v78, a60
    s_nop 1
    v_cmp_eq_u32 vcc, 1, v78
    s_nop 3
    s_cmp_eq_u32 vcc_lo, -1
    s_cbranch_scc1 Lrdy_f
    s_lshl_b32 s62, s21, 4
    s_mov_b32 s61, 0x4000
Lpoll_rf:
    buffer_load_dword v76, off, s[16:19], s62 sc0 sc1
    s_waitcnt vmcnt(0)
    v_readfirstlane_b32 s56, v76
    s_nop 3
    s_and_b32 s56, s56, 1
    s_cmp_eq_u32 s56, 1
    s_cbranch_scc1 Lpollok_rf
    s_sleep 4
    s_sub_u32 s61, s61, 1
    s_cbranch_scc0 Lpoll_rf
Lpollok_rf:
Lrdy_f:
    s_mul_i32 s62, s21, 1536
    s_lshl_b32 s63, s22, 2
    s_add_u32 s62, s62, s63
    s_add_u32 s62, s62, 38338560
    v_lshlrev_b32 v77, 7, v1
    v_mov_b32 v79, 1073741824
    v_cmp_gt_u32 vcc, 12, v1
    s_nop 1
    v_cndmask_b32 v77, v79, v77, vcc
    v_mov_b32 v76, 7
    buffer_store_dword v76, v77, s[12:15], s62 offen sc0 sc1
Lnosig_f:
    s_mul_i32 s57, s21, 12
    s_add_u32 s57, s57, s22
    s_lshl_b32 s57, s57, 7
    s_add_u32 s57, s57, 38338560
    v_and_b32 v5, 15, v1
    v_lshlrev_b32 v5, 2, v5
    buffer_load_dwordx4 v[16:19], v4, s[8:11], s25 offen
    buffer_load_dwordx4 v[20:23], v4, s[8:11], s26 offen
    buffer_load_dwordx4 v[24:27], v4, s[8:11], s27 offen
    v_mov_b32 v28, 0
    v_mov_b32 v29, 0
    v_mov_b32 v30, 0
    v_mov_b32 v31, 0
    v_mov_b32 v32, 0
    v_mov_b32 v33, 0
    v_mov_b32 v34, 0
    v_mov_b32 v35, 0
    v_mov_b32 v36, 0
    v_mov_b32 v37, 0
    v_mov_b32 v38, 0
    v_mov_b32 v39, 0
    v_mov_b32 v40, 0
    v_mov_b32 v41, 0
    v_mov_b32 v42, 0
    v_mov_b32 v43, 0
    v_mov_b32 v44, 0
    v_mov_b32 v45, 0
    v_mov_b32 v46, 0
    v_mov_b32 v47, 0
    v_mov_b32 v48, 0
    v_mov_b32 v49, 0
    v_mov_b32 v50, 0
    v_mov_b32 v51, 0
    v_mov_b32 v52, 0
    v_mov_b32 v53, 0
    v_mov_b32 v54, 0
    v_mov_b32 v55, 0
    v_mov_b32 v56, 0
    v_mov_b32 v57, 0
    v_mov_b32 v58, 0
    v_mov_b32 v59, 0
    v_mov_b32 v60, 0
    v_mov_b32 v61, 0
    v_mov_b32 v62, 0
    v_mov_b32 v63, 0
    v_mov_b32 v64, 0
    v_mov_b32 v65, 0
    v_mov_b32 v66, 0
    v_mov_b32 v67, 0
    v_mov_b32 v68, 0
    v_mov_b32 v69, 0
    v_mov_b32 v70, 0
    v_mov_b32 v71, 0
    v_mov_b32 v72, 0
    v_mov_b32 v73, 0
    v_mov_b32 v74, 0
    v_mov_b32 v75, 0
    s_cmp_eq_u32 s20, 0
    s_cbranch_scc0 Lpollok_f0
    s_mov_b32 s61, 0x4000
Lpoll_f0:
    buffer_load_dword v6, v5, s[12:15], s57 offen sc0 sc1
    s_waitcnt vmcnt(0)
    v_and_b32 v6, 1, v6
    v_cmp_ne_u32 vcc, 0, v6
    s_nop 3
    s_and_b32 s56, vcc_lo, 0xfff
    s_cmp_eq_u32 s56, 0xfff
    s_cbranch_scc1 Lpollok_f0
    s_sleep 2
    s_sub_u32 s61, s61, 1
    s_cbranch_scc0 Lpoll_f0
Lpollok_f0:
    s_barrier
    s_add_u32 s54, s24, 0
    buffer_load_dwordx4 v[80:83], v11, s[12:15], s54 offen sc0 sc1
    s_add_u32 s54, s54, 147456
    buffer_load_dwordx4 v[92:95], v11, s[12:15], s54 offen sc0 sc1
    s_add_u32 s54, s54, 147456
    buffer_load_dwordx4 v[104:107], v11, s[12:15], s54 offen sc0 sc1
    s_add_u32 s54, s54, 147456
    buffer_load_dwordx4 v[116:119], v11, s[12:15], s54 offen sc0 sc1
    s_add_u32 s54, s54, 147456
    buffer_load_dwordx4 v[128:131], v11, s[12:15], s54 offen sc0 sc1
    s_add_u32 s54, s54, 147456
    buffer_load_dwordx4 v[140:143], v11, s[12:15], s54 offen sc0 sc1
    s_add_u32 s54, s54, 147456
    buffer_load_dwordx4 v[152:155], v11, s[12:15], s54 offen sc0 sc1
    s_add_u32 s54, s54, 147456
    buffer_load_dwordx4 v[164:167], v11, s[12:15], s54 offen sc0 sc1
    s_add_u32 s54, s54, 147456
    buffer_load_dwordx4 v[176:179], v11, s[12:15], s54 offen sc0 sc1
    s_add_u32 s54, s54, 147456
    buffer_load_dwordx4 v[188:191], v11, s[12:15], s54 offen sc0 sc1
    s_add_u32 s54, s54, 147456
    buffer_load_dwordx4 v[200:203], v11, s[12:15], s54 offen sc0 sc1
    s_add_u32 s54, s54, 147456
    buffer_load_dwordx4 v[212:215], v11, s[12:15], s54 offen sc0 sc1
    s_cmp_eq_u32 s20, 0
    s_cbranch_scc0 Lpollok_f1
    s_mov_b32 s61, 0x4000
Lpoll_f1:
    buffer_load_dword v6, v5, s[12:15], s57 offen sc0 sc1
    s_waitcnt vmcnt(0)
    v_and_b32 v6, 2, v6
    v_cmp_ne_u32 vcc, 0, v6
    s_nop 3
    s_and_b32 s56, vcc_lo, 0xfff
    s_cmp_eq_u32 s56, 0xfff
    s_cbranch_scc1 Lpollok_f1
    s_sleep 2
    s_sub_u32 s61, s61, 1
    s_cbranch_scc0 Lpoll_f1
Lpollok_f1:
    s_barrier
    s_add_u32 s54, s24, 12288
    buffer_load_dwordx4 v[84:87], v11, s[12:15], s54 offen sc0 sc1
    s_add_u32 s54, s54, 147456
    buffer_load_dwordx4 v[96:99], v11, s[12:15], s54 offen sc0 sc1
    s_add_u32 s54, s54, 147456
    buffer_load_dwordx4 v[108:111], v11, s[12:15], s54 offen sc0 sc1
    s_add_u32 s54, s54, 147456
    buffer_load_dwordx4 v[120:123], v11, s[12:15], s54 offen sc0 sc1
    s_add_u32 s54, s54, 147456
    buffer_load_dwordx4 v[132:135], v11, s[12:15], s54 offen sc0 sc1
    s_add_u32 s54, s54, 147456
    buffer_load_dwordx4 v[144:147], v11, s[12:15], s54 offen sc0 sc1
    s_add_u32 s54, s54, 147456
    buffer_load_dwordx4 v[156:159], v11, s[12:15], s54 offen sc0 sc1
    s_add_u32 s54, s54, 147456
    buffer_load_dwordx4 v[168:171], v11, s[12:15], s54 offen sc0 sc1
    s_add_u32 s54, s54, 147456
    buffer_load_dwordx4 v[180:183], v11, s[12:15], s54 offen sc0 sc1
    s_add_u32 s54, s54, 147456
    buffer_load_dwordx4 v[192:195], v11, s[12:15], s54 offen sc0 sc1
    s_add_u32 s54, s54, 147456
    buffer_load_dwordx4 v[204:207], v11, s[12:15], s54 offen sc0 sc1
    s_add_u32 s54, s54, 147456
    buffer_load_dwordx4 v[216:219], v11, s[12:15], s54 offen sc0 sc1
    s_cmp_eq_u32 s20, 0
    s_cbranch_scc0 Lpollok_f2
    s_mov_b32 s61, 0x4000
Lpoll_f2:
    buffer_load_dword v6, v5, s[12:15], s57 offen sc0 sc1
    s_waitcnt vmcnt(0)
    v_and_b32 v6, 4, v6
    v_cmp_ne_u32 vcc, 0, v6
    s_nop 3
    s_and_b32 s56, vcc_lo, 0xfff
    s_cmp_eq_u32 s56, 0xfff
    s_cbranch_scc1 Lpollok_f2
    s_sleep 2
    s_sub_u32 s61, s61, 1
    s_cbranch_scc0 Lpoll_f2
Lpollok_f2:
    s_barrier
    s_add_u32 s54, s24, 24576
    buffer_load_dwordx4 v[88:91], v11, s[12:15], s54 offen sc0 sc1
    s_add_u32 s54, s54, 147456
    buffer_load_dwordx4 v[100:103], v11, s[12:15], s54 offen sc0 sc1
    s_add_u32 s54, s54, 147456
    buffer_load_dwordx4 v[112:115], v11, s[12:15], s54 offen sc0 sc1
    s_add_u32 s54, s54, 147456
    buffer_load_dwordx4 v[124:127], v11, s[12:15], s54 offen sc0 sc1
    s_add_u32 s54, s54, 147456
    buffer_load_dwordx4 v[136:139], v11, s[12:15], s54 offen sc0 sc1
    s_add_u32 s54, s54, 147456
    buffer_load_dwordx4 v[148:151], v11, s[12:15], s54 offen sc0 sc1
    s_add_u32 s54, s54, 147456
    buffer_load_dwordx4 v[160:163], v11, s[12:15], s54 offen sc0 sc1
    s_add_u32 s54, s54, 147456
    buffer_load_dwordx4 v[172:175], v11, s[12:15], s54 offen sc0 sc1
    s_add_u32 s54, s54, 147456
    buffer_load_dwordx4 v[184:187], v11, s[12:15], s54 offen sc0 sc1
    s_add_u32 s54, s54, 147456
    buffer_load_dwordx4 v[196:199], v11, s[12:15], s54 offen sc0 sc1
    s_add_u32 s54, s54, 147456
    buffer_load_dwordx4 v[208:211], v11, s[12:15], s54 offen sc0 sc1
    s_add_u32 s54, s54, 147456
    buffer_load_dwordx4 v[220:223], v11, s[12:15], s54 offen sc0 sc1
    s_waitcnt vmcnt(35)
    v_dot2c_f32_bf16 v28, s42, v80
    v_dot2c_f32_bf16 v29, s43, v80
    v_dot2c_f32_bf16 v30, s42, v81
    v_dot2c_f32_bf16 v31, s43, v81
    v_dot2c_f32_bf16 v32, s42, v82
    v_dot2c_f32_bf16 v33, s43, v82
    v_dot2c_f32_bf16 v34, s42, v83
    v_dot2c_f32_bf16 v35, s43, v83
    s_waitcnt vmcnt(34)
    v_dot2c_f32_bf16 v28, s42, v92
    v_dot2c_f32_bf16 v29, s43, v92
    v_dot2c_f32_bf16 v30, s42, v93
    v_dot2c_f32_bf16 v31, s43, v93
    v_dot2c_f32_bf16 v32, s42, v94
    v_dot2c_f32_bf16 v33, s43, v94
    v_dot2c_f32_bf16 v34, s42, v95
    v_dot2c_f32_bf16 v35, s43, v95
    s_waitcnt vmcnt(33)
    v_dot2c_f32_bf16 v28, s42, v104
    v_dot2c_f32_bf16 v29, s43, v104
    v_dot2c_f32_bf16 v30, s42, v105
    v_dot2c_f32_bf16 v31, s43, v105
    v_dot2c_f32_bf16 v32, s42, v106
    v_dot2c_f32_bf16 v33, s43, v106
    v_dot2c_f32_bf16 v34, s42, v107
    v_dot2c_f32_bf16 v35, s43, v107
    s_waitcnt vmcnt(32)
    v_dot2c_f32_bf16 v28, s42, v116
    v_dot2c_f32_bf16 v29, s43, v116
    v_dot2c_f32_bf16 v30, s42, v117
    v_dot2c_f32_bf16 v31, s43, v117
    v_dot2c_f32_bf16 v32, s42, v118
    v_dot2c_f32_bf16 v33, s43, v118
    v_dot2c_f32_bf16 v34, s42, v119
    v_dot2c_f32_bf16 v35, s43, v119
    s_waitcnt vmcnt(31)
    v_dot2c_f32_bf16 v28, s42, v128
    v_dot2c_f32_bf16 v29, s43, v128
    v_dot2c_f32_bf16 v30, s42, v129
    v_dot2c_f32_bf16 v31, s43, v129
    v_dot2c_f32_bf16 v32, s42, v130
    v_dot2c_f32_bf16 v33, s43, v130
    v_dot2c_f32_bf16 v34, s42, v131
    v_dot2c_f32_bf16 v35, s43, v131
    s_waitcnt vmcnt(30)
    v_dot2c_f32_bf16 v28, s42, v140
    v_dot2c_f32_bf16 v29, s43, v140
    v_dot2c_f32_bf16 v30, s42, v141
    v_dot2c_f32_bf16 v31, s43, v141
    v_dot2c_f32_bf16 v32, s42, v142
    v_dot2c_f32_bf16 v33, s43, v142
    v_dot2c_f32_bf16 v34, s42, v143
    v_dot2c_f32_bf16 v35, s43, v143
    s_waitcnt vmcnt(29)
    v_dot2c_f32_bf16 v28, s42, v152
    v_dot2c_f32_bf16 v29, s43, v152
    v_dot2c_f32_bf16 v30, s42, v153
    v_dot2c_f32_bf16 v31, s43, v153
    v_dot2c_f32_bf16 v32, s42, v154
    v_dot2c_f32_bf16 v33, s43, v154
    v_dot2c_f32_bf16 v34, s42, v155
    v_dot2c_f32_bf16 v35, s43, v155
    s_waitcnt vmcnt(28)
    v_dot2c_f32_bf16 v28, s42, v164
    v_dot2c_f32_bf16 v29, s43, v164
    v_dot2c_f32_bf16 v30, s42, v165
    v_dot2c_f32_bf16 v31, s43, v165
    v_dot2c_f32_bf16 v32, s42, v166
    v_dot2c_f32_bf16 v33, s43, v166
    v_dot2c_f32_bf16 v34, s42, v167
    v_dot2c_f32_bf16 v35, s43, v167
    s_waitcnt vmcnt(27)
    v_dot2c_f32_bf16 v28, s42, v176
    v_dot2c_f32_bf16 v29, s43, v176
    v_dot2c_f32_bf16 v30, s42, v177
    v_dot2c_f32_bf16 v31, s43, v177
    v_dot2c_f32_bf16 v32, s42, v178
    v_dot2c_f32_bf16 v33, s43, v178
    v_dot2c_f32_bf16 v34, s42, v179
    v_dot2c_f32_bf16 v35, s43, v179
    s_waitcnt vmcnt(26)
    v_dot2c_f32_bf16 v28, s42, v188
    v_dot2c_f32_bf16 v29, s43, v188
    v_dot2c_f32_bf16 v30, s42, v189
    v_dot2c_f32_bf16 v31, s43, v189
    v_dot2c_f32_bf16 v32, s42, v190
    v_dot2c_f32_bf16 v33, s43, v190
    v_dot2c_f32_bf16 v34, s42, v191
    v_dot2c_f32_bf16 v35, s43, v191
    s_waitcnt vmcnt(25)
    v_dot2c_f32_bf16 v28, s42, v200
    v_dot2c_f32_bf16 v29, s43, v200
    v_dot2c_f32_bf16 v30, s42, v201
    v_dot2c_f32_bf16 v31, s43, v201
    v_dot2c_f32_bf16 v32, s42, v202
    v_dot2c_f32_bf16 v33, s43, v202
    v_dot2c_f32_bf16 v34, s42, v203
    v_dot2c_f32_bf16 v35, s43, v203
    s_waitcnt vmcnt(24)
    v_dot2c_f32_bf16 v28, s42, v212
    v_dot2c_f32_bf16 v29, s43, v212
    v_dot2c_f32_bf16 v30, s42, v213
    v_dot2c_f32_bf16 v31, s43, v213
    v_dot2c_f32_bf16 v32, s42, v214
    v_dot2c_f32_bf16 v33, s43, v214
    v_dot2c_f32_bf16 v34, s42, v215
    v_dot2c_f32_bf16 v35, s43, v215
    s_waitcnt vmcnt(23)
    v_dot2c_f32_bf16 v36, s42, v84
    v_dot2c_f32_bf16 v37, s43, v84
    v_dot2c_f32_bf16 v38, s42, v85
    v_dot2c_f32_bf16 v39, s43, v85
    v_dot2c_f32_bf16 v40, s42, v86
    v_dot2c_f32_bf16 v41, s43, v86
    v_dot2c_f32_bf16 v42, s42, v87
    v_dot2c_f32_bf16 v43, s43, v87
    s_waitcnt vmcnt(22)
    v_dot2c_f32_bf16 v36, s42, v96
    v_dot2c_f32_bf16 v37, s43, v96
    v_dot2c_f32_bf16 v38, s42, v97
    v_dot2c_f32_bf16 v39, s43, v97
    v_dot2c_f32_bf16 v40, s42, v98
    v_dot2c_f32_bf16 v41, s43, v98
    v_dot2c_f32_bf16 v42, s42, v99
    v_dot2c_f32_bf16 v43, s43, v99
    s_waitcnt vmcnt(21)
    v_dot2c_f32_bf16 v36, s42, v108
    v_dot2c_f32_bf16 v37, s43, v108
    v_dot2c_f32_bf16 v38, s42, v109
    v_dot2c_f32_bf16 v39, s43, v109
    v_dot2c_f32_bf16 v40, s42, v110
    v_dot2c_f32_bf16 v41, s43, v110
    v_dot2c_f32_bf16 v42, s42, v111
    v_dot2c_f32_bf16 v43, s43, v111
    s_waitcnt vmcnt(20)
    v_dot2c_f32_bf16 v36, s42, v120
    v_dot2c_f32_bf16 v37, s43, v120
    v_dot2c_f32_bf16 v38, s42, v121
    v_dot2c_f32_bf16 v39, s43, v121
    v_dot2c_f32_bf16 v40, s42, v122
    v_dot2c_f32_bf16 v41, s43, v122
    v_dot2c_f32_bf16 v42, s42, v123
    v_dot2c_f32_bf16 v43, s43, v123
    s_waitcnt vmcnt(19)
    v_dot2c_f32_bf16 v36, s42, v132
    v_dot2c_f32_bf16 v37, s43, v132
    v_dot2c_f32_bf16 v38, s42, v133
    v_dot2c_f32_bf16 v39, s43, v133
    v_dot2c_f32_bf16 v40, s42, v134
    v_dot2c_f32_bf16 v41, s43, v134
    v_dot2c_f32_bf16 v42, s42, v135
    v_dot2c_f32_bf16 v43, s43, v135
    s_waitcnt vmcnt(18)
    v_dot2c_f32_bf16 v36, s42, v144
    v_dot2c_f32_bf16 v37, s43, v144
    v_dot2c_f32_bf16 v38, s42, v145
    v_dot2c_f32_bf16 v39, s43, v145
    v_dot2c_f32_bf16 v40, s42, v146
    v_dot2c_f32_bf16 v41, s43, v146
    v_dot2c_f32_bf16 v42, s42, v147
    v_dot2c_f32_bf16 v43, s43, v147
    s_waitcnt vmcnt(17)
    v_dot2c_f32_bf16 v36, s42, v156
    v_dot2c_f32_bf16 v37, s43, v156
    v_dot2c_f32_bf16 v38, s42, v157
    v_dot2c_f32_bf16 v39, s43, v157
    v_dot2c_f32_bf16 v40, s42, v158
    v_dot2c_f32_bf16 v41, s43, v158
    v_dot2c_f32_bf16 v42, s42, v159
    v_dot2c_f32_bf16 v43, s43, v159
    s_waitcnt vmcnt(16)
    v_dot2c_f32_bf16 v36, s42, v168
    v_dot2c_f32_bf16 v37, s43, v168
    v_dot2c_f32_bf16 v38, s42, v169
    v_dot2c_f32_bf16 v39, s43, v169
    v_dot2c_f32_bf16 v40, s42, v170
    v_dot2c_f32_bf16 v41, s43, v170
    v_dot2c_f32_bf16 v42, s42, v171
    v_dot2c_f32_bf16 v43, s43, v171
    s_waitcnt vmcnt(15)
    v_dot2c_f32_bf16 v36, s42, v180
    v_dot2c_f32_bf16 v37, s43, v180
    v_dot2c_f32_bf16 v38, s42, v181
    v_dot2c_f32_bf16 v39, s43, v181
    v_dot2c_f32_bf16 v40, s42, v182
    v_dot2c_f32_bf16 v41, s43, v182
    v_dot2c_f32_bf16 v42, s42, v183
    v_dot2c_f32_bf16 v43, s43, v183
    s_waitcnt vmcnt(14)
    v_dot2c_f32_bf16 v36, s42, v192
    v_dot2c_f32_bf16 v37, s43, v192
    v_dot2c_f32_bf16 v38, s42, v193
    v_dot2c_f32_bf16 v39, s43, v193
    v_dot2c_f32_bf16 v40, s42, v194
    v_dot2c_f32_bf16 v41, s43, v194
    v_dot2c_f32_bf16 v42, s42, v195
    v_dot2c_f32_bf16 v43, s43, v195
    s_waitcnt vmcnt(13)
    v_dot2c_f32_bf16 v36, s42, v204
    v_dot2c_f32_bf16 v37, s43, v204
    v_dot2c_f32_bf16 v38, s42, v205
    v_dot2c_f32_bf16 v39, s43, v205
    v_dot2c_f32_bf16 v40, s42, v206
    v_dot2c_f32_bf16 v41, s43, v206
    v_dot2c_f32_bf16 v42, s42, v207
    v_dot2c_f32_bf16 v43, s43, v207
    s_waitcnt vmcnt(12)
    v_dot2c_f32_bf16 v36, s42, v216
    v_dot2c_f32_bf16 v37, s43, v216
    v_dot2c_f32_bf16 v38, s42, v217
    v_dot2c_f32_bf16 v39, s43, v217
    v_dot2c_f32_bf16 v40, s42, v218
    v_dot2c_f32_bf16 v41, s43, v218
    v_dot2c_f32_bf16 v42, s42, v219
    v_dot2c_f32_bf16 v43, s43, v219
    s_waitcnt vmcnt(11)
    v_dot2c_f32_bf16 v44, s42, v88
    v_dot2c_f32_bf16 v45, s43, v88
    v_dot2c_f32_bf16 v46, s42, v89
    v_dot2c_f32_bf16 v47, s43, v89
    v_dot2c_f32_bf16 v48, s42, v90
    v_dot2c_f32_bf16 v49, s43, v90
    v_dot2c_f32_bf16 v50, s42, v91
    v_dot2c_f32_bf16 v51, s43, v91
    s_waitcnt vmcnt(10)
    v_dot2c_f32_bf16 v44, s42, v100
    v_dot2c_f32_bf16 v45, s43, v100
    v_dot2c_f32_bf16 v46, s42, v101
    v_dot2c_f32_bf16 v47, s43, v101
    v_dot2c_f32_bf16 v48, s42, v102
    v_dot2c_f32_bf16 v49, s43, v102
    v_dot2c_f32_bf16 v50, s42, v103
    v_dot2c_f32_bf16 v51, s43, v103
    s_waitcnt vmcnt(9)
    v_dot2c_f32_bf16 v44, s42, v112
    v_dot2c_f32_bf16 v45, s43, v112
    v_dot2c_f32_bf16 v46, s42, v113
    v_dot2c_f32_bf16 v47, s43, v113
    v_dot2c_f32_bf16 v48, s42, v114
    v_dot2c_f32_bf16 v49, s43, v114
    v_dot2c_f32_bf16 v50, s42, v115
    v_dot2c_f32_bf16 v51, s43, v115
    s_waitcnt vmcnt(8)
    v_dot2c_f32_bf16 v44, s42, v124
    v_dot2c_f32_bf16 v45, s43, v124
    v_dot2c_f32_bf16 v46, s42, v125
    v_dot2c_f32_bf16 v47, s43, v125
    v_dot2c_f32_bf16 v48, s42, v126
    v_dot2c_f32_bf16 v49, s43, v126
    v_dot2c_f32_bf16 v50, s42, v127
    v_dot2c_f32_bf16 v51, s43, v127
    s_waitcnt vmcnt(7)
    v_dot2c_f32_bf16 v44, s42, v136
    v_dot2c_f32_bf16 v45, s43, v136
    v_dot2c_f32_bf16 v46, s42, v137
    v_dot2c_f32_bf16 v47, s43, v137
    v_dot2c_f32_bf16 v48, s42, v138
    v_dot2c_f32_bf16 v49, s43, v138
    v_dot2c_f32_bf16 v50, s42, v139
    v_dot2c_f32_bf16 v51, s43, v139
    s_waitcnt vmcnt(6)
    v_dot2c_f32_bf16 v44, s42, v148
    v_dot2c_f32_bf16 v45, s43, v148
    v_dot2c_f32_bf16 v46, s42, v149
    v_dot2c_f32_bf16 v47, s43, v149
    v_dot2c_f32_bf16 v48, s42, v150
    v_dot2c_f32_bf16 v49, s43, v150
    v_dot2c_f32_bf16 v50, s42, v151
    v_dot2c_f32_bf16 v51, s43, v151
    s_waitcnt vmcnt(5)
    v_dot2c_f32_bf16 v44, s42, v160
    v_dot2c_f32_bf16 v45, s43, v160
    v_dot2c_f32_bf16 v46, s42, v161
    v_dot2c_f32_bf16 v47, s43, v161
    v_dot2c_f32_bf16 v48, s42, v162
    v_dot2c_f32_bf16 v49, s43, v162
    v_dot2c_f32_bf16 v50, s42, v163
    v_dot2c_f32_bf16 v51, s43, v163
    s_waitcnt vmcnt(4)
    v_dot2c_f32_bf16 v44, s42, v172
    v_dot2c_f32_bf16 v45, s43, v172
    v_dot2c_f32_bf16 v46, s42, v173
    v_dot2c_f32_bf16 v47, s43, v173
    v_dot2c_f32_bf16 v48, s42, v174
    v_dot2c_f32_bf16 v49, s43, v174
    v_dot2c_f32_bf16 v50, s42, v175
    v_dot2c_f32_bf16 v51, s43, v175
    s_waitcnt vmcnt(3)
    v_dot2c_f32_bf16 v44, s42, v184
    v_dot2c_f32_bf16 v45, s43, v184
    v_dot2c_f32_bf16 v46, s42, v185
    v_dot2c_f32_bf16 v47, s43, v185
    v_dot2c_f32_bf16 v48, s42, v186
    v_dot2c_f32_bf16 v49, s43, v186
    v_dot2c_f32_bf16 v50, s42, v187
    v_dot2c_f32_bf16 v51, s43, v187
    s_waitcnt vmcnt(2)
    v_dot2c_f32_bf16 v44, s42, v196
    v_dot2c_f32_bf16 v45, s43, v196
    v_dot2c_f32_bf16 v46, s42, v197
    v_dot2c_f32_bf16 v47, s43, v197
    v_dot2c_f32_bf16 v48, s42, v198
    v_dot2c_f32_bf16 v49, s43, v198
    v_dot2c_f32_bf16 v50, s42, v199
    v_dot2c_f32_bf16 v51, s43, v199
    s_waitcnt vmcnt(1)
    v_dot2c_f32_bf16 v44, s42, v208
    v_dot2c_f32_bf16 v45, s43, v208
    v_dot2c_f32_bf16 v46, s42, v209
    v_dot2c_f32_bf16 v47, s43, v209
    v_dot2c_f32_bf16 v48, s42, v210
    v_dot2c_f32_bf16 v49, s43, v210
    v_dot2c_f32_bf16 v50, s42, v211
    v_dot2c_f32_bf16 v51, s43, v211
    s_waitcnt vmcnt(0)
    v_dot2c_f32_bf16 v44, s42, v220
    v_dot2c_f32_bf16 v45, s43, v220
    v_dot2c_f32_bf16 v46, s42, v221
    v_dot2c_f32_bf16 v47, s43, v221
    v_dot2c_f32_bf16 v48, s42, v222
    v_dot2c_f32_bf16 v49, s43, v222
    v_dot2c_f32_bf16 v50, s42, v223
    v_dot2c_f32_bf16 v51, s43, v223
    s_nop 2
    v_mul_f32 v28, v28, v10
    v_mul_f32 v29, v29, v10
    v_mul_f32 v30, v30, v10
    v_mul_f32 v31, v31, v10
    v_mul_f32 v32, v32, v10
    v_mul_f32 v33, v33, v10
    v_mul_f32 v34, v34, v10
    v_mul_f32 v35, v35, v10
    v_mul_f32 v36, v36, v10
    v_mul_f32 v37, v37, v10
    v_mul_f32 v38, v38, v10
    v_mul_f32 v39, v39, v10
    v_mul_f32 v40, v40, v10
    v_mul_f32 v41, v41, v10
    v_mul_f32 v42, v42, v10
    v_mul_f32 v43, v43, v10
    v_mul_f32 v44, v44, v10
    v_mul_f32 v45, v45, v10
    v_mul_f32 v46, v46, v10
    v_mul_f32 v47, v47, v10
    v_mul_f32 v48, v48, v10
    v_mul_f32 v49, v49, v10
    v_mul_f32 v50, v50, v10
    v_mul_f32 v51, v51, v10
    v_cvt_pk_bf16_f32 v80, v28, v29
    v_cvt_pk_bf16_f32 v81, v30, v31
    v_cvt_pk_bf16_f32 v82, v32, v33
    v_cvt_pk_bf16_f32 v83, v34, v35
    v_cvt_pk_bf16_f32 v84, v36, v37
    v_cvt_pk_bf16_f32 v85, v38, v39
    v_cvt_pk_bf16_f32 v86, v40, v41
    v_cvt_pk_bf16_f32 v87, v42, v43
    v_cvt_pk_bf16_f32 v88, v44, v45
    v_cvt_pk_bf16_f32 v89, v46, v47
    v_cvt_pk_bf16_f32 v90, v48, v49
    v_cvt_pk_bf16_f32 v91, v50, v51
    v_lshlrev_b32 v28, 16, v80
    v_and_b32 v29, 0xffff0000, v80
    v_lshlrev_b32 v30, 16, v81
    v_and_b32 v31, 0xffff0000, v81
    v_lshlrev_b32 v32, 16, v82
    v_and_b32 v33, 0xffff0000, v82
    v_lshlrev_b32 v34, 16, v83
    v_and_b32 v35, 0xffff0000, v83
    v_lshlrev_b32 v36, 16, v84
    v_and_b32 v37, 0xffff0000, v84
    v_lshlrev_b32 v38, 16, v85
    v_and_b32 v39, 0xffff0000, v85
    v_lshlrev_b32 v40, 16, v86
    v_and_b32 v41, 0xffff0000, v86
    v_lshlrev_b32 v42, 16, v87
    v_and_b32 v43, 0xffff0000, v87
    v_lshlrev_b32 v44, 16, v88
    v_and_b32 v45, 0xffff0000, v88
    v_lshlrev_b32 v46, 16, v89
    v_and_b32 v47, 0xffff0000, v89
    v_lshlrev_b32 v48, 16, v90
    v_and_b32 v49, 0xffff0000, v90
    v_lshlrev_b32 v50, 16, v91
    v_and_b32 v51, 0xffff0000, v91
    v_mul_f32 v80, 0xbfb8aa3b, v28
    v_mul_f32 v81, 0xbfb8aa3b, v29
    v_mul_f32 v82, 0xbfb8aa3b, v30
    v_mul_f32 v83, 0xbfb8aa3b, v31
    v_mul_f32 v84, 0xbfb8aa3b, v32
    v_mul_f32 v85, 0xbfb8aa3b, v33
    v_mul_f32 v86, 0xbfb8aa3b, v34
    v_mul_f32 v87, 0xbfb8aa3b, v35
    v_mul_f32 v88, 0xbfb8aa3b, v36
    v_mul_f32 v89, 0xbfb8aa3b, v37
    v_mul_f32 v90, 0xbfb8aa3b, v38
    v_mul_f32 v91, 0xbfb8aa3b, v39
    v_mul_f32 v92, 0xbfb8aa3b, v40
    v_mul_f32 v93, 0xbfb8aa3b, v41
    v_mul_f32 v94, 0xbfb8aa3b, v42
    v_mul_f32 v95, 0xbfb8aa3b, v43
    v_mul_f32 v96, 0xbfb8aa3b, v44
    v_mul_f32 v97, 0xbfb8aa3b, v45
    v_mul_f32 v98, 0xbfb8aa3b, v46
    v_mul_f32 v99, 0xbfb8aa3b, v47
    v_mul_f32 v100, 0xbfb8aa3b, v48
    v_mul_f32 v101, 0xbfb8aa3b, v49
    v_mul_f32 v102, 0xbfb8aa3b, v50
    v_mul_f32 v103, 0xbfb8aa3b, v51
    v_exp_f32 v80, v80
    v_exp_f32 v81, v81
    v_exp_f32 v82, v82
    v_exp_f32 v83, v83
    v_exp_f32 v84, v84
    v_exp_f32 v85, v85
    v_exp_f32 v86, v86
    v_exp_f32 v87, v87
    v_exp_f32 v88, v88
    v_exp_f32 v89, v89
    v_exp_f32 v90, v90
    v_exp_f32 v91, v91
    v_exp_f32 v92, v92
    v_exp_f32 v93, v93
    v_exp_f32 v94, v94
    v_exp_f32 v95, v95
    v_exp_f32 v96, v96
    v_exp_f32 v97, v97
    v_exp_f32 v98, v98
    v_exp_f32 v99, v99
    v_exp_f32 v100, v100
    v_exp_f32 v101, v101
    v_exp_f32 v102, v102
    v_exp_f32 v103, v103
    v_add_f32 v80, 1.0, v80
    v_add_f32 v81, 1.0, v81
    v_add_f32 v82, 1.0, v82
    v_add_f32 v83, 1.0, v83
    v_add_f32 v84, 1.0, v84
    v_add_f32 v85, 1.0, v85
    v_add_f32 v86, 1.0, v86
    v_add_f32 v87, 1.0, v87
    v_add_f32 v88, 1.0, v88
    v_add_f32 v89, 1.0, v89
    v_add_f32 v90, 1.0, v90
    v_add_f32 v91, 1.0, v91
    v_add_f32 v92, 1.0, v92
    v_add_f32 v93, 1.0, v93
    v_add_f32 v94, 1.0, v94
    v_add_f32 v95, 1.0, v95
    v_add_f32 v96, 1.0, v96
    v_add_f32 v97, 1.0, v97
    v_add_f32 v98, 1.0, v98
    v_add_f32 v99, 1.0, v99
    v_add_f32 v100, 1.0, v100
    v_add_f32 v101, 1.0, v101
    v_add_f32 v102, 1.0, v102
    v_add_f32 v103, 1.0, v103
    v_rcp_f32 v80, v80
    v_rcp_f32 v81, v81
    v_rcp_f32 v82, v82
    v_rcp_f32 v83, v83
    v_rcp_f32 v84, v84
    v_rcp_f32 v85, v85
    v_rcp_f32 v86, v86
    v_rcp_f32 v87, v87
    v_rcp_f32 v88, v88
    v_rcp_f32 v89, v89
    v_rcp_f32 v90, v90
    v_rcp_f32 v91, v91
    v_rcp_f32 v92, v92
    v_rcp_f32 v93, v93
    v_rcp_f32 v94, v94
    v_rcp_f32 v95, v95
    v_rcp_f32 v96, v96
    v_rcp_f32 v97, v97
    v_rcp_f32 v98, v98
    v_rcp_f32 v99, v99
    v_rcp_f32 v100, v100
    v_rcp_f32 v101, v101
    v_rcp_f32 v102, v102
    v_rcp_f32 v103, v103
    v_mul_f32 v28, v28, v80
    v_mul_f32 v29, v29, v81
    v_mul_f32 v30, v30, v82
    v_mul_f32 v31, v31, v83
    v_mul_f32 v32, v32, v84
    v_mul_f32 v33, v33, v85
    v_mul_f32 v34, v34, v86
    v_mul_f32 v35, v35, v87
    v_mul_f32 v36, v36, v88
    v_mul_f32 v37, v37, v89
    v_mul_f32 v38, v38, v90
    v_mul_f32 v39, v39, v91
    v_mul_f32 v40, v40, v92
    v_mul_f32 v41, v41, v93
    v_mul_f32 v42, v42, v94
    v_mul_f32 v43, v43, v95
    v_mul_f32 v44, v44, v96
    v_mul_f32 v45, v45, v97
    v_mul_f32 v46, v46, v98
    v_mul_f32 v47, v47, v99
    v_mul_f32 v48, v48, v100
    v_mul_f32 v49, v49, v101
    v_mul_f32 v50, v50, v102
    v_mul_f32 v51, v51, v103
    v_cvt_pk_bf16_f32 v80, v28, v29
    v_cvt_pk_bf16_f32 v81, v30, v31
    v_cvt_pk_bf16_f32 v82, v32, v33
    v_cvt_pk_bf16_f32 v83, v34, v35
    v_cvt_pk_bf16_f32 v84, v36, v37
    v_cvt_pk_bf16_f32 v85, v38, v39
    v_cvt_pk_bf16_f32 v86, v40, v41
    v_cvt_pk_bf16_f32 v87, v42, v43
    v_cvt_pk_bf16_f32 v88, v44, v45
    v_cvt_pk_bf16_f32 v89, v46, v47
    v_cvt_pk_bf16_f32 v90, v48, v49
    v_cvt_pk_bf16_f32 v91, v50, v51
    v_lshlrev_b32 v28, 16, v80
    v_and_b32 v29, 0xffff0000, v80
    v_lshlrev_b32 v30, 16, v81
    v_and_b32 v31, 0xffff0000, v81
    v_lshlrev_b32 v32, 16, v82
    v_and_b32 v33, 0xffff0000, v82
    v_lshlrev_b32 v34, 16, v83
    v_and_b32 v35, 0xffff0000, v83
    v_lshlrev_b32 v36, 16, v84
    v_and_b32 v37, 0xffff0000, v84
    v_lshlrev_b32 v38, 16, v85
    v_and_b32 v39, 0xffff0000, v85
    v_lshlrev_b32 v40, 16, v86
    v_and_b32 v41, 0xffff0000, v86
    v_lshlrev_b32 v42, 16, v87
    v_and_b32 v43, 0xffff0000, v87
    v_lshlrev_b32 v44, 16, v88
    v_and_b32 v45, 0xffff0000, v88
    v_lshlrev_b32 v46, 16, v89
    v_and_b32 v47, 0xffff0000, v89
    v_lshlrev_b32 v48, 16, v90
    v_and_b32 v49, 0xffff0000, v90
    v_lshlrev_b32 v50, 16, v91
    v_and_b32 v51, 0xffff0000, v91
    s_cmp_eq_u32 s20, 0
Lpad0:
    s_cbranch_execz Lret
    s_cbranch_scc0 Lpollok_a
    s_mov_b32 s61, 0x4000
Lpoll_a:
    buffer_load_dword v6, v5, s[12:15], s57 offen sc0 sc1
    s_waitcnt vmcnt(0)
    v_and_b32 v6, 1, v6
    v_cmp_ne_u32 vcc, 0, v6
    s_nop 3
    s_and_b32 s56, vcc_lo, 0xf000
    s_cmp_eq_u32 s56, 0xf000
    s_cbranch_scc1 Lpollok_a
    s_sleep 2
    s_sub_u32 s61, s61, 1
    s_cbranch_scc0 Lpoll_a
Lpollok_a:
    s_barrier
    s_add_u32 s54, s24, 1769472
    buffer_load_dwordx4 v[112:115], v11, s[12:15], s54 offen sc0 sc1
    s_add_u32 s54, s54, 147456
    buffer_load_dwordx4 v[124:127], v11, s[12:15], s54 offen sc0 sc1
    s_add_u32 s54, s54, 147456
    buffer_load_dwordx4 v[136:139], v11, s[12:15], s54 offen sc0 sc1
Lpad1:
    s_cbranch_execz Lret
    s_add_u32 s54, s54, 147456
    buffer_load_dwordx4 v[148:151], v11, s[12:15], s54 offen sc0 sc1
    s_add_u32 s54, s24, 1781760
    buffer_load_dwordx4 v[116:119], v11, s[12:15], s54 offen sc0 sc1
    s_add_u32 s54, s54, 147456
    buffer_load_dwordx4 v[128:131], v11, s[12:15], s54 offen sc0 sc1
    s_add_u32 s54, s54, 147456
    buffer_load_dwordx4 v[140:143], v11, s[12:15], s54 offen sc0 sc1
    s_add_u32 s54, s54, 147456
    buffer_load_dwordx4 v[152:155], v11, s[12:15], s54 offen sc0 sc1
    s_add_u32 s54, s24, 1794048
    buffer_load_dwordx4 v[120:123], v11, s[12:15], s54 offen sc0 sc1
    s_add_u32 s54, s54, 147456
    buffer_load_dwordx4 v[132:135], v11, s[12:15], s54 offen sc0 sc1
    s_add_u32 s54, s54, 147456
Lpad2:
    s_cbranch_execz Lret
    buffer_load_dwordx4 v[144:147], v11, s[12:15], s54 offen sc0 sc1
    s_add_u32 s54, s54, 147456
    buffer_load_dwordx4 v[156:159], v11, s[12:15], s54 offen sc0 sc1
    s_waitcnt vmcnt(11)
    v_dot2c_f32_bf16 v52, s42, v112
    v_dot2c_f32_bf16 v53, s43, v112
    v_dot2c_f32_bf16 v54, s42, v113
    v_dot2c_f32_bf16 v55, s43, v113
    v_dot2c_f32_bf16 v56, s42, v114
    v_dot2c_f32_bf16 v57, s43, v114
    v_dot2c_f32_bf16 v58, s42, v115
    v_dot2c_f32_bf16 v59, s43, v115
    s_waitcnt vmcnt(10)
    v_dot2c_f32_bf16 v52, s42, v124
    v_dot2c_f32_bf16 v53, s43, v124
    v_dot2c_f32_bf16 v54, s42, v125
    v_dot2c_f32_bf16 v55, s43, v125
    v_dot2c_f32_bf16 v56, s42, v126
    v_dot2c_f32_bf16 v57, s43, v126
    v_dot2c_f32_bf16 v58, s42, v127
    v_dot2c_f32_bf16 v59, s43, v127
    s_waitcnt vmcnt(9)
    v_dot2c_f32_bf16 v52, s42, v136
    v_dot2c_f32_bf16 v53, s43, v136
    v_dot2c_f32_bf16 v54, s42, v137
    v_dot2c_f32_bf16 v55, s43, v137
Lpad3:
    s_cbranch_execz Lret
    v_dot2c_f32_bf16 v56, s42, v138
    v_dot2c_f32_bf16 v57, s43, v138
    v_dot2c_f32_bf16 v58, s42, v139
    v_dot2c_f32_bf16 v59, s43, v139
    s_waitcnt vmcnt(8)
    v_dot2c_f32_bf16 v52, s42, v148
    v_dot2c_f32_bf16 v53, s43, v148
    v_dot2c_f32_bf16 v54, s42, v149
    v_dot2c_f32_bf16 v55, s43, v149
    v_dot2c_f32_bf16 v56, s42, v150
    v_dot2c_f32_bf16 v57, s43, v150
    v_dot2c_f32_bf16 v58, s42, v151
    v_dot2c_f32_bf16 v59, s43, v151
    s_waitcnt vmcnt(7)
    v_dot2c_f32_bf16 v60, s42, v116
    v_dot2c_f32_bf16 v61, s43, v116
    v_dot2c_f32_bf16 v62, s42, v117
    v_dot2c_f32_bf16 v63, s43, v117
    v_dot2c_f32_bf16 v64, s42, v118
    v_dot2c_f32_bf16 v65, s43, v118
    v_dot2c_f32_bf16 v66, s42, v119
    v_dot2c_f32_bf16 v67, s43, v119
    s_waitcnt vmcnt(6)
    v_dot2c_f32_bf16 v60, s42, v128
    v_dot2c_f32_bf16 v61, s43, v128
    v_dot2c_f32_bf16 v62, s42, v129
    v_dot2c_f32_bf16 v63, s43, v129
    v_dot2c_f32_bf16 v64, s42, v130
    v_dot2c_f32_bf16 v65, s43, v130
Lpad4:
    s_cbranch_execz Lret
    v_dot2c_f32_bf16 v66, s42, v131
    v_dot2c_f32_bf16 v67, s43, v131
    s_waitcnt vmcnt(5)
    v_dot2c_f32_bf16 v60, s42, v140
    v_dot2c_f32_bf16 v61, s43, v140
    v_dot2c_f32_bf16 v62, s42, v141
    v_dot2c_f32_bf16 v63, s43, v141
    v_dot2c_f32_bf16 v64, s42, v142
    v_dot2c_f32_bf16 v65, s43, v142
    v_dot2c_f32_bf16 v66, s42, v143
    v_dot2c_f32_bf16 v67, s43, v143
    s_waitcnt vmcnt(4)
    v_dot2c_f32_bf16 v60, s42, v152
    v_dot2c_f32_bf16 v61, s43, v152
    v_dot2c_f32_bf16 v62, s42, v153
    v_dot2c_f32_bf16 v63, s43, v153
    v_dot2c_f32_bf16 v64, s42, v154
    v_dot2c_f32_bf16 v65, s43, v154
    v_dot2c_f32_bf16 v66, s42, v155
    v_dot2c_f32_bf16 v67, s43, v155
    s_waitcnt vmcnt(3)
    v_dot2c_f32_bf16 v68, s42, v120
    v_dot2c_f32_bf16 v69, s43, v120
    v_dot2c_f32_bf16 v70, s42, v121
    v_dot2c_f32_bf16 v71, s43, v121
    v_dot2c_f32_bf16 v72, s42, v122
    v_dot2c_f32_bf16 v73, s43, v122
    v_dot2c_f32_bf16 v74, s42, v123
    v_dot2c_f32_bf16 v75, s43, v123
Lpad5:
    s_cbranch_execz Lret
    s_waitcnt vmcnt(2)
    v_dot2c_f32_bf16 v68, s42, v132
    v_dot2c_f32_bf16 v69, s43, v132
    v_dot2c_f32_bf16 v70, s42, v133
    v_dot2c_f32_bf16 v71, s43, v133
    v_dot2c_f32_bf16 v72, s42, v134
    v_dot2c_f32_bf16 v73, s43, v134
    v_dot2c_f32_bf16 v74, s42, v135
    v_dot2c_f32_bf16 v75, s43, v135
    s_waitcnt vmcnt(1)
    v_dot2c_f32_bf16 v68, s42, v144
    v_dot2c_f32_bf16 v69, s43, v144
    v_dot2c_f32_bf16 v70, s42, v145
    v_dot2c_f32_bf16 v71, s43, v145
    v_dot2c_f32_bf16 v72, s42, v146
    v_dot2c_f32_bf16 v73, s43, v146
    v_dot2c_f32_bf16 v74, s42, v147
    v_dot2c_f32_bf16 v75, s43, v147
    s_waitcnt vmcnt(0)
    v_dot2c_f32_bf16 v68, s42, v156
    v_dot2c_f32_bf16 v69, s43, v156
    v_dot2c_f32_bf16 v70, s42, v157
    v_dot2c_f32_bf16 v71, s43, v157
    v_dot2c_f32_bf16 v72, s42, v158
    v_dot2c_f32_bf16 v73, s43, v158
    v_dot2c_f32_bf16 v74, s42, v159
    v_dot2c_f32_bf16 v75, s43, v159
    s_nop 2
    v_cvt_pk_bf16_f32 v80, v52, v53
Lpad6:
    s_cbranch_execz Lret
    v_cvt_pk_bf16_f32 v81, v54, v55
    v_cvt_pk_bf16_f32 v82, v56, v57
    v_cvt_pk_bf16_f32 v83, v58, v59
    v_cvt_pk_bf16_f32 v84, v60, v61
    v_cvt_pk_bf16_f32 v85, v62, v63
    v_cvt_pk_bf16_f32 v86, v64, v65
    v_cvt_pk_bf16_f32 v87, v66, v67
    v_cvt_pk_bf16_f32 v88, v68, v69
    v_cvt_pk_bf16_f32 v89, v70, v71
    v_cvt_pk_bf16_f32 v90, v72, v73
    v_cvt_pk_bf16_f32 v91, v74, v75
    v_lshlrev_b32 v52, 16, v80
    v_and_b32 v53, 0xffff0000, v80
    v_lshlrev_b32 v54, 16, v81
    v_and_b32 v55, 0xffff0000, v81
    v_lshlrev_b32 v56, 16, v82
Lpad7:
    s_cbranch_execz Lret
    v_and_b32 v57, 0xffff0000, v82
    v_lshlrev_b32 v58, 16, v83
    v_and_b32 v59, 0xffff0000, v83
    v_lshlrev_b32 v60, 16, v84
    v_and_b32 v61, 0xffff0000, v84
    v_lshlrev_b32 v62, 16, v85
    v_and_b32 v63, 0xffff0000, v85
    v_lshlrev_b32 v64, 16, v86
    v_and_b32 v65, 0xffff0000, v86
    v_lshlrev_b32 v66, 16, v87
    v_and_b32 v67, 0xffff0000, v87
    v_lshlrev_b32 v68, 16, v88
    v_and_b32 v69, 0xffff0000, v88
    v_lshlrev_b32 v70, 16, v89
    v_and_b32 v71, 0xffff0000, v89
    v_lshlrev_b32 v72, 16, v90
    v_and_b32 v73, 0xffff0000, v90
    v_lshlrev_b32 v74, 16, v91
    v_and_b32 v75, 0xffff0000, v91
Lpad8:
    s_cbranch_execz Lret
    v_mul_f32 v28, v28, v52
    v_mul_f32 v29, v29, v53
    v_mul_f32 v30, v30, v54
    v_mul_f32 v31, v31, v55
    v_mul_f32 v32, v32, v56
    v_mul_f32 v33, v33, v57
    v_mul_f32 v34, v34, v58
    v_mul_f32 v35, v35, v59
    v_mul_f32 v36, v36, v60
    v_mul_f32 v37, v37, v61
    v_mul_f32 v38, v38, v62
    v_mul_f32 v39, v39, v63
    v_mul_f32 v40, v40, v64
    v_mul_f32 v41, v41, v65
    v_mul_f32 v42, v42, v66
    v_mul_f32 v43, v43, v67
    v_mul_f32 v44, v44, v68
    v_mul_f32 v45, v45, v69
    v_mul_f32 v46, v46, v70
    v_mul_f32 v47, v47, v71
    v_mul_f32 v48, v48, v72
    v_mul_f32 v49, v49, v73
    v_mul_f32 v50, v50, v74
    v_mul_f32 v51, v51, v75
    v_cvt_pk_bf16_f32 v80, v28, v29
    v_cvt_pk_bf16_f32 v81, v30, v31
    v_cvt_pk_bf16_f32 v82, v32, v33
Lpad9:
    s_cbranch_execz Lret
    v_cvt_pk_bf16_f32 v83, v34, v35
    v_cvt_pk_bf16_f32 v84, v36, v37
    v_cvt_pk_bf16_f32 v85, v38, v39
    v_cvt_pk_bf16_f32 v86, v40, v41
    v_cvt_pk_bf16_f32 v87, v42, v43
    v_cvt_pk_bf16_f32 v88, v44, v45
    v_cvt_pk_bf16_f32 v89, v46, v47
    v_cvt_pk_bf16_f32 v90, v48, v49
    v_cvt_pk_bf16_f32 v91, v50, v51
    v_lshlrev_b32 v28, 16, v80
    v_and_b32 v29, 0xffff0000, v80
    v_lshlrev_b32 v30, 16, v81
    v_and_b32 v31, 0xffff0000, v81
    v_lshlrev_b32 v32, 16, v82
    v_and_b32 v33, 0xffff0000, v82
    v_lshlrev_b32 v34, 16, v83
    v_and_b32 v35, 0xffff0000, v83
Lpad10:
    s_cbranch_execz Lret
    v_lshlrev_b32 v36, 16, v84
    v_and_b32 v37, 0xffff0000, v84
    v_lshlrev_b32 v38, 16, v85
    v_and_b32 v39, 0xffff0000, v85
    v_lshlrev_b32 v40, 16, v86
    v_and_b32 v41, 0xffff0000, v86
    v_lshlrev_b32 v42, 16, v87
    v_and_b32 v43, 0xffff0000, v87
    v_lshlrev_b32 v44, 16, v88
    v_and_b32 v45, 0xffff0000, v88
    v_lshlrev_b32 v46, 16, v89
    v_and_b32 v47, 0xffff0000, v89
    v_lshlrev_b32 v48, 16, v90
    v_and_b32 v49, 0xffff0000, v90
    v_lshlrev_b32 v50, 16, v91
    v_and_b32 v51, 0xffff0000, v91
    v_lshlrev_b32 v52, 16, v16
    v_and_b32 v53, 0xffff0000, v16
    v_lshlrev_b32 v54, 16, v17
    v_and_b32 v55, 0xffff0000, v17
Lpad11:
    s_cbranch_execz Lret
    v_lshlrev_b32 v56, 16, v18
    v_and_b32 v57, 0xffff0000, v18
    v_lshlrev_b32 v58, 16, v19
    v_and_b32 v59, 0xffff0000, v19
    v_lshlrev_b32 v60, 16, v20
    v_and_b32 v61, 0xffff0000, v20
    v_lshlrev_b32 v62, 16, v21
    v_and_b32 v63, 0xffff0000, v21
    v_lshlrev_b32 v64, 16, v22
    v_and_b32 v65, 0xffff0000, v22
    v_lshlrev_b32 v66, 16, v23
    v_and_b32 v67, 0xffff0000, v23
    v_lshlrev_b32 v68, 16, v24
    v_and_b32 v69, 0xffff0000, v24
    v_lshlrev_b32 v70, 16, v25
    v_and_b32 v71, 0xffff0000, v25
    v_lshlrev_b32 v72, 16, v26
    v_and_b32 v73, 0xffff0000, v26
    v_lshlrev_b32 v74, 16, v27
    v_and_b32 v75, 0xffff0000, v27
Lpad12:
    s_cbranch_execz Lret
    v_add_f32 v28, v28, v52
    v_add_f32 v29, v29, v53
    v_add_f32 v30, v30, v54
    v_add_f32 v31, v31, v55
    v_add_f32 v32, v32, v56
    v_add_f32 v33, v33, v57
    v_add_f32 v34, v34, v58
    v_add_f32 v35, v35, v59
    v_add_f32 v36, v36, v60
    v_add_f32 v37, v37, v61
    v_add_f32 v38, v38, v62
    v_add_f32 v39, v39, v63
    v_add_f32 v40, v40, v64
    v_add_f32 v41, v41, v65
    v_add_f32 v42, v42, v66
    v_add_f32 v43, v43, v67
    v_add_f32 v44, v44, v68
    v_add_f32 v45, v45, v69
    v_add_f32 v46, v46, v70
    v_add_f32 v47, v47, v71
    v_add_f32 v48, v48, v72
    v_add_f32 v49, v49, v73
    v_add_f32 v50, v50, v74
    v_add_f32 v51, v51, v75
    v_cvt_pk_bf16_f32 v80, v28, v29
    v_cvt_pk_bf16_f32 v81, v30, v31
    v_cvt_pk_bf16_f32 v82, v32, v33
Lpad13:
    s_cbranch_execz Lret
    v_cvt_pk_bf16_f32 v83, v34, v35
    v_cvt_pk_bf16_f32 v84, v36, v37
    v_cvt_pk_bf16_f32 v85, v38, v39
    v_cvt_pk_bf16_f32 v86, v40, v41
    v_cvt_pk_bf16_f32 v87, v42, v43
    v_cvt_pk_bf16_f32 v88, v44, v45
    v_cvt_pk_bf16_f32 v89, v46, v47
    v_cvt_pk_bf16_f32 v90, v48, v49
    v_cvt_pk_bf16_f32 v91, v50, v51
    buffer_store_dwordx4 v[80:83], v4, s[44:47], s25 offen
    buffer_store_dwordx4 v[84:87], v4, s[44:47], s26 offen
    buffer_store_dwordx4 v[88:91], v4, s[44:47], s27 offen
    s_endpgm
Lsw_f0:
    s_cmp_eq_u32 s31, 4
    s_cbranch_scc0 Lsw5_f0
    s_mov_b32 s4, s74
    s_and_b32 s5, s75, 0xffff
    s_mov_b32 s6, 5308416
    s_mul_i32 s24, s22, 442368
    s_mov_b32 s25, 221184
    s_mov_b32 s26, 221184
    s_mov_b32 s27, 4294746240
    v_mov_b32 v64, v70
    v_mov_b32 v65, v71
    v_mov_b32 v66, v72
    v_mov_b32 v67, v73
    v_mov_b32 v68, v74
    v_mov_b32 v69, v75
    s_branch Lswr_f0
Lsw5_f0:
    s_mov_b32 s27, 221184
    s_mov_b32 s26, 4294746240
    v_xor_b32 v8, v4, v14
    s_branch Lswr_f0
Lsw_f1:
    s_cmp_eq_u32 s31, 4
    s_cbranch_scc0 Lsw5_f1
    s_mov_b32 s4, s74
    s_and_b32 s5, s75, 0xffff
    s_mov_b32 s6, 5308416
    s_mul_i32 s24, s22, 442368
    s_mov_b32 s25, 221184
    s_mov_b32 s26, 221184
    s_mov_b32 s27, 4294746240
    v_mov_b32 v64, v70
    v_mov_b32 v65, v71
    v_mov_b32 v66, v72
    v_mov_b32 v67, v73
    v_mov_b32 v68, v74
    v_mov_b32 v69, v75
    s_branch Lswr_f1
Lsw5_f1:
    s_mov_b32 s27, 221184
    s_mov_b32 s26, 4294746240
    v_xor_b32 v8, v4, v14
    s_branch Lswr_f1
Lsw_f2:
    s_cmp_eq_u32 s31, 4
    s_cbranch_scc0 Lsw5_f2
    s_mov_b32 s4, s74
    s_and_b32 s5, s75, 0xffff
    s_mov_b32 s6, 5308416
    s_mul_i32 s24, s22, 442368
    s_mov_b32 s25, 221184
    s_mov_b32 s26, 221184
    s_mov_b32 s27, 4294746240
    v_mov_b32 v64, v70
    v_mov_b32 v65, v71
    v_mov_b32 v66, v72
    v_mov_b32 v67, v73
    v_mov_b32 v68, v74
    v_mov_b32 v69, v75
    s_branch Lswr_f2
Lsw5_f2:
    s_mov_b32 s27, 221184
    s_mov_b32 s26, 4294746240
    v_xor_b32 v8, v4, v14
    s_branch Lswr_f2
Lsw_f3:
    s_cmp_eq_u32 s31, 4
    s_cbranch_scc0 Lsw5_f3
    s_mov_b32 s4, s74
    s_and_b32 s5, s75, 0xffff
    s_mov_b32 s6, 5308416
    s_mul_i32 s24, s22, 442368
    s_mov_b32 s25, 221184
    s_mov_b32 s26, 221184
    s_mov_b32 s27, 4294746240
    v_mov_b32 v64, v70
    v_mov_b32 v65, v71
    v_mov_b32 v66, v72
    v_mov_b32 v67, v73
    v_mov_b32 v68, v74
    v_mov_b32 v69, v75
    s_branch Lswr_f3
Lsw5_f3:
    s_mov_b32 s27, 221184
    s_mov_b32 s26, 4294746240
    v_xor_b32 v8, v4, v14
    s_branch Lswr_f3
Lpub:
    s_lshl_b32 s54, s21, 2
    s_add_u32 s54, s54, s22
    s_sub_u32 s54, s54, 12
    s_cmp_eq_u32 s31, 5
    s_cbranch_scc0 Lflag
    s_mul_i32 s54, s54, 9216
    s_add_u32 s54, s54, 37748736
    v_and_b32 v78, 15, v2
    v_mul_u32_u24 v78, 576, v78
    v_lshl_add_u32 v78, v3, 5, v78
    v_cmp_lt_u32 vcc, 15, v2
    s_and_saveexec_b64 s[84:85], vcc
    buffer_store_dwordx4 v[80:83], v78, s[12:15], s54 offen offset:0 sc0 sc1
    buffer_store_dwordx4 v[84:87], v78, s[12:15], s54 offen offset:16 sc0 sc1
    buffer_store_dwordx4 v[88:91], v78, s[12:15], s54 offen offset:64 sc0 sc1
    buffer_store_dwordx4 v[92:95], v78, s[12:15], s54 offen offset:80 sc0 sc1
    buffer_store_dwordx4 v[96:99], v78, s[12:15], s54 offen offset:128 sc0 sc1
    buffer_store_dwordx4 v[100:103], v78, s[12:15], s54 offen offset:144 sc0 sc1
    buffer_store_dwordx4 v[104:107], v78, s[12:15], s54 offen offset:192 sc0 sc1
    buffer_store_dwordx4 v[108:111], v78, s[12:15], s54 offen offset:208 sc0 sc1
    buffer_store_dwordx4 v[112:115], v78, s[12:15], s54 offen offset:256 sc0 sc1
    buffer_store_dwordx4 v[116:119], v78, s[12:15], s54 offen offset:272 sc0 sc1
    buffer_store_dwordx4 v[120:123], v78, s[12:15], s54 offen offset:320 sc0 sc1
    buffer_store_dwordx4 v[124:127], v78, s[12:15], s54 offen offset:336 sc0 sc1
    buffer_store_dwordx4 v[128:131], v78, s[12:15], s54 offen offset:384 sc0 sc1
    buffer_store_dwordx4 v[132:135], v78, s[12:15], s54 offen offset:400 sc0 sc1
    buffer_store_dwordx4 v[136:139], v78, s[12:15], s54 offen offset:448 sc0 sc1
    buffer_store_dwordx4 v[140:143], v78, s[12:15], s54 offen offset:464 sc0 sc1
    buffer_store_dwordx4 v[144:147], v78, s[12:15], s54 offen offset:512 sc0 sc1
    buffer_store_dwordx4 v[148:151], v78, s[12:15], s54 offen offset:528 sc0 sc1
    s_mov_b64 exec, s[84:85]
    s_nop 3
    s_branch Lpubr
Lflag:
    s_waitcnt vmcnt(16)
    s_lshl_b32 s54, s21, 4
    s_add_u32 s54, s54, s22
    v_mov_b32 v78, 0
    v_mov_b32 v77, 1
    v_cmp_eq_u32 vcc, 0, v1
    s_and_saveexec_b64 s[84:85], vcc
    buffer_store_byte v77, v78, s[16:19], s54 offen sc0 sc1
    s_mov_b64 exec, s[84:85]
    s_nop 3
    s_branch Lpubr
    .p2align 6
Lp1_a0:
    ds_read_b64_tr_b16 a[24:25], v4 offset:12288
    ds_read_b64_tr_b16 a[26:27], v4 offset:12800
    s_waitcnt lgkmcnt(10)
    v_mfma_f32_32x32x16_bf16 v[16:31], a[0:3], a[64:67], 0
    ds_read_b64_tr_b16 a[28:29], v4 offset:14336
    ds_read_b64_tr_b16 a[30:31], v4 offset:14848
    v_mfma_f32_32x32x16_bf16 v[16:31], a[4:7], a[68:71], v[16:31]
    s_add_u32 m0, s29, 28672
    v_mul_f32 v32, v32, v10
    v_mul_f32 v33, v33, v10
    ds_read_b64_tr_b16 a[0:1], v4 offset:16384
    ds_read_b64_tr_b16 a[2:3], v4 offset:16896
    s_waitcnt lgkmcnt(10)
    v_mfma_f32_32x32x16_bf16 v[16:31], a[8:11], a[72:75], v[16:31]
    buffer_load_dwordx4 v68, s[4:7], s24 offen offset:0 lds
    v_mul_f32 v34, v34, v10
    ds_read_b64_tr_b16 a[4:5], v4 offset:18432
    ds_read_b64_tr_b16 a[6:7], v4 offset:18944
    v_mfma_f32_32x32x16_bf16 v[16:31], a[12:15], a[76:79], v[16:31]
    v_mul_f32 v35, v35, v10
    v_mul_f32 v36, v36, v10
    v_mul_f32 v37, v37, v10
    ds_read_b64_tr_b16 a[8:9], v4 offset:20480
    ds_read_b64_tr_b16 a[10:11], v4 offset:20992
    s_waitcnt lgkmcnt(10)
    v_mfma_f32_32x32x16_bf16 v[16:31], a[16:19], a[80:83], v[16:31]
    v_mul_f32 v38, v38, v10
    v_mul_f32 v39, v39, v10
    v_mul_f32 v40, v40, v10
    v_mul_f32 v41, v41, v10
    ds_read_b64_tr_b16 a[12:13], v4 offset:22528
    ds_read_b64_tr_b16 a[14:15], v4 offset:23040
    v_mfma_f32_32x32x16_bf16 v[16:31], a[20:23], a[84:87], v[16:31]
    v_mul_f32 v42, v42, v10
    v_mul_f32 v43, v43, v10
    v_mul_f32 v44, v44, v10
    ds_read_b64_tr_b16 a[16:17], v5 offset:0
    ds_read_b64_tr_b16 a[18:19], v5 offset:512
    s_waitcnt lgkmcnt(10)
    v_mfma_f32_32x32x16_bf16 v[16:31], a[24:27], a[88:91], v[16:31]
    buffer_load_dwordx4 v69, s[4:7], s24 offen offset:1024 lds
    v_mul_f32 v45, v45, v10
    ds_read_b64_tr_b16 a[20:21], v5 offset:2048
    ds_read_b64_tr_b16 a[22:23], v5 offset:2560
    v_mfma_f32_32x32x16_bf16 v[16:31], a[28:31], a[92:95], v[16:31]
    s_add_u32 s24, s24, s27
    v_mul_f32 v46, v46, v10
    v_mul_f32 v47, v47, v10
    ds_read_b64_tr_b16 a[24:25], v5 offset:4096
    ds_read_b64_tr_b16 a[26:27], v5 offset:4608
    s_waitcnt lgkmcnt(10)
    v_mfma_f32_32x32x16_bf16 v[16:31], a[0:3], a[96:99], v[16:31]
    ds_read_b64_tr_b16 a[28:29], v5 offset:6144
    ds_read_b64_tr_b16 a[30:31], v5 offset:6656
    v_mfma_f32_32x32x16_bf16 v[16:31], a[4:7], a[100:103], v[16:31]
    s_add_u32 m0, s29, 49152
    s_waitcnt vmcnt(19)
    s_barrier
    ds_read_b64_tr_b16 a[0:1], v5 offset:8192
    ds_read_b64_tr_b16 a[2:3], v5 offset:8704
    s_waitcnt lgkmcnt(10)
    v_mfma_f32_32x32x16_bf16 v[16:31], a[8:11], a[104:107], v[16:31]
    buffer_load_dwordx4 v64, s[4:7], s24 offen offset:0 lds
    ds_read_b64_tr_b16 a[4:5], v5 offset:10240
    ds_read_b64_tr_b16 a[6:7], v5 offset:10752
    v_mfma_f32_32x32x16_bf16 v[16:31], a[12:15], a[108:111], v[16:31]
    s_set_gpr_idx_on s32, 0x8
    s_nop 0
    v_cvt_pk_bf16_f32 v88, v32, v33
    v_cvt_pk_bf16_f32 v89, v34, v35
    v_cvt_pk_bf16_f32 v90, v36, v37
    v_cvt_pk_bf16_f32 v91, v38, v39
    v_cvt_pk_bf16_f32 v92, v40, v41
    v_cvt_pk_bf16_f32 v93, v42, v43
    v_cvt_pk_bf16_f32 v94, v44, v45
    v_cvt_pk_bf16_f32 v95, v46, v47
    s_set_gpr_idx_off
    s_add_u32 m0, s29, 49152
    s_add_u32 s32, s32, s33
    s_mov_b32 s33, 16
    ds_read_b64_tr_b16 a[8:9], v5 offset:12288
    ds_read_b64_tr_b16 a[10:11], v5 offset:12800
    s_waitcnt lgkmcnt(10)
    v_mfma_f32_32x32x16_bf16 v[32:47], a[16:19], a[64:67], 0
    v_add_u32 v12, 4, v12
    v_subrev_u32 v76, 27, v12
    v_min_u32 v12, v12, v76
    ds_read_b64_tr_b16 a[12:13], v5 offset:14336
    ds_read_b64_tr_b16 a[14:15], v5 offset:14848
    v_mfma_f32_32x32x16_bf16 v[32:47], a[20:23], a[68:71], v[32:47]
    v_mul_u32_u24 v76, 57, v12
    v_lshrrev_b32 v76, 9, v76
    ds_read_b64_tr_b16 a[16:17], v5 offset:16384
    ds_read_b64_tr_b16 a[18:19], v5 offset:16896
    s_waitcnt lgkmcnt(10)
    v_mfma_f32_32x32x16_bf16 v[32:47], a[24:27], a[72:75], v[32:47]
    buffer_load_dwordx4 v65, s[4:7], s24 offen offset:1024 lds
    ds_read_b64_tr_b16 a[20:21], v5 offset:18432
    ds_read_b64_tr_b16 a[22:23], v5 offset:18944
    v_mfma_f32_32x32x16_bf16 v[32:47], a[28:31], a[76:79], v[32:47]
    v_mul_u32_u24 v76, 864, v76
    v_lshl_add_u32 v77, v12, 5, v76
    ds_read_b64_tr_b16 a[24:25], v5 offset:20480
    ds_read_b64_tr_b16 a[26:27], v5 offset:20992
    s_waitcnt lgkmcnt(10)
    v_mfma_f32_32x32x16_bf16 v[32:47], a[0:3], a[80:83], v[32:47]
    buffer_load_dword a63, v79, s[44:47], s52 offen
    ds_read_b64_tr_b16 a[28:29], v5 offset:22528
    ds_read_b64_tr_b16 a[30:31], v5 offset:23040
    v_mfma_f32_32x32x16_bf16 v[32:47], a[4:7], a[84:87], v[32:47]
    s_add_u32 s52, s52, 1792
    v_sub_u32 v76, v77, v13
    ds_read_b64_tr_b16 a[0:1], v4 offset:24576
    ds_read_b64_tr_b16 a[2:3], v4 offset:25088
    s_waitcnt lgkmcnt(10)
    v_mfma_f32_32x32x16_bf16 v[32:47], a[8:11], a[88:91], v[32:47]
    buffer_load_dwordx4 v66, s[4:7], s24 offen offset:2048 lds
    ds_read_b64_tr_b16 a[4:5], v4 offset:26624
    ds_read_b64_tr_b16 a[6:7], v4 offset:27136
    v_mfma_f32_32x32x16_bf16 v[32:47], a[12:15], a[92:95], v[32:47]
    s_cmp_ge_u32 s31, 2
    s_cselect_b32 s46, 0, s46
    ds_read_b64_tr_b16 a[8:9], v4 offset:28672
    ds_read_b64_tr_b16 a[10:11], v4 offset:29184
    s_waitcnt lgkmcnt(10)
    v_mfma_f32_32x32x16_bf16 v[32:47], a[16:19], a[96:99], v[32:47]
    v_mov_b32 v13, v77
    ds_read_b64_tr_b16 a[12:13], v4 offset:30720
    ds_read_b64_tr_b16 a[14:15], v4 offset:31232
    v_mfma_f32_32x32x16_bf16 v[32:47], a[20:23], a[100:103], v[32:47]
    ds_read_b64_tr_b16 a[16:17], v4 offset:32768
    ds_read_b64_tr_b16 a[18:19], v4 offset:33280
    s_waitcnt lgkmcnt(10)
    v_mfma_f32_32x32x16_bf16 v[32:47], a[24:27], a[104:107], v[32:47]
    buffer_load_dwordx4 v67, s[4:7], s24 offen offset:3072 lds
    ds_read_b64_tr_b16 a[20:21], v4 offset:34816
    ds_read_b64_tr_b16 a[22:23], v4 offset:35328
    v_mfma_f32_32x32x16_bf16 v[32:47], a[28:31], a[108:111], v[32:47]
    ds_read_b64_tr_b16 a[24:25], v4 offset:36864
    ds_read_b64_tr_b16 a[26:27], v4 offset:37376
    s_waitcnt lgkmcnt(10)
    v_mfma_f32_32x32x16_bf16 v[16:31], a[0:3], a[112:115], v[16:31]
    ds_read_b64_tr_b16 a[28:29], v4 offset:38912
    ds_read_b64_tr_b16 a[30:31], v4 offset:39424
    v_mfma_f32_32x32x16_bf16 v[16:31], a[4:7], a[116:119], v[16:31]
    s_add_u32 m0, s29, 53248
    ds_read_b64_tr_b16 a[0:1], v4 offset:40960
    ds_read_b64_tr_b16 a[2:3], v4 offset:41472
    s_waitcnt lgkmcnt(10)
    v_mfma_f32_32x32x16_bf16 v[16:31], a[8:11], a[120:123], v[16:31]
    buffer_load_dwordx4 v68, s[4:7], s24 offen offset:0 lds
    ds_read_b64_tr_b16 a[4:5], v4 offset:43008
    ds_read_b64_tr_b16 a[6:7], v4 offset:43520
    v_mfma_f32_32x32x16_bf16 v[16:31], a[12:15], a[124:127], v[16:31]
    ds_read_b64_tr_b16 a[8:9], v4 offset:45056
    ds_read_b64_tr_b16 a[10:11], v4 offset:45568
    s_waitcnt lgkmcnt(10)
    v_mfma_f32_32x32x16_bf16 v[16:31], a[16:19], a[128:131], v[16:31]
    ds_read_b64_tr_b16 a[12:13], v4 offset:47104
    ds_read_b64_tr_b16 a[14:15], v4 offset:47616
    v_mfma_f32_32x32x16_bf16 v[16:31], a[20:23], a[132:135], v[16:31]
    v_add_u32 v64, v64, v76
    v_add_u32 v65, v65, v76
    ds_read_b64_tr_b16 a[16:17], v5 offset:24576
    ds_read_b64_tr_b16 a[18:19], v5 offset:25088
    s_waitcnt lgkmcnt(10)
    v_mfma_f32_32x32x16_bf16 v[16:31], a[24:27], a[136:139], v[16:31]
    buffer_load_dwordx4 v69, s[4:7], s24 offen offset:1024 lds
    ds_read_b64_tr_b16 a[20:21], v5 offset:26624
    ds_read_b64_tr_b16 a[22:23], v5 offset:27136
    v_mfma_f32_32x32x16_bf16 v[16:31], a[28:31], a[140:143], v[16:31]
    s_add_u32 s24, s24, s25
    v_add_u32 v66, v66, v76
    ds_read_b64_tr_b16 a[24:25], v5 offset:28672
    ds_read_b64_tr_b16 a[26:27], v5 offset:29184
    s_waitcnt lgkmcnt(10)
    v_mfma_f32_32x32x16_bf16 v[16:31], a[0:3], v[192:195], v[16:31]
    s_cmp_ge_u32 s31, 5
    s_cselect_b32 s6, 0, s6
    v_add_u32 v67, v67, v76
    ds_read_b64_tr_b16 a[28:29], v5 offset:30720
    ds_read_b64_tr_b16 a[30:31], v5 offset:31232
    v_mfma_f32_32x32x16_bf16 v[16:31], a[4:7], v[196:199], v[16:31]
    s_add_u32 m0, s28, 0
    s_waitcnt vmcnt(19)
    s_barrier
    ds_read_b64_tr_b16 a[0:1], v5 offset:32768
    ds_read_b64_tr_b16 a[2:3], v5 offset:33280
    s_waitcnt lgkmcnt(10)
    v_mfma_f32_32x32x16_bf16 v[16:31], a[8:11], v[200:203], v[16:31]
    buffer_load_dwordx4 v64, s[4:7], s24 offen offset:0 lds
    ds_read_b64_tr_b16 a[4:5], v5 offset:34816
    ds_read_b64_tr_b16 a[6:7], v5 offset:35328
    v_mfma_f32_32x32x16_bf16 v[16:31], a[12:15], v[204:207], v[16:31]
    v_add_u32 v68, v68, v76
    v_add_u32 v69, v69, v76
    ds_read_b64_tr_b16 a[8:9], v5 offset:36864
    ds_read_b64_tr_b16 a[10:11], v5 offset:37376
    s_waitcnt lgkmcnt(10)
    v_mfma_f32_32x32x16_bf16 v[32:47], a[16:19], a[112:115], v[32:47]
    v_xor_b32 v4, v8, v4
    ds_read_b64_tr_b16 a[12:13], v5 offset:38912
    ds_read_b64_tr_b16 a[14:15], v5 offset:39424
    v_mfma_f32_32x32x16_bf16 v[32:47], a[20:23], a[116:119], v[32:47]
    ds_read_b64_tr_b16 a[16:17], v5 offset:40960
    ds_read_b64_tr_b16 a[18:19], v5 offset:41472
    s_waitcnt lgkmcnt(10)
    v_mfma_f32_32x32x16_bf16 v[32:47], a[24:27], a[120:123], v[32:47]
    buffer_load_dwordx4 v65, s[4:7], s24 offen offset:1024 lds
    ds_read_b64_tr_b16 a[20:21], v5 offset:43008
    ds_read_b64_tr_b16 a[22:23], v5 offset:43520
    v_mfma_f32_32x32x16_bf16 v[32:47], a[28:31], a[124:127], v[32:47]
    ds_read_b64_tr_b16 a[24:25], v5 offset:45056
    ds_read_b64_tr_b16 a[26:27], v5 offset:45568
    s_waitcnt lgkmcnt(10)
    v_mfma_f32_32x32x16_bf16 v[32:47], a[0:3], a[128:131], v[32:47]
    ds_read_b64_tr_b16 a[28:29], v5 offset:47104
    ds_read_b64_tr_b16 a[30:31], v5 offset:47616
    v_mfma_f32_32x32x16_bf16 v[32:47], a[4:7], a[132:135], v[32:47]
    ds_read_b64_tr_b16 a[0:1], v6 offset:0
    ds_read_b64_tr_b16 a[2:3], v6 offset:512
    s_waitcnt lgkmcnt(10)
    v_mfma_f32_32x32x16_bf16 v[32:47], a[8:11], a[136:139], v[32:47]
    buffer_load_dwordx4 v66, s[4:7], s24 offen offset:2048 lds
    ds_read_b64_tr_b16 a[4:5], v6 offset:2048
    ds_read_b64_tr_b16 a[6:7], v6 offset:2560
    v_mfma_f32_32x32x16_bf16 v[32:47], a[12:15], a[140:143], v[32:47]
    v_xor_b32 v5, 73728, v5
    ds_read_b64_tr_b16 a[8:9], v6 offset:4096
    ds_read_b64_tr_b16 a[10:11], v6 offset:4608
    s_waitcnt lgkmcnt(10)
    v_mfma_f32_32x32x16_bf16 v[32:47], a[16:19], v[192:195], v[32:47]
    ds_read_b64_tr_b16 a[12:13], v6 offset:6144
    ds_read_b64_tr_b16 a[14:15], v6 offset:6656
    v_mfma_f32_32x32x16_bf16 v[32:47], a[20:23], v[196:199], v[32:47]
    ds_read_b64_tr_b16 a[16:17], v6 offset:8192
    ds_read_b64_tr_b16 a[18:19], v6 offset:8704
    s_waitcnt lgkmcnt(10)
    v_mfma_f32_32x32x16_bf16 v[32:47], a[24:27], v[200:203], v[32:47]
    buffer_load_dwordx4 v67, s[4:7], s24 offen offset:3072 lds
    ds_read_b64_tr_b16 a[20:21], v6 offset:10240
    ds_read_b64_tr_b16 a[22:23], v6 offset:10752
    v_mfma_f32_32x32x16_bf16 v[32:47], a[28:31], v[204:207], v[32:47]
    ds_read_b64_tr_b16 a[24:25], v6 offset:12288
    ds_read_b64_tr_b16 a[26:27], v6 offset:12800
    s_waitcnt lgkmcnt(10)
    v_mfma_f32_32x32x16_bf16 v[16:31], a[0:3], v[208:211], v[16:31]
    ds_read_b64_tr_b16 a[28:29], v6 offset:14336
    ds_read_b64_tr_b16 a[30:31], v6 offset:14848
    v_mfma_f32_32x32x16_bf16 v[16:31], a[4:7], v[212:215], v[16:31]
    s_add_u32 m0, s28, 4096
    ds_read_b64_tr_b16 a[0:1], v6 offset:16384
    ds_read_b64_tr_b16 a[2:3], v6 offset:16896
    s_waitcnt lgkmcnt(10)
    v_mfma_f32_32x32x16_bf16 v[16:31], a[8:11], v[216:219], v[16:31]
    buffer_load_dwordx4 v68, s[4:7], s24 offen offset:0 lds
    ds_read_b64_tr_b16 a[4:5], v6 offset:18432
    ds_read_b64_tr_b16 a[6:7], v6 offset:18944
    v_mfma_f32_32x32x16_bf16 v[16:31], a[12:15], v[220:223], v[16:31]
    ds_read_b64_tr_b16 a[8:9], v6 offset:20480
    ds_read_b64_tr_b16 a[10:11], v6 offset:20992
    s_waitcnt lgkmcnt(10)
    v_mfma_f32_32x32x16_bf16 v[16:31], a[16:19], v[224:227], v[16:31]
    ds_read_b64_tr_b16 a[12:13], v6 offset:22528
    ds_read_b64_tr_b16 a[14:15], v6 offset:23040
    v_mfma_f32_32x32x16_bf16 v[16:31], a[20:23], v[228:231], v[16:31]
    ds_read_b64_tr_b16 a[16:17], v7 offset:0
    ds_read_b64_tr_b16 a[18:19], v7 offset:512
    s_waitcnt lgkmcnt(10)
    v_mfma_f32_32x32x16_bf16 v[16:31], a[24:27], v[232:235], v[16:31]
    buffer_load_dwordx4 v69, s[4:7], s24 offen offset:1024 lds
    ds_read_b64_tr_b16 a[20:21], v7 offset:2048
    ds_read_b64_tr_b16 a[22:23], v7 offset:2560
    v_mfma_f32_32x32x16_bf16 v[16:31], a[28:31], v[236:239], v[16:31]
    s_add_u32 s24, s24, s26
    v_xor_b32 v6, 73728, v6
    ds_read_b64_tr_b16 a[24:25], v7 offset:4096
    ds_read_b64_tr_b16 a[26:27], v7 offset:4608
    s_waitcnt lgkmcnt(10)
    v_mfma_f32_32x32x16_bf16 v[16:31], a[0:3], v[240:243], v[16:31]
    ds_read_b64_tr_b16 a[28:29], v7 offset:6144
    ds_read_b64_tr_b16 a[30:31], v7 offset:6656
    v_mfma_f32_32x32x16_bf16 v[16:31], a[4:7], v[244:247], v[16:31]
    s_add_u32 m0, s28, 24576
    s_waitcnt vmcnt(19)
    s_barrier
    ds_read_b64_tr_b16 a[0:1], v7 offset:8192
    ds_read_b64_tr_b16 a[2:3], v7 offset:8704
    s_waitcnt lgkmcnt(10)
    v_mfma_f32_32x32x16_bf16 v[16:31], a[8:11], v[248:251], v[16:31]
    buffer_load_dwordx4 v64, s[4:7], s24 offen offset:0 lds
    ds_read_b64_tr_b16 a[4:5], v7 offset:10240
    ds_read_b64_tr_b16 a[6:7], v7 offset:10752
    v_mfma_f32_32x32x16_bf16 v[16:31], a[12:15], v[252:255], v[16:31]
    ds_read_b64_tr_b16 a[8:9], v7 offset:12288
    ds_read_b64_tr_b16 a[10:11], v7 offset:12800
    s_waitcnt lgkmcnt(10)
    v_mfma_f32_32x32x16_bf16 v[32:47], a[16:19], v[208:211], v[32:47]
    ds_read_b64_tr_b16 a[12:13], v7 offset:14336
    ds_read_b64_tr_b16 a[14:15], v7 offset:14848
    v_mfma_f32_32x32x16_bf16 v[32:47], a[20:23], v[212:215], v[32:47]
    v_mul_f32 v16, v16, v10
    v_mul_f32 v17, v17, v10
    v_mul_f32 v18, v18, v10
    ds_read_b64_tr_b16 a[16:17], v7 offset:16384
    ds_read_b64_tr_b16 a[18:19], v7 offset:16896
    s_waitcnt lgkmcnt(10)
    v_mfma_f32_32x32x16_bf16 v[32:47], a[24:27], v[216:219], v[32:47]
    buffer_load_dwordx4 v65, s[4:7], s24 offen offset:1024 lds
    v_mul_f32 v19, v19, v10
    ds_read_b64_tr_b16 a[20:21], v7 offset:18432
    ds_read_b64_tr_b16 a[22:23], v7 offset:18944
    v_mfma_f32_32x32x16_bf16 v[32:47], a[28:31], v[220:223], v[32:47]
    v_mul_f32 v20, v20, v10
    v_mul_f32 v21, v21, v10
    v_mul_f32 v22, v22, v10
    ds_read_b64_tr_b16 a[24:25], v7 offset:20480
    ds_read_b64_tr_b16 a[26:27], v7 offset:20992
    s_waitcnt lgkmcnt(10)
    v_mfma_f32_32x32x16_bf16 v[32:47], a[0:3], v[224:227], v[32:47]
    v_mul_f32 v23, v23, v10
    v_mul_f32 v24, v24, v10
    v_mul_f32 v25, v25, v10
    v_mul_f32 v26, v26, v10
    ds_read_b64_tr_b16 a[28:29], v7 offset:22528
    ds_read_b64_tr_b16 a[30:31], v7 offset:23040
    v_mfma_f32_32x32x16_bf16 v[32:47], a[4:7], v[228:231], v[32:47]
    v_mul_f32 v27, v27, v10
    v_mul_f32 v28, v28, v10
    v_mul_f32 v29, v29, v10
    ds_read_b64_tr_b16 a[0:1], v4 offset:0
    ds_read_b64_tr_b16 a[2:3], v4 offset:512
    s_waitcnt lgkmcnt(10)
    v_mfma_f32_32x32x16_bf16 v[32:47], a[8:11], v[232:235], v[32:47]
    buffer_load_dwordx4 v66, s[4:7], s24 offen offset:2048 lds
    v_mul_f32 v30, v30, v10
    ds_read_b64_tr_b16 a[4:5], v4 offset:2048
    ds_read_b64_tr_b16 a[6:7], v4 offset:2560
    v_mfma_f32_32x32x16_bf16 v[32:47], a[12:15], v[236:239], v[32:47]
    v_xor_b32 v7, 73728, v7
    v_mul_f32 v31, v31, v10
    ds_read_b64_tr_b16 a[8:9], v4 offset:4096
    ds_read_b64_tr_b16 a[10:11], v4 offset:4608
    s_waitcnt lgkmcnt(10)
    v_mfma_f32_32x32x16_bf16 v[32:47], a[16:19], v[240:243], v[32:47]
    ds_read_b64_tr_b16 a[12:13], v4 offset:6144
    ds_read_b64_tr_b16 a[14:15], v4 offset:6656
    v_mfma_f32_32x32x16_bf16 v[32:47], a[20:23], v[244:247], v[32:47]
    ds_read_b64_tr_b16 a[16:17], v4 offset:8192
    ds_read_b64_tr_b16 a[18:19], v4 offset:8704
    s_waitcnt lgkmcnt(10)
    v_mfma_f32_32x32x16_bf16 v[32:47], a[24:27], v[248:251], v[32:47]
    buffer_load_dwordx4 v67, s[4:7], s24 offen offset:3072 lds
    ds_read_b64_tr_b16 a[20:21], v4 offset:10240
    ds_read_b64_tr_b16 a[22:23], v4 offset:10752
    v_mfma_f32_32x32x16_bf16 v[32:47], a[28:31], v[252:255], v[32:47]
    s_set_gpr_idx_on s32, 0x8
    s_nop 0
    v_cvt_pk_bf16_f32 v80, v16, v17
    v_cvt_pk_bf16_f32 v81, v18, v19
    v_cvt_pk_bf16_f32 v82, v20, v21
    v_cvt_pk_bf16_f32 v83, v22, v23
    v_cvt_pk_bf16_f32 v84, v24, v25
    v_cvt_pk_bf16_f32 v85, v26, v27
    v_cvt_pk_bf16_f32 v86, v28, v29
    v_cvt_pk_bf16_f32 v87, v30, v31
    s_set_gpr_idx_off
    s_add_u32 m0, s28, 24576
    s_xor_b32 s28, s28, 73728
    s_xor_b32 s29, s29, 73728
    s_add_u32 s31, s31, 1
    s_cmp_lt_u32 s31, 7
    s_cbranch_scc1 Lp1_a0
    s_branch Latt
    .p2align 6
Lp1_a1:
    ds_read_b64_tr_b16 a[24:25], v4 offset:12288
    ds_read_b64_tr_b16 a[26:27], v4 offset:12800
    s_waitcnt lgkmcnt(10)
    v_mfma_f32_32x32x16_bf16 v[16:31], a[0:3], a[64:67], 0
    ds_read_b64_tr_b16 a[28:29], v4 offset:14336
    ds_read_b64_tr_b16 a[30:31], v4 offset:14848
    v_mfma_f32_32x32x16_bf16 v[16:31], a[4:7], a[68:71], v[16:31]
    v_mul_f32 v32, v32, v10
    v_mul_f32 v33, v33, v10
    v_mul_f32 v34, v34, v10
    ds_read_b64_tr_b16 a[0:1], v4 offset:16384
    ds_read_b64_tr_b16 a[2:3], v4 offset:16896
    s_waitcnt lgkmcnt(10)
    v_mfma_f32_32x32x16_bf16 v[16:31], a[8:11], a[72:75], v[16:31]
    s_add_u32 m0, s29, 34816
    v_mul_f32 v35, v35, v10
    v_mul_f32 v36, v36, v10
    v_mul_f32 v37, v37, v10
    ds_read_b64_tr_b16 a[4:5], v4 offset:18432
    ds_read_b64_tr_b16 a[6:7], v4 offset:18944
    v_mfma_f32_32x32x16_bf16 v[16:31], a[12:15], a[76:79], v[16:31]
    buffer_load_dwordx4 v68, s[4:7], s24 offen offset:0 lds
    ds_read_b64_tr_b16 a[8:9], v4 offset:20480
    ds_read_b64_tr_b16 a[10:11], v4 offset:20992
    s_waitcnt lgkmcnt(10)
    v_mfma_f32_32x32x16_bf16 v[16:31], a[16:19], a[80:83], v[16:31]
    v_mul_f32 v38, v38, v10
    v_mul_f32 v39, v39, v10
    v_mul_f32 v40, v40, v10
    v_mul_f32 v41, v41, v10
    ds_read_b64_tr_b16 a[12:13], v4 offset:22528
    ds_read_b64_tr_b16 a[14:15], v4 offset:23040
    v_mfma_f32_32x32x16_bf16 v[16:31], a[20:23], a[84:87], v[16:31]
    v_mul_f32 v42, v42, v10
    v_mul_f32 v43, v43, v10
    v_mul_f32 v44, v44, v10
    ds_read_b64_tr_b16 a[16:17], v5 offset:0
    ds_read_b64_tr_b16 a[18:19], v5 offset:512
    s_waitcnt lgkmcnt(10)
    v_mfma_f32_32x32x16_bf16 v[16:31], a[24:27], a[88:91], v[16:31]
    v_mul_f32 v45, v45, v10
    v_mul_f32 v46, v46, v10
    v_mul_f32 v47, v47, v10
    ds_read_b64_tr_b16 a[20:21], v5 offset:2048
    ds_read_b64_tr_b16 a[22:23], v5 offset:2560
    v_mfma_f32_32x32x16_bf16 v[16:31], a[28:31], a[92:95], v[16:31]
    buffer_load_dwordx4 v69, s[4:7], s24 offen offset:1024 lds
    ds_read_b64_tr_b16 a[24:25], v5 offset:4096
    ds_read_b64_tr_b16 a[26:27], v5 offset:4608
    s_waitcnt lgkmcnt(10)
    v_mfma_f32_32x32x16_bf16 v[16:31], a[0:3], a[96:99], v[16:31]
    s_add_u32 s24, s24, s27
    ds_read_b64_tr_b16 a[28:29], v5 offset:6144
    ds_read_b64_tr_b16 a[30:31], v5 offset:6656
    v_mfma_f32_32x32x16_bf16 v[16:31], a[4:7], a[100:103], v[16:31]
    s_waitcnt vmcnt(19)
    s_barrier
    ds_read_b64_tr_b16 a[0:1], v5 offset:8192
    ds_read_b64_tr_b16 a[2:3], v5 offset:8704
    s_waitcnt lgkmcnt(10)
    v_mfma_f32_32x32x16_bf16 v[16:31], a[8:11], a[104:107], v[16:31]
    s_add_u32 m0, s29, 55296
    s_set_gpr_idx_on s32, 0x8
    s_nop 0
    v_cvt_pk_bf16_f32 v88, v32, v33
    v_cvt_pk_bf16_f32 v89, v34, v35
    v_cvt_pk_bf16_f32 v90, v36, v37
    v_cvt_pk_bf16_f32 v91, v38, v39
    v_cvt_pk_bf16_f32 v92, v40, v41
    v_cvt_pk_bf16_f32 v93, v42, v43
    v_cvt_pk_bf16_f32 v94, v44, v45
    v_cvt_pk_bf16_f32 v95, v46, v47
    s_set_gpr_idx_off
    s_add_u32 m0, s29, 55296
    s_add_u32 s32, s32, s33
    s_mov_b32 s33, 16
    ds_read_b64_tr_b16 a[4:5], v5 offset:10240
    ds_read_b64_tr_b16 a[6:7], v5 offset:10752
    v_mfma_f32_32x32x16_bf16 v[16:31], a[12:15], a[108:111], v[16:31]
    buffer_load_dwordx4 v64, s[4:7], s24 offen offset:0 lds
    ds_read_b64_tr_b16 a[8:9], v5 offset:12288
    ds_read_b64_tr_b16 a[10:11], v5 offset:12800
    s_waitcnt lgkmcnt(10)
    v_mfma_f32_32x32x16_bf16 v[32:47], a[16:19], a[64:67], 0
    v_add_u32 v12, 4, v12
    v_subrev_u32 v76, 27, v12
    v_min_u32 v12, v12, v76
    ds_read_b64_tr_b16 a[12:13], v5 offset:14336
    ds_read_b64_tr_b16 a[14:15], v5 offset:14848
    v_mfma_f32_32x32x16_bf16 v[32:47], a[20:23], a[68:71], v[32:47]
    v_mul_u32_u24 v76, 57, v12
    v_lshrrev_b32 v76, 9, v76
    ds_read_b64_tr_b16 a[16:17], v5 offset:16384
    ds_read_b64_tr_b16 a[18:19], v5 offset:16896
    s_waitcnt lgkmcnt(10)
    v_mfma_f32_32x32x16_bf16 v[32:47], a[24:27], a[72:75], v[32:47]
    v_mul_u32_u24 v76, 864, v76
    v_lshl_add_u32 v77, v12, 5, v76
    v_sub_u32 v76, v77, v13
    ds_read_b64_tr_b16 a[20:21], v5 offset:18432
    ds_read_b64_tr_b16 a[22:23], v5 offset:18944
    v_mfma_f32_32x32x16_bf16 v[32:47], a[28:31], a[76:79], v[32:47]
    buffer_load_dwordx4 v65, s[4:7], s24 offen offset:1024 lds
    ds_read_b64_tr_b16 a[24:25], v5 offset:20480
    ds_read_b64_tr_b16 a[26:27], v5 offset:20992
    s_waitcnt lgkmcnt(10)
    v_mfma_f32_32x32x16_bf16 v[32:47], a[0:3], a[80:83], v[32:47]
    v_mov_b32 v13, v77
    ds_read_b64_tr_b16 a[28:29], v5 offset:22528
    ds_read_b64_tr_b16 a[30:31], v5 offset:23040
    v_mfma_f32_32x32x16_bf16 v[32:47], a[4:7], a[84:87], v[32:47]
    buffer_load_dword a63, v79, s[44:47], s52 offen
    ds_read_b64_tr_b16 a[0:1], v4 offset:24576
    ds_read_b64_tr_b16 a[2:3], v4 offset:25088
    s_waitcnt lgkmcnt(10)
    v_mfma_f32_32x32x16_bf16 v[32:47], a[8:11], a[88:91], v[32:47]
    s_add_u32 s52, s52, 1792
    s_cmp_ge_u32 s31, 2
    s_cselect_b32 s46, 0, s46
    ds_read_b64_tr_b16 a[4:5], v4 offset:26624
    ds_read_b64_tr_b16 a[6:7], v4 offset:27136
    v_mfma_f32_32x32x16_bf16 v[32:47], a[12:15], a[92:95], v[32:47]
    buffer_load_dwordx4 v66, s[4:7], s24 offen offset:2048 lds
    ds_read_b64_tr_b16 a[8:9], v4 offset:28672
    ds_read_b64_tr_b16 a[10:11], v4 offset:29184
    s_waitcnt lgkmcnt(10)
    v_mfma_f32_32x32x16_bf16 v[32:47], a[16:19], a[96:99], v[32:47]
    ds_read_b64_tr_b16 a[12:13], v4 offset:30720
    ds_read_b64_tr_b16 a[14:15], v4 offset:31232
    v_mfma_f32_32x32x16_bf16 v[32:47], a[20:23], a[100:103], v[32:47]
    ds_read_b64_tr_b16 a[16:17], v4 offset:32768
    ds_read_b64_tr_b16 a[18:19], v4 offset:33280
    s_waitcnt lgkmcnt(10)
    v_mfma_f32_32x32x16_bf16 v[32:47], a[24:27], a[104:107], v[32:47]
    ds_read_b64_tr_b16 a[20:21], v4 offset:34816
    ds_read_b64_tr_b16 a[22:23], v4 offset:35328
    v_mfma_f32_32x32x16_bf16 v[32:47], a[28:31], a[108:111], v[32:47]
    buffer_load_dwordx4 v67, s[4:7], s24 offen offset:3072 lds
    ds_read_b64_tr_b16 a[24:25], v4 offset:36864
    ds_read_b64_tr_b16 a[26:27], v4 offset:37376
    s_waitcnt lgkmcnt(10)
    v_mfma_f32_32x32x16_bf16 v[16:31], a[0:3], a[112:115], v[16:31]
    ds_read_b64_tr_b16 a[28:29], v4 offset:38912
    ds_read_b64_tr_b16 a[30:31], v4 offset:39424
    v_mfma_f32_32x32x16_bf16 v[16:31], a[4:7], a[116:119], v[16:31]
    ds_read_b64_tr_b16 a[0:1], v4 offset:40960
    ds_read_b64_tr_b16 a[2:3], v4 offset:41472
    s_waitcnt lgkmcnt(10)
    v_mfma_f32_32x32x16_bf16 v[16:31], a[8:11], a[120:123], v[16:31]
    s_add_u32 m0, s29, 59392
    ds_read_b64_tr_b16 a[4:5], v4 offset:43008
    ds_read_b64_tr_b16 a[6:7], v4 offset:43520
    v_mfma_f32_32x32x16_bf16 v[16:31], a[12:15], a[124:127], v[16:31]
    buffer_load_dwordx4 v68, s[4:7], s24 offen offset:0 lds
    ds_read_b64_tr_b16 a[8:9], v4 offset:45056
    ds_read_b64_tr_b16 a[10:11], v4 offset:45568
    s_waitcnt lgkmcnt(10)
    v_mfma_f32_32x32x16_bf16 v[16:31], a[16:19], a[128:131], v[16:31]
    ds_read_b64_tr_b16 a[12:13], v4 offset:47104
    ds_read_b64_tr_b16 a[14:15], v4 offset:47616
    v_mfma_f32_32x32x16_bf16 v[16:31], a[20:23], a[132:135], v[16:31]
    v_add_u32 v64, v64, v76
    v_add_u32 v65, v65, v76
    ds_read_b64_tr_b16 a[16:17], v5 offset:24576
    ds_read_b64_tr_b16 a[18:19], v5 offset:25088
    s_waitcnt lgkmcnt(10)
    v_mfma_f32_32x32x16_bf16 v[16:31], a[24:27], a[136:139], v[16:31]
    v_add_u32 v66, v66, v76
    v_add_u32 v67, v67, v76
    v_add_u32 v68, v68, v76
    ds_read_b64_tr_b16 a[20:21], v5 offset:26624
    ds_read_b64_tr_b16 a[22:23], v5 offset:27136
    v_mfma_f32_32x32x16_bf16 v[16:31], a[28:31], a[140:143], v[16:31]
    buffer_load_dwordx4 v69, s[4:7], s24 offen offset:1024 lds
    ds_read_b64_tr_b16 a[24:25], v5 offset:28672
    ds_read_b64_tr_b16 a[26:27], v5 offset:29184
    s_waitcnt lgkmcnt(10)
    v_mfma_f32_32x32x16_bf16 v[16:31], a[0:3], v[192:195], v[16:31]
    s_add_u32 s24, s24, s25
    v_add_u32 v69, v69, v76
    ds_read_b64_tr_b16 a[28:29], v5 offset:30720
    ds_read_b64_tr_b16 a[30:31], v5 offset:31232
    v_mfma_f32_32x32x16_bf16 v[16:31], a[4:7], v[196:199], v[16:31]
    s_waitcnt vmcnt(19)
    s_barrier
    s_cmp_ge_u32 s31, 5
    s_cselect_b32 s6, 0, s6
    ds_read_b64_tr_b16 a[0:1], v5 offset:32768
    ds_read_b64_tr_b16 a[2:3], v5 offset:33280
    s_waitcnt lgkmcnt(10)
    v_mfma_f32_32x32x16_bf16 v[16:31], a[8:11], v[200:203], v[16:31]
    s_add_u32 m0, s28, 6144
    ds_read_b64_tr_b16 a[4:5], v5 offset:34816
    ds_read_b64_tr_b16 a[6:7], v5 offset:35328
    v_mfma_f32_32x32x16_bf16 v[16:31], a[12:15], v[204:207], v[16:31]
    buffer_load_dwordx4 v64, s[4:7], s24 offen offset:0 lds
    ds_read_b64_tr_b16 a[8:9], v5 offset:36864
    ds_read_b64_tr_b16 a[10:11], v5 offset:37376
    s_waitcnt lgkmcnt(10)
    v_mfma_f32_32x32x16_bf16 v[32:47], a[16:19], a[112:115], v[32:47]
    v_xor_b32 v4, v8, v4
    ds_read_b64_tr_b16 a[12:13], v5 offset:38912
    ds_read_b64_tr_b16 a[14:15], v5 offset:39424
    v_mfma_f32_32x32x16_bf16 v[32:47], a[20:23], a[116:119], v[32:47]
    ds_read_b64_tr_b16 a[16:17], v5 offset:40960
    ds_read_b64_tr_b16 a[18:19], v5 offset:41472
    s_waitcnt lgkmcnt(10)
    v_mfma_f32_32x32x16_bf16 v[32:47], a[24:27], a[120:123], v[32:47]
    ds_read_b64_tr_b16 a[20:21], v5 offset:43008
    ds_read_b64_tr_b16 a[22:23], v5 offset:43520
    v_mfma_f32_32x32x16_bf16 v[32:47], a[28:31], a[124:127], v[32:47]
    buffer_load_dwordx4 v65, s[4:7], s24 offen offset:1024 lds
    ds_read_b64_tr_b16 a[24:25], v5 offset:45056
    ds_read_b64_tr_b16 a[26:27], v5 offset:45568
    s_waitcnt lgkmcnt(10)
    v_mfma_f32_32x32x16_bf16 v[32:47], a[0:3], a[128:131], v[32:47]
    ds_read_b64_tr_b16 a[28:29], v5 offset:47104
    ds_read_b64_tr_b16 a[30:31], v5 offset:47616
    v_mfma_f32_32x32x16_bf16 v[32:47], a[4:7], a[132:135], v[32:47]
    ds_read_b64_tr_b16 a[0:1], v6 offset:0
    ds_read_b64_tr_b16 a[2:3], v6 offset:512
    s_waitcnt lgkmcnt(10)
    v_mfma_f32_32x32x16_bf16 v[32:47], a[8:11], a[136:139], v[32:47]
    v_xor_b32 v5, 73728, v5
    ds_read_b64_tr_b16 a[4:5], v6 offset:2048
    ds_read_b64_tr_b16 a[6:7], v6 offset:2560
    v_mfma_f32_32x32x16_bf16 v[32:47], a[12:15], a[140:143], v[32:47]
    buffer_load_dwordx4 v66, s[4:7], s24 offen offset:2048 lds
    ds_read_b64_tr_b16 a[8:9], v6 offset:4096
    ds_read_b64_tr_b16 a[10:11], v6 offset:4608
    s_waitcnt lgkmcnt(10)
    v_mfma_f32_32x32x16_bf16 v[32:47], a[16:19], v[192:195], v[32:47]
    ds_read_b64_tr_b16 a[12:13], v6 offset:6144
    ds_read_b64_tr_b16 a[14:15], v6 offset:6656
    v_mfma_f32_32x32x16_bf16 v[32:47], a[20:23], v[196:199], v[32:47]
    ds_read_b64_tr_b16 a[16:17], v6 offset:8192
    ds_read_b64_tr_b16 a[18:19], v6 offset:8704
    s_waitcnt lgkmcnt(10)
    v_mfma_f32_32x32x16_bf16 v[32:47], a[24:27], v[200:203], v[32:47]
    ds_read_b64_tr_b16 a[20:21], v6 offset:10240
    ds_read_b64_tr_b16 a[22:23], v6 offset:10752
    v_mfma_f32_32x32x16_bf16 v[32:47], a[28:31], v[204:207], v[32:47]
    buffer_load_dwordx4 v67, s[4:7], s24 offen offset:3072 lds
    ds_read_b64_tr_b16 a[24:25], v6 offset:12288
    ds_read_b64_tr_b16 a[26:27], v6 offset:12800
    s_waitcnt lgkmcnt(10)
    v_mfma_f32_32x32x16_bf16 v[16:31], a[0:3], v[208:211], v[16:31]
    ds_read_b64_tr_b16 a[28:29], v6 offset:14336
    ds_read_b64_tr_b16 a[30:31], v6 offset:14848
    v_mfma_f32_32x32x16_bf16 v[16:31], a[4:7], v[212:215], v[16:31]
    ds_read_b64_tr_b16 a[0:1], v6 offset:16384
    ds_read_b64_tr_b16 a[2:3], v6 offset:16896
    s_waitcnt lgkmcnt(10)
    v_mfma_f32_32x32x16_bf16 v[16:31], a[8:11], v[216:219], v[16:31]
    s_add_u32 m0, s28, 10240
    ds_read_b64_tr_b16 a[4:5], v6 offset:18432
    ds_read_b64_tr_b16 a[6:7], v6 offset:18944
    v_mfma_f32_32x32x16_bf16 v[16:31], a[12:15], v[220:223], v[16:31]
    buffer_load_dwordx4 v68, s[4:7], s24 offen offset:0 lds
    ds_read_b64_tr_b16 a[8:9], v6 offset:20480
    ds_read_b64_tr_b16 a[10:11], v6 offset:20992
    s_waitcnt lgkmcnt(10)
    v_mfma_f32_32x32x16_bf16 v[16:31], a[16:19], v[224:227], v[16:31]
    ds_read_b64_tr_b16 a[12:13], v6 offset:22528
    ds_read_b64_tr_b16 a[14:15], v6 offset:23040
    v_mfma_f32_32x32x16_bf16 v[16:31], a[20:23], v[228:231], v[16:31]
    ds_read_b64_tr_b16 a[16:17], v7 offset:0
    ds_read_b64_tr_b16 a[18:19], v7 offset:512
    s_waitcnt lgkmcnt(10)
    v_mfma_f32_32x32x16_bf16 v[16:31], a[24:27], v[232:235], v[16:31]
    v_xor_b32 v6, 73728, v6
    ds_read_b64_tr_b16 a[20:21], v7 offset:2048
    ds_read_b64_tr_b16 a[22:23], v7 offset:2560
    v_mfma_f32_32x32x16_bf16 v[16:31], a[28:31], v[236:239], v[16:31]
    buffer_load_dwordx4 v69, s[4:7], s24 offen offset:1024 lds
    ds_read_b64_tr_b16 a[24:25], v7 offset:4096
    ds_read_b64_tr_b16 a[26:27], v7 offset:4608
    s_waitcnt lgkmcnt(10)
    v_mfma_f32_32x32x16_bf16 v[16:31], a[0:3], v[240:243], v[16:31]
    s_add_u32 s24, s24, s26
    ds_read_b64_tr_b16 a[28:29], v7 offset:6144
    ds_read_b64_tr_b16 a[30:31], v7 offset:6656
    v_mfma_f32_32x32x16_bf16 v[16:31], a[4:7], v[244:247], v[16:31]
    s_waitcnt vmcnt(19)
    s_barrier
    ds_read_b64_tr_b16 a[0:1], v7 offset:8192
    ds_read_b64_tr_b16 a[2:3], v7 offset:8704
    s_waitcnt lgkmcnt(10)
    v_mfma_f32_32x32x16_bf16 v[16:31], a[8:11], v[248:251], v[16:31]
    s_add_u32 m0, s28, 30720
    ds_read_b64_tr_b16 a[4:5], v7 offset:10240
    ds_read_b64_tr_b16 a[6:7], v7 offset:10752
    v_mfma_f32_32x32x16_bf16 v[16:31], a[12:15], v[252:255], v[16:31]
    buffer_load_dwordx4 v64, s[4:7], s24 offen offset:0 lds
    ds_read_b64_tr_b16 a[8:9], v7 offset:12288
    ds_read_b64_tr_b16 a[10:11], v7 offset:12800
    s_waitcnt lgkmcnt(10)
    v_mfma_f32_32x32x16_bf16 v[32:47], a[16:19], v[208:211], v[32:47]
    ds_read_b64_tr_b16 a[12:13], v7 offset:14336
    ds_read_b64_tr_b16 a[14:15], v7 offset:14848
    v_mfma_f32_32x32x16_bf16 v[32:47], a[20:23], v[212:215], v[32:47]
    v_mul_f32 v16, v16, v10
    v_mul_f32 v17, v17, v10
    v_mul_f32 v18, v18, v10
    ds_read_b64_tr_b16 a[16:17], v7 offset:16384
    ds_read_b64_tr_b16 a[18:19], v7 offset:16896
    s_waitcnt lgkmcnt(10)
    v_mfma_f32_32x32x16_bf16 v[32:47], a[24:27], v[216:219], v[32:47]
    v_mul_f32 v19, v19, v10
    v_mul_f32 v20, v20, v10
    v_mul_f32 v21, v21, v10
    v_mul_f32 v22, v22, v10
    ds_read_b64_tr_b16 a[20:21], v7 offset:18432
    ds_read_b64_tr_b16 a[22:23], v7 offset:18944
    v_mfma_f32_32x32x16_bf16 v[32:47], a[28:31], v[220:223], v[32:47]
    buffer_load_dwordx4 v65, s[4:7], s24 offen offset:1024 lds
    ds_read_b64_tr_b16 a[24:25], v7 offset:20480
    ds_read_b64_tr_b16 a[26:27], v7 offset:20992
    s_waitcnt lgkmcnt(10)
    v_mfma_f32_32x32x16_bf16 v[32:47], a[0:3], v[224:227], v[32:47]
    v_mul_f32 v23, v23, v10
    v_mul_f32 v24, v24, v10
    v_mul_f32 v25, v25, v10
    v_mul_f32 v26, v26, v10
    ds_read_b64_tr_b16 a[28:29], v7 offset:22528
    ds_read_b64_tr_b16 a[30:31], v7 offset:23040
    v_mfma_f32_32x32x16_bf16 v[32:47], a[4:7], v[228:231], v[32:47]
    v_mul_f32 v27, v27, v10
    v_mul_f32 v28, v28, v10
    v_mul_f32 v29, v29, v10
    ds_read_b64_tr_b16 a[0:1], v4 offset:0
    ds_read_b64_tr_b16 a[2:3], v4 offset:512
    s_waitcnt lgkmcnt(10)
    v_mfma_f32_32x32x16_bf16 v[32:47], a[8:11], v[232:235], v[32:47]
    v_xor_b32 v7, 73728, v7
    v_mul_f32 v30, v30, v10
    v_mul_f32 v31, v31, v10
    ds_read_b64_tr_b16 a[4:5], v4 offset:2048
    ds_read_b64_tr_b16 a[6:7], v4 offset:2560
    v_mfma_f32_32x32x16_bf16 v[32:47], a[12:15], v[236:239], v[32:47]
    buffer_load_dwordx4 v66, s[4:7], s24 offen offset:2048 lds
    ds_read_b64_tr_b16 a[8:9], v4 offset:4096
    ds_read_b64_tr_b16 a[10:11], v4 offset:4608
    s_waitcnt lgkmcnt(10)
    v_mfma_f32_32x32x16_bf16 v[32:47], a[16:19], v[240:243], v[32:47]
    ds_read_b64_tr_b16 a[12:13], v4 offset:6144
    ds_read_b64_tr_b16 a[14:15], v4 offset:6656
    v_mfma_f32_32x32x16_bf16 v[32:47], a[20:23], v[244:247], v[32:47]
    ds_read_b64_tr_b16 a[16:17], v4 offset:8192
    ds_read_b64_tr_b16 a[18:19], v4 offset:8704
    s_waitcnt lgkmcnt(10)
    v_mfma_f32_32x32x16_bf16 v[32:47], a[24:27], v[248:251], v[32:47]
    s_set_gpr_idx_on s32, 0x8
    s_nop 0
    v_cvt_pk_bf16_f32 v80, v16, v17
    v_cvt_pk_bf16_f32 v81, v18, v19
    v_cvt_pk_bf16_f32 v82, v20, v21
    v_cvt_pk_bf16_f32 v83, v22, v23
    v_cvt_pk_bf16_f32 v84, v24, v25
    v_cvt_pk_bf16_f32 v85, v26, v27
    v_cvt_pk_bf16_f32 v86, v28, v29
    v_cvt_pk_bf16_f32 v87, v30, v31
    s_set_gpr_idx_off
    s_add_u32 m0, s28, 30720
    ds_read_b64_tr_b16 a[20:21], v4 offset:10240
    ds_read_b64_tr_b16 a[22:23], v4 offset:10752
    v_mfma_f32_32x32x16_bf16 v[32:47], a[28:31], v[252:255], v[32:47]
    buffer_load_dwordx4 v67, s[4:7], s24 offen offset:3072 lds
    s_xor_b32 s28, s28, 73728
    s_xor_b32 s29, s29, 73728
    s_add_u32 s31, s31, 1
    s_cmp_lt_u32 s31, 7
    s_cbranch_scc1 Lp1_a1
    s_branch Latt
    .p2align 6
Lp1_a2:
    ds_read_b64_tr_b16 a[24:25], v4 offset:12288
    ds_read_b64_tr_b16 a[26:27], v4 offset:12800
    s_waitcnt lgkmcnt(10)
    v_mfma_f32_32x32x16_bf16 v[16:31], a[0:3], a[64:67], 0
    buffer_load_dwordx4 v67, s[4:7], s24 offen offset:3072 lds
    ds_read_b64_tr_b16 a[28:29], v4 offset:14336
    ds_read_b64_tr_b16 a[30:31], v4 offset:14848
    v_mfma_f32_32x32x16_bf16 v[16:31], a[4:7], a[68:71], v[16:31]
    v_mul_f32 v32, v32, v10
    v_mul_f32 v33, v33, v10
    v_mul_f32 v34, v34, v10
    ds_read_b64_tr_b16 a[0:1], v4 offset:16384
    ds_read_b64_tr_b16 a[2:3], v4 offset:16896
    s_waitcnt lgkmcnt(10)
    v_mfma_f32_32x32x16_bf16 v[16:31], a[8:11], a[72:75], v[16:31]
    v_mul_f32 v35, v35, v10
    v_mul_f32 v36, v36, v10
    v_mul_f32 v37, v37, v10
    v_mul_f32 v38, v38, v10
    ds_read_b64_tr_b16 a[4:5], v4 offset:18432
    ds_read_b64_tr_b16 a[6:7], v4 offset:18944
    v_mfma_f32_32x32x16_bf16 v[16:31], a[12:15], a[76:79], v[16:31]
    s_add_u32 m0, s29, 40960
    v_mul_f32 v39, v39, v10
    v_mul_f32 v40, v40, v10
    ds_read_b64_tr_b16 a[8:9], v4 offset:20480
    ds_read_b64_tr_b16 a[10:11], v4 offset:20992
    s_waitcnt lgkmcnt(10)
    v_mfma_f32_32x32x16_bf16 v[16:31], a[16:19], a[80:83], v[16:31]
    buffer_load_dwordx4 v68, s[4:7], s24 offen offset:0 lds
    v_mul_f32 v41, v41, v10
    ds_read_b64_tr_b16 a[12:13], v4 offset:22528
    ds_read_b64_tr_b16 a[14:15], v4 offset:23040
    v_mfma_f32_32x32x16_bf16 v[16:31], a[20:23], a[84:87], v[16:31]
    v_mul_f32 v42, v42, v10
    v_mul_f32 v43, v43, v10
    v_mul_f32 v44, v44, v10
    ds_read_b64_tr_b16 a[16:17], v5 offset:0
    ds_read_b64_tr_b16 a[18:19], v5 offset:512
    s_waitcnt lgkmcnt(10)
    v_mfma_f32_32x32x16_bf16 v[16:31], a[24:27], a[88:91], v[16:31]
    v_mul_f32 v45, v45, v10
    v_mul_f32 v46, v46, v10
    v_mul_f32 v47, v47, v10
    ds_read_b64_tr_b16 a[20:21], v5 offset:2048
    ds_read_b64_tr_b16 a[22:23], v5 offset:2560
    v_mfma_f32_32x32x16_bf16 v[16:31], a[28:31], a[92:95], v[16:31]
    ds_read_b64_tr_b16 a[24:25], v5 offset:4096
    ds_read_b64_tr_b16 a[26:27], v5 offset:4608
    s_waitcnt lgkmcnt(10)
    v_mfma_f32_32x32x16_bf16 v[16:31], a[0:3], a[96:99], v[16:31]
    buffer_load_dwordx4 v69, s[4:7], s24 offen offset:1024 lds
    ds_read_b64_tr_b16 a[28:29], v5 offset:6144
    ds_read_b64_tr_b16 a[30:31], v5 offset:6656
    v_mfma_f32_32x32x16_bf16 v[16:31], a[4:7], a[100:103], v[16:31]
    s_add_u32 s24, s24, s27
    s_waitcnt vmcnt(19)
    s_barrier
    ds_read_b64_tr_b16 a[0:1], v5 offset:8192
    ds_read_b64_tr_b16 a[2:3], v5 offset:8704
    s_waitcnt lgkmcnt(10)
    v_mfma_f32_32x32x16_bf16 v[16:31], a[8:11], a[104:107], v[16:31]
    ds_read_b64_tr_b16 a[4:5], v5 offset:10240
    ds_read_b64_tr_b16 a[6:7], v5 offset:10752
    v_mfma_f32_32x32x16_bf16 v[16:31], a[12:15], a[108:111], v[16:31]
    s_add_u32 m0, s29, 61440
    s_set_gpr_idx_on s32, 0x8
    s_nop 0
    v_cvt_pk_bf16_f32 v88, v32, v33
    v_cvt_pk_bf16_f32 v89, v34, v35
    v_cvt_pk_bf16_f32 v90, v36, v37
    v_cvt_pk_bf16_f32 v91, v38, v39
    v_cvt_pk_bf16_f32 v92, v40, v41
    v_cvt_pk_bf16_f32 v93, v42, v43
    v_cvt_pk_bf16_f32 v94, v44, v45
    v_cvt_pk_bf16_f32 v95, v46, v47
    s_set_gpr_idx_off
    s_add_u32 m0, s29, 61440
    s_add_u32 s32, s32, s33
    s_mov_b32 s33, 16
    ds_read_b64_tr_b16 a[8:9], v5 offset:12288
    ds_read_b64_tr_b16 a[10:11], v5 offset:12800
    s_waitcnt lgkmcnt(10)
    v_mfma_f32_32x32x16_bf16 v[32:47], a[16:19], a[64:67], 0
    buffer_load_dwordx4 v64, s[4:7], s24 offen offset:0 lds
    ds_read_b64_tr_b16 a[12:13], v5 offset:14336
    ds_read_b64_tr_b16 a[14:15], v5 offset:14848
    v_mfma_f32_32x32x16_bf16 v[32:47], a[20:23], a[68:71], v[32:47]
    v_add_u32 v12, 4, v12
    v_subrev_u32 v76, 27, v12
    ds_read_b64_tr_b16 a[16:17], v5 offset:16384
    ds_read_b64_tr_b16 a[18:19], v5 offset:16896
    s_waitcnt lgkmcnt(10)
    v_mfma_f32_32x32x16_bf16 v[32:47], a[24:27], a[72:75], v[32:47]
    buffer_load_dword a63, v79, s[44:47], s52 offen
    ds_read_b64_tr_b16 a[20:21], v5 offset:18432
    ds_read_b64_tr_b16 a[22:23], v5 offset:18944
    v_mfma_f32_32x32x16_bf16 v[32:47], a[28:31], a[76:79], v[32:47]
    s_add_u32 s52, s52, 1792
    v_min_u32 v12, v12, v76
    ds_read_b64_tr_b16 a[24:25], v5 offset:20480
    ds_read_b64_tr_b16 a[26:27], v5 offset:20992
    s_waitcnt lgkmcnt(10)
    v_mfma_f32_32x32x16_bf16 v[32:47], a[0:3], a[80:83], v[32:47]
    buffer_load_dwordx4 v65, s[4:7], s24 offen offset:1024 lds
    ds_read_b64_tr_b16 a[28:29], v5 offset:22528
    ds_read_b64_tr_b16 a[30:31], v5 offset:23040
    v_mfma_f32_32x32x16_bf16 v[32:47], a[4:7], a[84:87], v[32:47]
    s_cmp_ge_u32 s31, 2
    s_cselect_b32 s46, 0, s46
    ds_read_b64_tr_b16 a[0:1], v4 offset:24576
    ds_read_b64_tr_b16 a[2:3], v4 offset:25088
    s_waitcnt lgkmcnt(10)
    v_mfma_f32_32x32x16_bf16 v[32:47], a[8:11], a[88:91], v[32:47]
    v_mul_u32_u24 v76, 57, v12
    v_lshrrev_b32 v76, 9, v76
    v_mul_u32_u24 v76, 864, v76
    ds_read_b64_tr_b16 a[4:5], v4 offset:26624
    ds_read_b64_tr_b16 a[6:7], v4 offset:27136
    v_mfma_f32_32x32x16_bf16 v[32:47], a[12:15], a[92:95], v[32:47]
    v_lshl_add_u32 v77, v12, 5, v76
    v_sub_u32 v76, v77, v13
    ds_read_b64_tr_b16 a[8:9], v4 offset:28672
    ds_read_b64_tr_b16 a[10:11], v4 offset:29184
    s_waitcnt lgkmcnt(10)
    v_mfma_f32_32x32x16_bf16 v[32:47], a[16:19], a[96:99], v[32:47]
    buffer_load_dwordx4 v66, s[4:7], s24 offen offset:2048 lds
    ds_read_b64_tr_b16 a[12:13], v4 offset:30720
    ds_read_b64_tr_b16 a[14:15], v4 offset:31232
    v_mfma_f32_32x32x16_bf16 v[32:47], a[20:23], a[100:103], v[32:47]
    v_mov_b32 v13, v77
    ds_read_b64_tr_b16 a[16:17], v4 offset:32768
    ds_read_b64_tr_b16 a[18:19], v4 offset:33280
    s_waitcnt lgkmcnt(10)
    v_mfma_f32_32x32x16_bf16 v[32:47], a[24:27], a[104:107], v[32:47]
    ds_read_b64_tr_b16 a[20:21], v4 offset:34816
    ds_read_b64_tr_b16 a[22:23], v4 offset:35328
    v_mfma_f32_32x32x16_bf16 v[32:47], a[28:31], a[108:111], v[32:47]
    ds_read_b64_tr_b16 a[24:25], v4 offset:36864
    ds_read_b64_tr_b16 a[26:27], v4 offset:37376
    s_waitcnt lgkmcnt(10)
    v_mfma_f32_32x32x16_bf16 v[16:31], a[0:3], a[112:115], v[16:31]
    buffer_load_dwordx4 v67, s[4:7], s24 offen offset:3072 lds
    ds_read_b64_tr_b16 a[28:29], v4 offset:38912
    ds_read_b64_tr_b16 a[30:31], v4 offset:39424
    v_mfma_f32_32x32x16_bf16 v[16:31], a[4:7], a[116:119], v[16:31]
    ds_read_b64_tr_b16 a[0:1], v4 offset:40960
    ds_read_b64_tr_b16 a[2:3], v4 offset:41472
    s_waitcnt lgkmcnt(10)
    v_mfma_f32_32x32x16_bf16 v[16:31], a[8:11], a[120:123], v[16:31]
    ds_read_b64_tr_b16 a[4:5], v4 offset:43008
    ds_read_b64_tr_b16 a[6:7], v4 offset:43520
    v_mfma_f32_32x32x16_bf16 v[16:31], a[12:15], a[124:127], v[16:31]
    s_add_u32 m0, s29, 65536
    ds_read_b64_tr_b16 a[8:9], v4 offset:45056
    ds_read_b64_tr_b16 a[10:11], v4 offset:45568
    s_waitcnt lgkmcnt(10)
    v_mfma_f32_32x32x16_bf16 v[16:31], a[16:19], a[128:131], v[16:31]
    buffer_load_dwordx4 v68, s[4:7], s24 offen offset:0 lds
    ds_read_b64_tr_b16 a[12:13], v4 offset:47104
    ds_read_b64_tr_b16 a[14:15], v4 offset:47616
    v_mfma_f32_32x32x16_bf16 v[16:31], a[20:23], a[132:135], v[16:31]
    v_add_u32 v64, v64, v76
    v_add_u32 v65, v65, v76
    ds_read_b64_tr_b16 a[16:17], v5 offset:24576
    ds_read_b64_tr_b16 a[18:19], v5 offset:25088
    s_waitcnt lgkmcnt(10)
    v_mfma_f32_32x32x16_bf16 v[16:31], a[24:27], a[136:139], v[16:31]
    v_add_u32 v66, v66, v76
    v_add_u32 v67, v67, v76
    v_add_u32 v68, v68, v76
    ds_read_b64_tr_b16 a[20:21], v5 offset:26624
    ds_read_b64_tr_b16 a[22:23], v5 offset:27136
    v_mfma_f32_32x32x16_bf16 v[16:31], a[28:31], a[140:143], v[16:31]
    ds_read_b64_tr_b16 a[24:25], v5 offset:28672
    ds_read_b64_tr_b16 a[26:27], v5 offset:29184
    s_waitcnt lgkmcnt(10)
    v_mfma_f32_32x32x16_bf16 v[16:31], a[0:3], v[192:195], v[16:31]
    buffer_load_dwordx4 v69, s[4:7], s24 offen offset:1024 lds
    ds_read_b64_tr_b16 a[28:29], v5 offset:30720
    ds_read_b64_tr_b16 a[30:31], v5 offset:31232
    v_mfma_f32_32x32x16_bf16 v[16:31], a[4:7], v[196:199], v[16:31]
    s_add_u32 s24, s24, s25
    s_waitcnt vmcnt(19)
    s_barrier
    ds_read_b64_tr_b16 a[0:1], v5 offset:32768
    ds_read_b64_tr_b16 a[2:3], v5 offset:33280
    s_waitcnt lgkmcnt(10)
    v_mfma_f32_32x32x16_bf16 v[16:31], a[8:11], v[200:203], v[16:31]
    s_cmp_ge_u32 s31, 5
    s_cselect_b32 s6, 0, s6
    v_add_u32 v69, v69, v76
    ds_read_b64_tr_b16 a[4:5], v5 offset:34816
    ds_read_b64_tr_b16 a[6:7], v5 offset:35328
    v_mfma_f32_32x32x16_bf16 v[16:31], a[12:15], v[204:207], v[16:31]
    s_add_u32 m0, s28, 12288
    ds_read_b64_tr_b16 a[8:9], v5 offset:36864
    ds_read_b64_tr_b16 a[10:11], v5 offset:37376
    s_waitcnt lgkmcnt(10)
    v_mfma_f32_32x32x16_bf16 v[32:47], a[16:19], a[112:115], v[32:47]
    buffer_load_dwordx4 v64, s[4:7], s24 offen offset:0 lds
    ds_read_b64_tr_b16 a[12:13], v5 offset:38912
    ds_read_b64_tr_b16 a[14:15], v5 offset:39424
    v_mfma_f32_32x32x16_bf16 v[32:47], a[20:23], a[116:119], v[32:47]
    v_xor_b32 v4, v8, v4
    ds_read_b64_tr_b16 a[16:17], v5 offset:40960
    ds_read_b64_tr_b16 a[18:19], v5 offset:41472
    s_waitcnt lgkmcnt(10)
    v_mfma_f32_32x32x16_bf16 v[32:47], a[24:27], a[120:123], v[32:47]
    ds_read_b64_tr_b16 a[20:21], v5 offset:43008
    ds_read_b64_tr_b16 a[22:23], v5 offset:43520
    v_mfma_f32_32x32x16_bf16 v[32:47], a[28:31], a[124:127], v[32:47]
    ds_read_b64_tr_b16 a[24:25], v5 offset:45056
    ds_read_b64_tr_b16 a[26:27], v5 offset:45568
    s_waitcnt lgkmcnt(10)
    v_mfma_f32_32x32x16_bf16 v[32:47], a[0:3], a[128:131], v[32:47]
    buffer_load_dwordx4 v65, s[4:7], s24 offen offset:1024 lds
    ds_read_b64_tr_b16 a[28:29], v5 offset:47104
    ds_read_b64_tr_b16 a[30:31], v5 offset:47616
    v_mfma_f32_32x32x16_bf16 v[32:47], a[4:7], a[132:135], v[32:47]
    ds_read_b64_tr_b16 a[0:1], v6 offset:0
    ds_read_b64_tr_b16 a[2:3], v6 offset:512
    s_waitcnt lgkmcnt(10)
    v_mfma_f32_32x32x16_bf16 v[32:47], a[8:11], a[136:139], v[32:47]
    v_xor_b32 v5, 73728, v5
    ds_read_b64_tr_b16 a[4:5], v6 offset:2048
    ds_read_b64_tr_b16 a[6:7], v6 offset:2560
    v_mfma_f32_32x32x16_bf16 v[32:47], a[12:15], a[140:143], v[32:47]
    ds_read_b64_tr_b16 a[8:9], v6 offset:4096
    ds_read_b64_tr_b16 a[10:11], v6 offset:4608
    s_waitcnt lgkmcnt(10)
    v_mfma_f32_32x32x16_bf16 v[32:47], a[16:19], v[192:195], v[32:47]
    buffer_load_dwordx4 v66, s[4:7], s24 offen offset:2048 lds
    ds_read_b64_tr_b16 a[12:13], v6 offset:6144
    ds_read_b64_tr_b16 a[14:15], v6 offset:6656
    v_mfma_f32_32x32x16_bf16 v[32:47], a[20:23], v[196:199], v[32:47]
    ds_read_b64_tr_b16 a[16:17], v6 offset:8192
    ds_read_b64_tr_b16 a[18:19], v6 offset:8704
    s_waitcnt lgkmcnt(10)
    v_mfma_f32_32x32x16_bf16 v[32:47], a[24:27], v[200:203], v[32:47]
    ds_read_b64_tr_b16 a[20:21], v6 offset:10240
    ds_read_b64_tr_b16 a[22:23], v6 offset:10752
    v_mfma_f32_32x32x16_bf16 v[32:47], a[28:31], v[204:207], v[32:47]
    ds_read_b64_tr_b16 a[24:25], v6 offset:12288
    ds_read_b64_tr_b16 a[26:27], v6 offset:12800
    s_waitcnt lgkmcnt(10)
    v_mfma_f32_32x32x16_bf16 v[16:31], a[0:3], v[208:211], v[16:31]
    buffer_load_dwordx4 v67, s[4:7], s24 offen offset:3072 lds
    ds_read_b64_tr_b16 a[28:29], v6 offset:14336
    ds_read_b64_tr_b16 a[30:31], v6 offset:14848
    v_mfma_f32_32x32x16_bf16 v[16:31], a[4:7], v[212:215], v[16:31]
    ds_read_b64_tr_b16 a[0:1], v6 offset:16384
    ds_read_b64_tr_b16 a[2:3], v6 offset:16896
    s_waitcnt lgkmcnt(10)
    v_mfma_f32_32x32x16_bf16 v[16:31], a[8:11], v[216:219], v[16:31]
    ds_read_b64_tr_b16 a[4:5], v6 offset:18432
    ds_read_b64_tr_b16 a[6:7], v6 offset:18944
    v_mfma_f32_32x32x16_bf16 v[16:31], a[12:15], v[220:223], v[16:31]
    s_add_u32 m0, s28, 16384
    ds_read_b64_tr_b16 a[8:9], v6 offset:20480
    ds_read_b64_tr_b16 a[10:11], v6 offset:20992
    s_waitcnt lgkmcnt(10)
    v_mfma_f32_32x32x16_bf16 v[16:31], a[16:19], v[224:227], v[16:31]
    buffer_load_dwordx4 v68, s[4:7], s24 offen offset:0 lds
    ds_read_b64_tr_b16 a[12:13], v6 offset:22528
    ds_read_b64_tr_b16 a[14:15], v6 offset:23040
    v_mfma_f32_32x32x16_bf16 v[16:31], a[20:23], v[228:231], v[16:31]
    ds_read_b64_tr_b16 a[16:17], v7 offset:0
    ds_read_b64_tr_b16 a[18:19], v7 offset:512
    s_waitcnt lgkmcnt(10)
    v_mfma_f32_32x32x16_bf16 v[16:31], a[24:27], v[232:235], v[16:31]
    v_xor_b32 v6, 73728, v6
    ds_read_b64_tr_b16 a[20:21], v7 offset:2048
    ds_read_b64_tr_b16 a[22:23], v7 offset:2560
    v_mfma_f32_32x32x16_bf16 v[16:31], a[28:31], v[236:239], v[16:31]
    ds_read_b64_tr_b16 a[24:25], v7 offset:4096
    ds_read_b64_tr_b16 a[26:27], v7 offset:4608
    s_waitcnt lgkmcnt(10)
    v_mfma_f32_32x32x16_bf16 v[16:31], a[0:3], v[240:243], v[16:31]
    buffer_load_dwordx4 v69, s[4:7], s24 offen offset:1024 lds
    ds_read_b64_tr_b16 a[28:29], v7 offset:6144
    ds_read_b64_tr_b16 a[30:31], v7 offset:6656
    v_mfma_f32_32x32x16_bf16 v[16:31], a[4:7], v[244:247], v[16:31]
    s_add_u32 s24, s24, s26
    s_waitcnt vmcnt(19)
    s_barrier
    ds_read_b64_tr_b16 a[0:1], v7 offset:8192
    ds_read_b64_tr_b16 a[2:3], v7 offset:8704
    s_waitcnt lgkmcnt(10)
    v_mfma_f32_32x32x16_bf16 v[16:31], a[8:11], v[248:251], v[16:31]
    ds_read_b64_tr_b16 a[4:5], v7 offset:10240
    ds_read_b64_tr_b16 a[6:7], v7 offset:10752
    v_mfma_f32_32x32x16_bf16 v[16:31], a[12:15], v[252:255], v[16:31]
    s_add_u32 m0, s28, 36864
    ds_read_b64_tr_b16 a[8:9], v7 offset:12288
    ds_read_b64_tr_b16 a[10:11], v7 offset:12800
    s_waitcnt lgkmcnt(10)
    v_mfma_f32_32x32x16_bf16 v[32:47], a[16:19], v[208:211], v[32:47]
    buffer_load_dwordx4 v64, s[4:7], s24 offen offset:0 lds
    ds_read_b64_tr_b16 a[12:13], v7 offset:14336
    ds_read_b64_tr_b16 a[14:15], v7 offset:14848
    v_mfma_f32_32x32x16_bf16 v[32:47], a[20:23], v[212:215], v[32:47]
    v_mul_f32 v16, v16, v10
    v_mul_f32 v17, v17, v10
    v_mul_f32 v18, v18, v10
    ds_read_b64_tr_b16 a[16:17], v7 offset:16384
    ds_read_b64_tr_b16 a[18:19], v7 offset:16896
    s_waitcnt lgkmcnt(10)
    v_mfma_f32_32x32x16_bf16 v[32:47], a[24:27], v[216:219], v[32:47]
    v_mul_f32 v19, v19, v10
    v_mul_f32 v20, v20, v10
    v_mul_f32 v21, v21, v10
    v_mul_f32 v22, v22, v10
    ds_read_b64_tr_b16 a[20:21], v7 offset:18432
    ds_read_b64_tr_b16 a[22:23], v7 offset:18944
    v_mfma_f32_32x32x16_bf16 v[32:47], a[28:31], v[220:223], v[32:47]
    v_mul_f32 v23, v23, v10
    v_mul_f32 v24, v24, v10
    v_mul_f32 v25, v25, v10
    ds_read_b64_tr_b16 a[24:25], v7 offset:20480
    ds_read_b64_tr_b16 a[26:27], v7 offset:20992
    s_waitcnt lgkmcnt(10)
    v_mfma_f32_32x32x16_bf16 v[32:47], a[0:3], v[224:227], v[32:47]
    buffer_load_dwordx4 v65, s[4:7], s24 offen offset:1024 lds
    v_mul_f32 v26, v26, v10
    ds_read_b64_tr_b16 a[28:29], v7 offset:22528
    ds_read_b64_tr_b16 a[30:31], v7 offset:23040
    v_mfma_f32_32x32x16_bf16 v[32:47], a[4:7], v[228:231], v[32:47]
    v_mul_f32 v27, v27, v10
    v_mul_f32 v28, v28, v10
    v_mul_f32 v29, v29, v10
    ds_read_b64_tr_b16 a[0:1], v4 offset:0
    ds_read_b64_tr_b16 a[2:3], v4 offset:512
    s_waitcnt lgkmcnt(10)
    v_mfma_f32_32x32x16_bf16 v[32:47], a[8:11], v[232:235], v[32:47]
    v_xor_b32 v7, 73728, v7
    v_mul_f32 v30, v30, v10
    v_mul_f32 v31, v31, v10
    ds_read_b64_tr_b16 a[4:5], v4 offset:2048
    ds_read_b64_tr_b16 a[6:7], v4 offset:2560
    v_mfma_f32_32x32x16_bf16 v[32:47], a[12:15], v[236:239], v[32:47]
    ds_read_b64_tr_b16 a[8:9], v4 offset:4096
    ds_read_b64_tr_b16 a[10:11], v4 offset:4608
    s_waitcnt lgkmcnt(10)
    v_mfma_f32_32x32x16_bf16 v[32:47], a[16:19], v[240:243], v[32:47]
    buffer_load_dwordx4 v66, s[4:7], s24 offen offset:2048 lds
    ds_read_b64_tr_b16 a[12:13], v4 offset:6144
    ds_read_b64_tr_b16 a[14:15], v4 offset:6656
    v_mfma_f32_32x32x16_bf16 v[32:47], a[20:23], v[244:247], v[32:47]
    ds_read_b64_tr_b16 a[16:17], v4 offset:8192
    ds_read_b64_tr_b16 a[18:19], v4 offset:8704
    s_waitcnt lgkmcnt(10)
    v_mfma_f32_32x32x16_bf16 v[32:47], a[24:27], v[248:251], v[32:47]
    ds_read_b64_tr_b16 a[20:21], v4 offset:10240
    ds_read_b64_tr_b16 a[22:23], v4 offset:10752
    v_mfma_f32_32x32x16_bf16 v[32:47], a[28:31], v[252:255], v[32:47]
    s_set_gpr_idx_on s32, 0x8
    s_nop 0
    v_cvt_pk_bf16_f32 v80, v16, v17
    v_cvt_pk_bf16_f32 v81, v18, v19
    v_cvt_pk_bf16_f32 v82, v20, v21
    v_cvt_pk_bf16_f32 v83, v22, v23
    v_cvt_pk_bf16_f32 v84, v24, v25
    v_cvt_pk_bf16_f32 v85, v26, v27
    v_cvt_pk_bf16_f32 v86, v28, v29
    v_cvt_pk_bf16_f32 v87, v30, v31
    s_set_gpr_idx_off
    s_add_u32 m0, s28, 36864
    s_xor_b32 s28, s28, 73728
    s_xor_b32 s29, s29, 73728
    s_add_u32 s31, s31, 1
    s_cmp_lt_u32 s31, 7
    s_cbranch_scc1 Lp1_a2
    s_branch Latt
    .p2align 6
Lp1_a3:
    ds_read_b64_tr_b16 a[24:25], v4 offset:12288
    ds_read_b64_tr_b16 a[26:27], v4 offset:12800
    s_waitcnt lgkmcnt(10)
    v_mfma_f32_32x32x16_bf16 v[16:31], a[0:3], a[64:67], 0
    ds_read_b64_tr_b16 a[28:29], v4 offset:14336
    ds_read_b64_tr_b16 a[30:31], v4 offset:14848
    v_mfma_f32_32x32x16_bf16 v[16:31], a[4:7], a[68:71], v[16:31]
    buffer_load_dwordx4 v67, s[4:7], s24 offen offset:3072 lds
    ds_read_b64_tr_b16 a[0:1], v4 offset:16384
    ds_read_b64_tr_b16 a[2:3], v4 offset:16896
    s_waitcnt lgkmcnt(10)
    v_mfma_f32_32x32x16_bf16 v[16:31], a[8:11], a[72:75], v[16:31]
    v_mul_f32 v32, v32, v10
    v_mul_f32 v33, v33, v10
    v_mul_f32 v34, v34, v10
    v_mul_f32 v35, v35, v10
    ds_read_b64_tr_b16 a[4:5], v4 offset:18432
    ds_read_b64_tr_b16 a[6:7], v4 offset:18944
    v_mfma_f32_32x32x16_bf16 v[16:31], a[12:15], a[76:79], v[16:31]
    v_mul_f32 v36, v36, v10
    v_mul_f32 v37, v37, v10
    v_mul_f32 v38, v38, v10
    ds_read_b64_tr_b16 a[8:9], v4 offset:20480
    ds_read_b64_tr_b16 a[10:11], v4 offset:20992
    s_waitcnt lgkmcnt(10)
    v_mfma_f32_32x32x16_bf16 v[16:31], a[16:19], a[80:83], v[16:31]
    s_add_u32 m0, s29, 47104
    v_mul_f32 v39, v39, v10
    v_mul_f32 v40, v40, v10
    v_mul_f32 v41, v41, v10
    ds_read_b64_tr_b16 a[12:13], v4 offset:22528
    ds_read_b64_tr_b16 a[14:15], v4 offset:23040
    v_mfma_f32_32x32x16_bf16 v[16:31], a[20:23], a[84:87], v[16:31]
    buffer_load_dwordx4 v68, s[4:7], s24 offen offset:0 lds
    ds_read_b64_tr_b16 a[16:17], v5 offset:0
    ds_read_b64_tr_b16 a[18:19], v5 offset:512
    s_waitcnt lgkmcnt(10)
    v_mfma_f32_32x32x16_bf16 v[16:31], a[24:27], a[88:91], v[16:31]
    v_mul_f32 v42, v42, v10
    v_mul_f32 v43, v43, v10
    v_mul_f32 v44, v44, v10
    v_mul_f32 v45, v45, v10
    ds_read_b64_tr_b16 a[20:21], v5 offset:2048
    ds_read_b64_tr_b16 a[22:23], v5 offset:2560
    v_mfma_f32_32x32x16_bf16 v[16:31], a[28:31], a[92:95], v[16:31]
    v_mul_f32 v46, v46, v10
    v_mul_f32 v47, v47, v10
    ds_read_b64_tr_b16 a[24:25], v5 offset:4096
    ds_read_b64_tr_b16 a[26:27], v5 offset:4608
    s_waitcnt lgkmcnt(10)
    v_mfma_f32_32x32x16_bf16 v[16:31], a[0:3], a[96:99], v[16:31]
    ds_read_b64_tr_b16 a[28:29], v5 offset:6144
    ds_read_b64_tr_b16 a[30:31], v5 offset:6656
    v_mfma_f32_32x32x16_bf16 v[16:31], a[4:7], a[100:103], v[16:31]
    buffer_load_dwordx4 v69, s[4:7], s24 offen offset:1024 lds
    s_waitcnt vmcnt(19)
    s_barrier
    ds_read_b64_tr_b16 a[0:1], v5 offset:8192
    ds_read_b64_tr_b16 a[2:3], v5 offset:8704
    s_waitcnt lgkmcnt(10)
    v_mfma_f32_32x32x16_bf16 v[16:31], a[8:11], a[104:107], v[16:31]
    s_add_u32 s24, s24, s27
    ds_read_b64_tr_b16 a[4:5], v5 offset:10240
    ds_read_b64_tr_b16 a[6:7], v5 offset:10752
    v_mfma_f32_32x32x16_bf16 v[16:31], a[12:15], a[108:111], v[16:31]
    s_set_gpr_idx_on s32, 0x8
    s_nop 0
    v_cvt_pk_bf16_f32 v88, v32, v33
    v_cvt_pk_bf16_f32 v89, v34, v35
    v_cvt_pk_bf16_f32 v90, v36, v37
    v_cvt_pk_bf16_f32 v91, v38, v39
    v_cvt_pk_bf16_f32 v92, v40, v41
    v_cvt_pk_bf16_f32 v93, v42, v43
    v_cvt_pk_bf16_f32 v94, v44, v45
    v_cvt_pk_bf16_f32 v95, v46, v47
    s_set_gpr_idx_off
    s_add_u32 s32, s32, s33
    s_mov_b32 s33, 16
    ds_read_b64_tr_b16 a[8:9], v5 offset:12288
    ds_read_b64_tr_b16 a[10:11], v5 offset:12800
    s_waitcnt lgkmcnt(10)
    v_mfma_f32_32x32x16_bf16 v[32:47], a[16:19], a[64:67], 0
    s_add_u32 m0, s29, 67584
    v_add_u32 v12, 4, v12
    v_subrev_u32 v76, 27, v12
    ds_read_b64_tr_b16 a[12:13], v5 offset:14336
    ds_read_b64_tr_b16 a[14:15], v5 offset:14848
    v_mfma_f32_32x32x16_bf16 v[32:47], a[20:23], a[68:71], v[32:47]
    buffer_load_dwordx4 v64, s[4:7], s24 offen offset:0 lds
    ds_read_b64_tr_b16 a[16:17], v5 offset:16384
    ds_read_b64_tr_b16 a[18:19], v5 offset:16896
    s_waitcnt lgkmcnt(10)
    v_mfma_f32_32x32x16_bf16 v[32:47], a[24:27], a[72:75], v[32:47]
    v_min_u32 v12, v12, v76
    v_mul_u32_u24 v76, 57, v12
    v_lshrrev_b32 v76, 9, v76
    ds_read_b64_tr_b16 a[20:21], v5 offset:18432
    ds_read_b64_tr_b16 a[22:23], v5 offset:18944
    v_mfma_f32_32x32x16_bf16 v[32:47], a[28:31], a[76:79], v[32:47]
    buffer_load_dword a63, v79, s[44:47], s52 offen
    ds_read_b64_tr_b16 a[24:25], v5 offset:20480
    ds_read_b64_tr_b16 a[26:27], v5 offset:20992
    s_waitcnt lgkmcnt(10)
    v_mfma_f32_32x32x16_bf16 v[32:47], a[0:3], a[80:83], v[32:47]
    s_add_u32 s52, s52, 1792
    s_cmp_ge_u32 s31, 2
    s_cselect_b32 s46, 0, s46
    ds_read_b64_tr_b16 a[28:29], v5 offset:22528
    ds_read_b64_tr_b16 a[30:31], v5 offset:23040
    v_mfma_f32_32x32x16_bf16 v[32:47], a[4:7], a[84:87], v[32:47]
    buffer_load_dwordx4 v65, s[4:7], s24 offen offset:1024 lds
    ds_read_b64_tr_b16 a[0:1], v4 offset:24576
    ds_read_b64_tr_b16 a[2:3], v4 offset:25088
    s_waitcnt lgkmcnt(10)
    v_mfma_f32_32x32x16_bf16 v[32:47], a[8:11], a[88:91], v[32:47]
    v_mul_u32_u24 v76, 864, v76
    v_lshl_add_u32 v77, v12, 5, v76
    v_sub_u32 v76, v77, v13
    ds_read_b64_tr_b16 a[4:5], v4 offset:26624
    ds_read_b64_tr_b16 a[6:7], v4 offset:27136
    v_mfma_f32_32x32x16_bf16 v[32:47], a[12:15], a[92:95], v[32:47]
    v_mov_b32 v13, v77
    ds_read_b64_tr_b16 a[8:9], v4 offset:28672
    ds_read_b64_tr_b16 a[10:11], v4 offset:29184
    s_waitcnt lgkmcnt(10)
    v_mfma_f32_32x32x16_bf16 v[32:47], a[16:19], a[96:99], v[32:47]
    ds_read_b64_tr_b16 a[12:13], v4 offset:30720
    ds_read_b64_tr_b16 a[14:15], v4 offset:31232
    v_mfma_f32_32x32x16_bf16 v[32:47], a[20:23], a[100:103], v[32:47]
    buffer_load_dwordx4 v66, s[4:7], s24 offen offset:2048 lds
    ds_read_b64_tr_b16 a[16:17], v4 offset:32768
    ds_read_b64_tr_b16 a[18:19], v4 offset:33280
    s_waitcnt lgkmcnt(10)
    v_mfma_f32_32x32x16_bf16 v[32:47], a[24:27], a[104:107], v[32:47]
    ds_read_b64_tr_b16 a[20:21], v4 offset:34816
    ds_read_b64_tr_b16 a[22:23], v4 offset:35328
    v_mfma_f32_32x32x16_bf16 v[32:47], a[28:31], a[108:111], v[32:47]
    ds_read_b64_tr_b16 a[24:25], v4 offset:36864
    ds_read_b64_tr_b16 a[26:27], v4 offset:37376
    s_waitcnt lgkmcnt(10)
    v_mfma_f32_32x32x16_bf16 v[16:31], a[0:3], a[112:115], v[16:31]
    ds_read_b64_tr_b16 a[28:29], v4 offset:38912
    ds_read_b64_tr_b16 a[30:31], v4 offset:39424
    v_mfma_f32_32x32x16_bf16 v[16:31], a[4:7], a[116:119], v[16:31]
    buffer_load_dwordx4 v67, s[4:7], s24 offen offset:3072 lds
    ds_read_b64_tr_b16 a[0:1], v4 offset:40960
    ds_read_b64_tr_b16 a[2:3], v4 offset:41472
    s_waitcnt lgkmcnt(10)
    v_mfma_f32_32x32x16_bf16 v[16:31], a[8:11], a[120:123], v[16:31]
    ds_read_b64_tr_b16 a[4:5], v4 offset:43008
    ds_read_b64_tr_b16 a[6:7], v4 offset:43520
    v_mfma_f32_32x32x16_bf16 v[16:31], a[12:15], a[124:127], v[16:31]
    ds_read_b64_tr_b16 a[8:9], v4 offset:45056
    ds_read_b64_tr_b16 a[10:11], v4 offset:45568
    s_waitcnt lgkmcnt(10)
    v_mfma_f32_32x32x16_bf16 v[16:31], a[16:19], a[128:131], v[16:31]
    s_add_u32 m0, s29, 71680
    ds_read_b64_tr_b16 a[12:13], v4 offset:47104
    ds_read_b64_tr_b16 a[14:15], v4 offset:47616
    v_mfma_f32_32x32x16_bf16 v[16:31], a[20:23], a[132:135], v[16:31]
    buffer_load_dwordx4 v68, s[4:7], s24 offen offset:0 lds
    ds_read_b64_tr_b16 a[16:17], v5 offset:24576
    ds_read_b64_tr_b16 a[18:19], v5 offset:25088
    s_waitcnt lgkmcnt(10)
    v_mfma_f32_32x32x16_bf16 v[16:31], a[24:27], a[136:139], v[16:31]
    v_add_u32 v64, v64, v76
    v_add_u32 v65, v65, v76
    v_add_u32 v66, v66, v76
    ds_read_b64_tr_b16 a[20:21], v5 offset:26624
    ds_read_b64_tr_b16 a[22:23], v5 offset:27136
    v_mfma_f32_32x32x16_bf16 v[16:31], a[28:31], a[140:143], v[16:31]
    v_add_u32 v67, v67, v76
    v_add_u32 v68, v68, v76
    ds_read_b64_tr_b16 a[24:25], v5 offset:28672
    ds_read_b64_tr_b16 a[26:27], v5 offset:29184
    s_waitcnt lgkmcnt(10)
    v_mfma_f32_32x32x16_bf16 v[16:31], a[0:3], v[192:195], v[16:31]
    ds_read_b64_tr_b16 a[28:29], v5 offset:30720
    ds_read_b64_tr_b16 a[30:31], v5 offset:31232
    v_mfma_f32_32x32x16_bf16 v[16:31], a[4:7], v[196:199], v[16:31]
    buffer_load_dwordx4 v69, s[4:7], s24 offen offset:1024 lds
    s_waitcnt vmcnt(19)
    s_barrier
    ds_read_b64_tr_b16 a[0:1], v5 offset:32768
    ds_read_b64_tr_b16 a[2:3], v5 offset:33280
    s_waitcnt lgkmcnt(10)
    v_mfma_f32_32x32x16_bf16 v[16:31], a[8:11], v[200:203], v[16:31]
    s_add_u32 s24, s24, s25
    v_add_u32 v69, v69, v76
    ds_read_b64_tr_b16 a[4:5], v5 offset:34816
    ds_read_b64_tr_b16 a[6:7], v5 offset:35328
    v_mfma_f32_32x32x16_bf16 v[16:31], a[12:15], v[204:207], v[16:31]
    s_cmp_ge_u32 s31, 5
    s_cselect_b32 s6, 0, s6
    ds_read_b64_tr_b16 a[8:9], v5 offset:36864
    ds_read_b64_tr_b16 a[10:11], v5 offset:37376
    s_waitcnt lgkmcnt(10)
    v_mfma_f32_32x32x16_bf16 v[32:47], a[16:19], a[112:115], v[32:47]
    s_add_u32 m0, s28, 18432
    v_xor_b32 v4, v8, v4
    ds_read_b64_tr_b16 a[12:13], v5 offset:38912
    ds_read_b64_tr_b16 a[14:15], v5 offset:39424
    v_mfma_f32_32x32x16_bf16 v[32:47], a[20:23], a[116:119], v[32:47]
    buffer_load_dwordx4 v64, s[4:7], s24 offen offset:0 lds
    ds_read_b64_tr_b16 a[16:17], v5 offset:40960
    ds_read_b64_tr_b16 a[18:19], v5 offset:41472
    s_waitcnt lgkmcnt(10)
    v_mfma_f32_32x32x16_bf16 v[32:47], a[24:27], a[120:123], v[32:47]
    ds_read_b64_tr_b16 a[20:21], v5 offset:43008
    ds_read_b64_tr_b16 a[22:23], v5 offset:43520
    v_mfma_f32_32x32x16_bf16 v[32:47], a[28:31], a[124:127], v[32:47]
    ds_read_b64_tr_b16 a[24:25], v5 offset:45056
    ds_read_b64_tr_b16 a[26:27], v5 offset:45568
    s_waitcnt lgkmcnt(10)
    v_mfma_f32_32x32x16_bf16 v[32:47], a[0:3], a[128:131], v[32:47]
    s_cmp_ge_u32 s31, 5
    s_cbranch_scc1 Lpub
Lpubr:
    ds_read_b64_tr_b16 a[28:29], v5 offset:47104
    ds_read_b64_tr_b16 a[30:31], v5 offset:47616
    v_mfma_f32_32x32x16_bf16 v[32:47], a[4:7], a[132:135], v[32:47]
    buffer_load_dwordx4 v65, s[4:7], s24 offen offset:1024 lds
    ds_read_b64_tr_b16 a[0:1], v6 offset:0
    ds_read_b64_tr_b16 a[2:3], v6 offset:512
    s_waitcnt lgkmcnt(10)
    v_mfma_f32_32x32x16_bf16 v[32:47], a[8:11], a[136:139], v[32:47]
    v_xor_b32 v5, 73728, v5
    ds_read_b64_tr_b16 a[4:5], v6 offset:2048
    ds_read_b64_tr_b16 a[6:7], v6 offset:2560
    v_mfma_f32_32x32x16_bf16 v[32:47], a[12:15], a[140:143], v[32:47]
    ds_read_b64_tr_b16 a[8:9], v6 offset:4096
    ds_read_b64_tr_b16 a[10:11], v6 offset:4608
    s_waitcnt lgkmcnt(10)
    v_mfma_f32_32x32x16_bf16 v[32:47], a[16:19], v[192:195], v[32:47]
    ds_read_b64_tr_b16 a[12:13], v6 offset:6144
    ds_read_b64_tr_b16 a[14:15], v6 offset:6656
    v_mfma_f32_32x32x16_bf16 v[32:47], a[20:23], v[196:199], v[32:47]
    buffer_load_dwordx4 v66, s[4:7], s24 offen offset:2048 lds
    ds_read_b64_tr_b16 a[16:17], v6 offset:8192
    ds_read_b64_tr_b16 a[18:19], v6 offset:8704
    s_waitcnt lgkmcnt(10)
    v_mfma_f32_32x32x16_bf16 v[32:47], a[24:27], v[200:203], v[32:47]
    ds_read_b64_tr_b16 a[20:21], v6 offset:10240
    ds_read_b64_tr_b16 a[22:23], v6 offset:10752
    v_mfma_f32_32x32x16_bf16 v[32:47], a[28:31], v[204:207], v[32:47]
    ds_read_b64_tr_b16 a[24:25], v6 offset:12288
    ds_read_b64_tr_b16 a[26:27], v6 offset:12800
    s_waitcnt lgkmcnt(10)
    v_mfma_f32_32x32x16_bf16 v[16:31], a[0:3], v[208:211], v[16:31]
    ds_read_b64_tr_b16 a[28:29], v6 offset:14336
    ds_read_b64_tr_b16 a[30:31], v6 offset:14848
    v_mfma_f32_32x32x16_bf16 v[16:31], a[4:7], v[212:215], v[16:31]
    buffer_load_dwordx4 v67, s[4:7], s24 offen offset:3072 lds
    ds_read_b64_tr_b16 a[0:1], v6 offset:16384
    ds_read_b64_tr_b16 a[2:3], v6 offset:16896
    s_waitcnt lgkmcnt(10)
    v_mfma_f32_32x32x16_bf16 v[16:31], a[8:11], v[216:219], v[16:31]
    ds_read_b64_tr_b16 a[4:5], v6 offset:18432
    ds_read_b64_tr_b16 a[6:7], v6 offset:18944
    v_mfma_f32_32x32x16_bf16 v[16:31], a[12:15], v[220:223], v[16:31]
    ds_read_b64_tr_b16 a[8:9], v6 offset:20480
    ds_read_b64_tr_b16 a[10:11], v6 offset:20992
    s_waitcnt lgkmcnt(10)
    v_mfma_f32_32x32x16_bf16 v[16:31], a[16:19], v[224:227], v[16:31]
    s_add_u32 m0, s28, 22528
    ds_read_b64_tr_b16 a[12:13], v6 offset:22528
    ds_read_b64_tr_b16 a[14:15], v6 offset:23040
    v_mfma_f32_32x32x16_bf16 v[16:31], a[20:23], v[228:231], v[16:31]
    buffer_load_dwordx4 v68, s[4:7], s24 offen offset:0 lds
    ds_read_b64_tr_b16 a[16:17], v7 offset:0
    ds_read_b64_tr_b16 a[18:19], v7 offset:512
    s_waitcnt lgkmcnt(10)
    v_mfma_f32_32x32x16_bf16 v[16:31], a[24:27], v[232:235], v[16:31]
    v_xor_b32 v6, 73728, v6
    ds_read_b64_tr_b16 a[20:21], v7 offset:2048
    ds_read_b64_tr_b16 a[22:23], v7 offset:2560
    v_mfma_f32_32x32x16_bf16 v[16:31], a[28:31], v[236:239], v[16:31]
    ds_read_b64_tr_b16 a[24:25], v7 offset:4096
    ds_read_b64_tr_b16 a[26:27], v7 offset:4608
    s_waitcnt lgkmcnt(10)
    v_mfma_f32_32x32x16_bf16 v[16:31], a[0:3], v[240:243], v[16:31]
    ds_read_b64_tr_b16 a[28:29], v7 offset:6144
    ds_read_b64_tr_b16 a[30:31], v7 offset:6656
    v_mfma_f32_32x32x16_bf16 v[16:31], a[4:7], v[244:247], v[16:31]
    buffer_load_dwordx4 v69, s[4:7], s24 offen offset:1024 lds
    s_waitcnt vmcnt(19)
    s_barrier
    ds_read_b64_tr_b16 a[0:1], v7 offset:8192
    ds_read_b64_tr_b16 a[2:3], v7 offset:8704
    s_waitcnt lgkmcnt(10)
    v_mfma_f32_32x32x16_bf16 v[16:31], a[8:11], v[248:251], v[16:31]
    s_add_u32 s24, s24, s26
    ds_read_b64_tr_b16 a[4:5], v7 offset:10240
    ds_read_b64_tr_b16 a[6:7], v7 offset:10752
    v_mfma_f32_32x32x16_bf16 v[16:31], a[12:15], v[252:255], v[16:31]
    ds_read_b64_tr_b16 a[8:9], v7 offset:12288
    ds_read_b64_tr_b16 a[10:11], v7 offset:12800
    s_waitcnt lgkmcnt(10)
    v_mfma_f32_32x32x16_bf16 v[32:47], a[16:19], v[208:211], v[32:47]
    s_add_u32 m0, s28, 43008
    ds_read_b64_tr_b16 a[12:13], v7 offset:14336
    ds_read_b64_tr_b16 a[14:15], v7 offset:14848
    v_mfma_f32_32x32x16_bf16 v[32:47], a[20:23], v[212:215], v[32:47]
    buffer_load_dwordx4 v64, s[4:7], s24 offen offset:0 lds
    ds_read_b64_tr_b16 a[16:17], v7 offset:16384
    ds_read_b64_tr_b16 a[18:19], v7 offset:16896
    s_waitcnt lgkmcnt(10)
    v_mfma_f32_32x32x16_bf16 v[32:47], a[24:27], v[216:219], v[32:47]
    v_mul_f32 v16, v16, v10
    v_mul_f32 v17, v17, v10
    v_mul_f32 v18, v18, v10
    v_mul_f32 v19, v19, v10
    ds_read_b64_tr_b16 a[20:21], v7 offset:18432
    ds_read_b64_tr_b16 a[22:23], v7 offset:18944
    v_mfma_f32_32x32x16_bf16 v[32:47], a[28:31], v[220:223], v[32:47]
    v_mul_f32 v20, v20, v10
    v_mul_f32 v21, v21, v10
    v_mul_f32 v22, v22, v10
    ds_read_b64_tr_b16 a[24:25], v7 offset:20480
    ds_read_b64_tr_b16 a[26:27], v7 offset:20992
    s_waitcnt lgkmcnt(10)
    v_mfma_f32_32x32x16_bf16 v[32:47], a[0:3], v[224:227], v[32:47]
    v_mul_f32 v23, v23, v10
    v_mul_f32 v24, v24, v10
    v_mul_f32 v25, v25, v10
    v_mul_f32 v26, v26, v10
    ds_read_b64_tr_b16 a[28:29], v7 offset:22528
    ds_read_b64_tr_b16 a[30:31], v7 offset:23040
    v_mfma_f32_32x32x16_bf16 v[32:47], a[4:7], v[228:231], v[32:47]
    buffer_load_dwordx4 v65, s[4:7], s24 offen offset:1024 lds
    ds_read_b64_tr_b16 a[0:1], v4 offset:0
    ds_read_b64_tr_b16 a[2:3], v4 offset:512
    s_waitcnt lgkmcnt(10)
    v_mfma_f32_32x32x16_bf16 v[32:47], a[8:11], v[232:235], v[32:47]
    v_xor_b32 v7, 73728, v7
    v_mul_f32 v27, v27, v10
    v_mul_f32 v28, v28, v10
    v_mul_f32 v29, v29, v10
    ds_read_b64_tr_b16 a[4:5], v4 offset:2048
    ds_read_b64_tr_b16 a[6:7], v4 offset:2560
    v_mfma_f32_32x32x16_bf16 v[32:47], a[12:15], v[236:239], v[32:47]
    v_mul_f32 v30, v30, v10
    v_mul_f32 v31, v31, v10
    ds_read_b64_tr_b16 a[8:9], v4 offset:4096
    ds_read_b64_tr_b16 a[10:11], v4 offset:4608
    s_waitcnt lgkmcnt(10)
    v_mfma_f32_32x32x16_bf16 v[32:47], a[16:19], v[240:243], v[32:47]
    ds_read_b64_tr_b16 a[12:13], v4 offset:6144
    ds_read_b64_tr_b16 a[14:15], v4 offset:6656
    v_mfma_f32_32x32x16_bf16 v[32:47], a[20:23], v[244:247], v[32:47]
    buffer_load_dwordx4 v66, s[4:7], s24 offen offset:2048 lds
    ds_read_b64_tr_b16 a[16:17], v4 offset:8192
    ds_read_b64_tr_b16 a[18:19], v4 offset:8704
    s_waitcnt lgkmcnt(10)
    v_mfma_f32_32x32x16_bf16 v[32:47], a[24:27], v[248:251], v[32:47]
    ds_read_b64_tr_b16 a[20:21], v4 offset:10240
    ds_read_b64_tr_b16 a[22:23], v4 offset:10752
    v_mfma_f32_32x32x16_bf16 v[32:47], a[28:31], v[252:255], v[32:47]
    s_set_gpr_idx_on s32, 0x8
    s_nop 0
    v_cvt_pk_bf16_f32 v80, v16, v17
    v_cvt_pk_bf16_f32 v81, v18, v19
    v_cvt_pk_bf16_f32 v82, v20, v21
    v_cvt_pk_bf16_f32 v83, v22, v23
    v_cvt_pk_bf16_f32 v84, v24, v25
    v_cvt_pk_bf16_f32 v85, v26, v27
    v_cvt_pk_bf16_f32 v86, v28, v29
    v_cvt_pk_bf16_f32 v87, v30, v31
    s_set_gpr_idx_off
    s_add_u32 m0, s28, 43008
    s_xor_b32 s28, s28, 73728
    s_xor_b32 s29, s29, 73728
    s_add_u32 s31, s31, 1
    s_cmp_lt_u32 s31, 7
    s_cbranch_scc1 Lp1_a3
Latt:
    s_mov_b32 s4, s68
Lpad14:
    s_cbranch_execz Lret
    s_and_b32 s5, s69, 0xffff
    s_mov_b32 s6, 663552
    s_mul_i32 s60, s20, 5120
    s_sub_u32 s57, s22, 12
    s_mul_i32 s57, s57, 165888
    s_lshl_b32 s54, s20, 5
    s_nop 7
    v_add_u32 v194, s54, v2
    v_mul_u32_u24 v192, 592, v194
    v_add_u32 v192, 83200, v192
    v_lshl_add_u32 v195, v3, 5, v192
    v_mul_u32_u24 v196, 336, v194
    v_add_u32 v196, 30720, v196
    v_lshl_add_u32 v197, v3, 5, v196
    v_mul_u32_u24 v193, 144, v3
    v_add_u32 v192, v192, v193
    v_add_u32 v196, v196, v193
    v_lshlrev_b32 v193, 1, v193
Lpad15:
    s_cbranch_execz Lret
    v_mul_f32 v32, v32, v10
    v_mul_f32 v33, v33, v10
    v_mul_f32 v34, v34, v10
    v_mul_f32 v35, v35, v10
    v_mul_f32 v36, v36, v10
    v_mul_f32 v37, v37, v10
    v_mul_f32 v38, v38, v10
    v_mul_f32 v39, v39, v10
    v_mul_f32 v40, v40, v10
    v_mul_f32 v41, v41, v10
    v_mul_f32 v42, v42, v10
    v_mul_f32 v43, v43, v10
    v_mul_f32 v44, v44, v10
    v_mul_f32 v45, v45, v10
    v_mul_f32 v46, v46, v10
    v_mul_f32 v47, v47, v10
    v_cvt_pk_bf16_f32 v184, v32, v33
    v_cvt_pk_bf16_f32 v185, v34, v35
    v_cvt_pk_bf16_f32 v186, v36, v37
    v_cvt_pk_bf16_f32 v187, v38, v39
    v_cvt_pk_bf16_f32 v188, v40, v41
    v_cvt_pk_bf16_f32 v189, v42, v43
    v_cvt_pk_bf16_f32 v190, v44, v45
Lpad16:
    s_cbranch_execz Lret
    v_cvt_pk_bf16_f32 v191, v46, v47
    s_waitcnt vmcnt(0) lgkmcnt(0)
    s_barrier
    s_lshl_b32 s55, s21, 4
    s_sub_u32 s55, s55, 4
    s_cselect_b32 s55, 1073741824, s55
    s_cmp_eq_u32 s20, 0
    s_cselect_b32 s55, s55, 1073741824
    buffer_load_dword a61, off, s[16:19], s55 sc0 sc1
    s_add_u32 m0, s60, 0
    s_add_u32 s55, s57, 0
    buffer_load_dwordx4 v9, s[4:7], s55 offen lds
    s_add_u32 m0, s60, 1024
    s_add_u32 s55, s57, 9216
    buffer_load_dwordx4 v9, s[4:7], s55 offen lds
    s_add_u32 m0, s60, 2048
    s_add_u32 s55, s57, 18432
    buffer_load_dwordx4 v9, s[4:7], s55 offen lds
Lpad17:
    s_cbranch_execz Lret
    s_add_u32 m0, s60, 3072
    s_add_u32 s55, s57, 27648
    buffer_load_dwordx4 v9, s[4:7], s55 offen lds
    s_add_u32 m0, s60, 4096
    s_add_u32 s55, s57, 36864
    buffer_load_dwordx4 v9, s[4:7], s55 offen lds
    ds_write_b128 v197, v[152:155] offset:0
    ds_write_b128 v197, v[156:159] offset:16
    ds_write_b128 v197, v[160:163] offset:64
    ds_write_b128 v197, v[164:167] offset:80
    ds_write_b128 v197, v[168:171] offset:128
    ds_write_b128 v197, v[172:175] offset:144
    ds_write_b128 v197, v[176:179] offset:192
    ds_write_b128 v197, v[180:183] offset:208
    ds_write_b128 v197, v[184:187] offset:256
Lpad18:
    s_cbranch_execz Lret
    ds_write_b128 v197, v[188:191] offset:272
    ds_write_b128 v195, v[80:83] offset:0
    ds_write_b128 v195, v[84:87] offset:16
    ds_write_b128 v195, v[88:91] offset:64
    ds_write_b128 v195, v[92:95] offset:80
    ds_write_b128 v195, v[96:99] offset:128
    ds_write_b128 v195, v[100:103] offset:144
    ds_write_b128 v195, v[104:107] offset:192
    ds_write_b128 v195, v[108:111] offset:208
    ds_write_b128 v195, v[112:115] offset:256
    ds_write_b128 v195, v[116:119] offset:272
    ds_write_b128 v195, v[120:123] offset:320
    ds_write_b128 v195, v[124:127] offset:336
    ds_write_b128 v195, v[128:131] offset:384
    ds_write_b128 v195, v[132:135] offset:400
Lpad19:
    s_cbranch_execz Lret
    ds_write_b128 v195, v[136:139] offset:448
    ds_write_b128 v195, v[140:143] offset:464
    ds_write_b128 v195, v[144:147] offset:512
    ds_write_b128 v195, v[148:151] offset:528
    ds_read_b128 v[16:19], v196 offset:0
    ds_read_b128 v[20:23], v196 offset:16
    ds_read_b128 v[24:27], v196 offset:32
    ds_read_b128 v[28:31], v196 offset:48
    ds_read_b128 v[32:35], v196 offset:64
    ds_read_b128 v[36:39], v196 offset:80
    ds_read_b128 v[40:43], v196 offset:96
    ds_read_b128 v[44:47], v196 offset:112
    ds_read_b128 v[48:51], v196 offset:128
    s_waitcnt lgkmcnt(9)
    v_mov_b32 v96, v192
    v_mov_b32 v97, v193
Lpad20:
    s_cbranch_execz Lret
    s_cmp_eq_u32 s20, 0
    s_cbranch_scc0 Lhalo_done
    v_and_b32 v98, 15, v2
    v_lshrrev_b32 v99, 4, v2
    v_mul_u32_u24 v99, 144, v99
    v_add_u32 v99, v99, v97
    v_mul_u32_u24 v100, 576, v98
    v_add_u32 v100, v100, v99
    v_mul_u32_u24 v101, 592, v98
    v_add_u32 v101, v101, v99
    v_add_u32 v101, 73728, v101
    v_mov_b32 v112, 0
    v_mov_b32 v113, 0
    v_mov_b32 v114, 0
    v_mov_b32 v115, 0
    v_mov_b32 v116, 0
    v_mov_b32 v117, 0
    v_mov_b32 v118, 0
    v_mov_b32 v119, 0
    v_mov_b32 v120, 0
    v_mov_b32 v121, 0
    v_mov_b32 v122, 0
    v_mov_b32 v123, 0
    v_mov_b32 v124, 0
    v_mov_b32 v125, 0
Lpad21:
    s_cbranch_execz Lret
    v_mov_b32 v126, 0
    v_mov_b32 v127, 0
    v_mov_b32 v128, 0
    v_mov_b32 v129, 0
    v_mov_b32 v130, 0
    v_mov_b32 v131, 0
    v_mov_b32 v132, 0
    v_mov_b32 v133, 0
    v_mov_b32 v134, 0
    v_mov_b32 v135, 0
    v_mov_b32 v136, 0
    v_mov_b32 v137, 0
    v_mov_b32 v138, 0
    v_mov_b32 v139, 0
    v_mov_b32 v140, 0
    v_mov_b32 v141, 0
    v_mov_b32 v142, 0
    v_mov_b32 v143, 0
    v_mov_b32 v144, 0
    v_mov_b32 v145, 0
    v_mov_b32 v146, 0
    v_mov_b32 v147, 0
    s_cmp_eq_u32 s21, 0
    s_cbranch_scc1 Lhalo_wr
    s_lshl_b32 s54, s21, 2
    s_add_u32 s54, s54, s22
    s_sub_u32 s54, s54, 16
    s_lshl_b32 s55, s21, 4
    s_sub_u32 s55, s55, 4
Lpad22:
    s_cbranch_execz Lret
    s_lshl_b32 s62, s22, 3
    s_lshl_b32 s62, 1, s62
    s_mov_b32 s61, 0x4000
    s_waitcnt vmcnt(5)
    v_accvgpr_read_b32 v103, a61
    s_nop 1
    s_branch Lpchk_h
Lpoll_h:
    buffer_load_dword v103, off, s[16:19], s55 sc0 sc1
    s_waitcnt vmcnt(0)
Lpchk_h:
    v_readfirstlane_b32 s56, v103
    s_nop 3
    s_and_b32 s56, s56, s62
    s_cmp_eq_u32 s56, s62
    s_cbranch_scc1 Lpollok_h
    s_sleep 2
    s_sub_u32 s61, s61, 1
    s_cbranch_scc0 Lpoll_h
Lpollok_h:
    s_mul_i32 s54, s54, 9216
    s_add_u32 s54, s54, 37748736
    buffer_load_dwordx4 v[112:115], v100, s[12:15], s54 offen offset:0 sc0 sc1
    buffer_load_dwordx4 v[116:119], v100, s[12:15], s54 offen offset:16 sc0 sc1
    buffer_load_dwordx4 v[120:123], v100, s[12:15], s54 offen offset:32 sc0 sc1
Lpad23:
    s_cbranch_execz Lret
    buffer_load_dwordx4 v[124:127], v100, s[12:15], s54 offen offset:48 sc0 sc1
    buffer_load_dwordx4 v[128:131], v100, s[12:15], s54 offen offset:64 sc0 sc1
    buffer_load_dwordx4 v[132:135], v100, s[12:15], s54 offen offset:80 sc0 sc1
    buffer_load_dwordx4 v[136:139], v100, s[12:15], s54 offen offset:96 sc0 sc1
    buffer_load_dwordx4 v[140:143], v100, s[12:15], s54 offen offset:112 sc0 sc1
    buffer_load_dwordx4 v[144:147], v100, s[12:15], s54 offen offset:128 sc0 sc1
    s_waitcnt vmcnt(0)
Lhalo_wr:
    ds_write_b128 v101, v[112:115] offset:0
    ds_write_b128 v101, v[116:119] offset:16
    ds_write_b128 v101, v[120:123] offset:32
    ds_write_b128 v101, v[124:127] offset:48
    ds_write_b128 v101, v[128:131] offset:64
    ds_write_b128 v101, v[132:135] offset:80
    ds_write_b128 v101, v[136:139] offset:96
    ds_write_b128 v101, v[140:143] offset:112
Lpad24:
    s_cbranch_execz Lret
    ds_write_b128 v101, v[144:147] offset:128
Lhalo_done:
    s_waitcnt lgkmcnt(0)
    s_barrier
    s_add_u32 m0, s60, 24576
    s_add_u32 s55, s57, 128
    buffer_load_dwordx4 v9, s[4:7], s55 offen lds
    s_add_u32 m0, s60, 25600
    s_add_u32 s55, s57, 9344
    buffer_load_dwordx4 v9, s[4:7], s55 offen lds
    s_add_u32 m0, s60, 26624
    s_add_u32 s55, s57, 18560
    buffer_load_dwordx4 v9, s[4:7], s55 offen lds
    s_add_u32 m0, s60, 27648
    s_add_u32 s55, s57, 27776
    buffer_load_dwordx4 v9, s[4:7], s55 offen lds
    s_add_u32 m0, s60, 28672
Lpad25:
    s_cbranch_execz Lret
    s_add_u32 s55, s57, 36992
    buffer_load_dwordx4 v9, s[4:7], s55 offen lds
    s_add_u32 m0, s60, 49152
    s_add_u32 s55, s57, 256
    buffer_load_dwordx4 v9, s[4:7], s55 offen lds
    s_add_u32 m0, s60, 50176
    s_add_u32 s55, s57, 9472
    buffer_load_dwordx4 v9, s[4:7], s55 offen lds
    s_add_u32 m0, s60, 51200
    s_add_u32 s55, s57, 18688
    buffer_load_dwordx4 v9, s[4:7], s55 offen lds
    s_add_u32 m0, s60, 52224
    s_add_u32 s55, s57, 27904
    buffer_load_dwordx4 v9, s[4:7], s55 offen lds
    s_add_u32 m0, s60, 53248
Lpad26:
    s_cbranch_execz Lret
    s_add_u32 s55, s57, 37120
    buffer_load_dwordx4 v9, s[4:7], s55 offen lds
    v_min_u32 v98, 35, v1
    s_mul_i32 s54, s20, 36
    v_add_u32 v98, s54, v98
    v_mul_u32_u24 v98, 1152, v98
    buffer_load_dword a63, v98, s[4:7], s57 offen offset:384
    buffer_load_dword a63, v98, s[4:7], s57 offen offset:512
    buffer_load_dword a63, v98, s[4:7], s57 offen offset:640
    buffer_load_dword a63, v98, s[4:7], s57 offen offset:768
    buffer_load_dword a63, v98, s[4:7], s57 offen offset:896
    buffer_load_dword a63, v98, s[4:7], s57 offen offset:1024
    s_cmp_eq_u32 s20, 0
    s_cbranch_scc0 Lnordl
    s_lshl_b32 s62, s21, 4
    buffer_load_dword a60, off, s[16:19], s62 sc0 sc1
Lnordl:
    v_subrev_u32 v96, 8288, v96
    v_mov_b32 v52, 0
Lpad27:
    s_cbranch_execz Lret
    v_mov_b32 v53, 0
    v_mov_b32 v54, 0
    v_mov_b32 v55, 0
    v_mov_b32 v56, 0
    v_mov_b32 v57, 0
    v_mov_b32 v58, 0
    v_mov_b32 v59, 0
    v_mov_b32 v60, 0
    v_mov_b32 v61, 0
    v_mov_b32 v62, 0
    v_mov_b32 v63, 0
    v_mov_b32 v64, 0
    v_mov_b32 v65, 0
    v_mov_b32 v66, 0
    v_mov_b32 v67, 0
    v_mov_b32 v68, 0
    v_mov_b32 v69, 0
    v_mov_b32 v70, 0
    v_mov_b32 v71, 0
    v_mov_b32 v72, 0
    v_mov_b32 v73, 0
    v_mov_b32 v74, 0
    v_mov_b32 v75, 0
    v_mov_b32 v76, 0
    v_mov_b32 v77, 0
    v_mov_b32 v78, 0
    v_mov_b32 v79, 0
    v_mov_b32 v80, 0
    v_mov_b32 v81, 0
Lpad28:
    s_cbranch_execz Lret
    v_mov_b32 v82, 0
    v_mov_b32 v83, 0
    ds_read_b128 v[112:115], v96 offset:8288
    ds_read_b128 v[116:119], v96 offset:8304
    ds_read_b128 v[120:123], v96 offset:8320
    ds_read_b128 v[124:127], v96 offset:8336
    ds_read_b128 v[128:131], v96 offset:8352
    ds_read_b128 v[132:135], v96 offset:8368
    ds_read_b128 v[136:139], v96 offset:8384
    ds_read_b128 v[140:143], v96 offset:8400
    ds_read_b128 v[144:147], v96 offset:8416
    ds_read_b128 v[148:151], v96 offset:7104
    ds_read_b128 v[152:155], v96 offset:7120
    ds_read_b128 v[156:159], v96 offset:7136
    ds_read_b128 v[160:163], v96 offset:7152
    ds_read_b128 v[164:167], v96 offset:7168
Lpad29:
    s_cbranch_execz Lret
    ds_read_b128 v[168:171], v96 offset:7184
    ds_read_b128 v[172:175], v96 offset:7200
    ds_read_b128 v[176:179], v96 offset:7216
    ds_read_b128 v[180:183], v96 offset:7232
    s_waitcnt lgkmcnt(9)
    v_dot2c_f32_bf16 v52, v16, v112
    v_dot2c_f32_bf16 v60, v25, v121
    v_dot2c_f32_bf16 v68, v34, v130
    v_dot2c_f32_bf16 v76, v43, v139
    v_dot2c_f32_bf16 v52, v17, v113
    v_dot2c_f32_bf16 v60, v26, v122
    v_dot2c_f32_bf16 v68, v35, v131
    v_dot2c_f32_bf16 v76, v44, v140
    v_dot2c_f32_bf16 v52, v18, v114
    v_dot2c_f32_bf16 v60, v27, v123
    v_dot2c_f32_bf16 v68, v36, v132
    v_dot2c_f32_bf16 v76, v45, v141
    v_dot2c_f32_bf16 v52, v19, v115
    v_dot2c_f32_bf16 v60, v28, v124
    v_dot2c_f32_bf16 v68, v37, v133
    v_dot2c_f32_bf16 v76, v46, v142
    v_dot2c_f32_bf16 v52, v20, v116
    v_dot2c_f32_bf16 v60, v29, v125
    v_dot2c_f32_bf16 v68, v38, v134
    v_dot2c_f32_bf16 v76, v47, v143
Lpad30:
    s_cbranch_execz Lret
    v_dot2c_f32_bf16 v52, v21, v117
    v_dot2c_f32_bf16 v60, v30, v126
    v_dot2c_f32_bf16 v68, v39, v135
    v_dot2c_f32_bf16 v76, v48, v144
    v_dot2c_f32_bf16 v52, v22, v118
    v_dot2c_f32_bf16 v60, v31, v127
    v_dot2c_f32_bf16 v68, v40, v136
    v_dot2c_f32_bf16 v76, v49, v145
    v_dot2c_f32_bf16 v52, v23, v119
    v_dot2c_f32_bf16 v60, v32, v128
    v_dot2c_f32_bf16 v68, v41, v137
    v_dot2c_f32_bf16 v76, v50, v146
    v_dot2c_f32_bf16 v52, v24, v120
    v_dot2c_f32_bf16 v60, v33, v129
    v_dot2c_f32_bf16 v68, v42, v138
    v_dot2c_f32_bf16 v76, v51, v147
    ds_read_b128 v[112:115], v96 offset:5920
    ds_read_b128 v[116:119], v96 offset:5936
    ds_read_b128 v[120:123], v96 offset:5952
    ds_read_b128 v[124:127], v96 offset:5968
    ds_read_b128 v[128:131], v96 offset:5984
    ds_read_b128 v[132:135], v96 offset:6000
    ds_read_b128 v[136:139], v96 offset:6016
Lpad31:
    s_cbranch_execz Lret
    ds_read_b128 v[140:143], v96 offset:6032
    ds_read_b128 v[144:147], v96 offset:6048
    s_waitcnt lgkmcnt(9)
    v_dot2c_f32_bf16 v53, v16, v148
    v_dot2c_f32_bf16 v61, v25, v157
    v_dot2c_f32_bf16 v69, v34, v166
    v_dot2c_f32_bf16 v77, v43, v175
    v_dot2c_f32_bf16 v53, v17, v149
    v_dot2c_f32_bf16 v61, v26, v158
    v_dot2c_f32_bf16 v69, v35, v167
    v_dot2c_f32_bf16 v77, v44, v176
    v_dot2c_f32_bf16 v53, v18, v150
    v_dot2c_f32_bf16 v61, v27, v159
    v_dot2c_f32_bf16 v69, v36, v168
    v_dot2c_f32_bf16 v77, v45, v177
    v_dot2c_f32_bf16 v53, v19, v151
    v_dot2c_f32_bf16 v61, v28, v160
    v_dot2c_f32_bf16 v69, v37, v169
    v_dot2c_f32_bf16 v77, v46, v178
    v_dot2c_f32_bf16 v53, v20, v152
    v_dot2c_f32_bf16 v61, v29, v161
    v_dot2c_f32_bf16 v69, v38, v170
    v_dot2c_f32_bf16 v77, v47, v179
    v_dot2c_f32_bf16 v53, v21, v153
    v_dot2c_f32_bf16 v61, v30, v162
    v_dot2c_f32_bf16 v69, v39, v171
    v_dot2c_f32_bf16 v77, v48, v180
Lpad32:
    s_cbranch_execz Lret
    v_dot2c_f32_bf16 v53, v22, v154
    v_dot2c_f32_bf16 v61, v31, v163
    v_dot2c_f32_bf16 v69, v40, v172
    v_dot2c_f32_bf16 v77, v49, v181
    v_dot2c_f32_bf16 v53, v23, v155
    v_dot2c_f32_bf16 v61, v32, v164
    v_dot2c_f32_bf16 v69, v41, v173
    v_dot2c_f32_bf16 v77, v50, v182
    v_dot2c_f32_bf16 v53, v24, v156
    v_dot2c_f32_bf16 v61, v33, v165
    v_dot2c_f32_bf16 v69, v42, v174
    v_dot2c_f32_bf16 v77, v51, v183
    ds_read_b128 v[148:151], v96 offset:4736
    ds_read_b128 v[152:155], v96 offset:4752
    ds_read_b128 v[156:159], v96 offset:4768
    ds_read_b128 v[160:163], v96 offset:4784
    ds_read_b128 v[164:167], v96 offset:4800
    ds_read_b128 v[168:171], v96 offset:4816
    ds_read_b128 v[172:175], v96 offset:4832
    ds_read_b128 v[176:179], v96 offset:4848
    ds_read_b128 v[180:183], v96 offset:4864
Lpad33:
    s_cbranch_execz Lret
    s_waitcnt lgkmcnt(9)
    v_dot2c_f32_bf16 v54, v16, v112
    v_dot2c_f32_bf16 v62, v25, v121
    v_dot2c_f32_bf16 v70, v34, v130
    v_dot2c_f32_bf16 v78, v43, v139
    v_dot2c_f32_bf16 v54, v17, v113
    v_dot2c_f32_bf16 v62, v26, v122
    v_dot2c_f32_bf16 v70, v35, v131
    v_dot2c_f32_bf16 v78, v44, v140
    v_dot2c_f32_bf16 v54, v18, v114
    v_dot2c_f32_bf16 v62, v27, v123
    v_dot2c_f32_bf16 v70, v36, v132
    v_dot2c_f32_bf16 v78, v45, v141
    v_dot2c_f32_bf16 v54, v19, v115
    v_dot2c_f32_bf16 v62, v28, v124
    v_dot2c_f32_bf16 v70, v37, v133
    v_dot2c_f32_bf16 v78, v46, v142
    v_dot2c_f32_bf16 v54, v20, v116
    v_dot2c_f32_bf16 v62, v29, v125
    v_dot2c_f32_bf16 v70, v38, v134
    v_dot2c_f32_bf16 v78, v47, v143
    v_dot2c_f32_bf16 v54, v21, v117
    v_dot2c_f32_bf16 v62, v30, v126
    v_dot2c_f32_bf16 v70, v39, v135
    v_dot2c_f32_bf16 v78, v48, v144
    v_dot2c_f32_bf16 v54, v22, v118
    v_dot2c_f32_bf16 v62, v31, v127
    v_dot2c_f32_bf16 v70, v40, v136
    v_dot2c_f32_bf16 v78, v49, v145
Lpad34:
    s_cbranch_execz Lret
    v_dot2c_f32_bf16 v54, v23, v119
    v_dot2c_f32_bf16 v62, v32, v128
    v_dot2c_f32_bf16 v70, v41, v137
    v_dot2c_f32_bf16 v78, v50, v146
    v_dot2c_f32_bf16 v54, v24, v120
    v_dot2c_f32_bf16 v62, v33, v129
    v_dot2c_f32_bf16 v70, v42, v138
    v_dot2c_f32_bf16 v78, v51, v147
    ds_read_b128 v[112:115], v96 offset:3552
    ds_read_b128 v[116:119], v96 offset:3568
    ds_read_b128 v[120:123], v96 offset:3584
    ds_read_b128 v[124:127], v96 offset:3600
    ds_read_b128 v[128:131], v96 offset:3616
    ds_read_b128 v[132:135], v96 offset:3632
    ds_read_b128 v[136:139], v96 offset:3648
    ds_read_b128 v[140:143], v96 offset:3664
    ds_read_b128 v[144:147], v96 offset:3680
    s_waitcnt lgkmcnt(9)
    v_dot2c_f32_bf16 v55, v16, v148
    v_dot2c_f32_bf16 v63, v25, v157
Lpad35:
    s_cbranch_execz Lret
    v_dot2c_f32_bf16 v71, v34, v166
    v_dot2c_f32_bf16 v79, v43, v175
    v_dot2c_f32_bf16 v55, v17, v149
    v_dot2c_f32_bf16 v63, v26, v158
    v_dot2c_f32_bf16 v71, v35, v167
    v_dot2c_f32_bf16 v79, v44, v176
    v_dot2c_f32_bf16 v55, v18, v150
    v_dot2c_f32_bf16 v63, v27, v159
    v_dot2c_f32_bf16 v71, v36, v168
    v_dot2c_f32_bf16 v79, v45, v177
    v_dot2c_f32_bf16 v55, v19, v151
    v_dot2c_f32_bf16 v63, v28, v160
    v_dot2c_f32_bf16 v71, v37, v169
    v_dot2c_f32_bf16 v79, v46, v178
    v_dot2c_f32_bf16 v55, v20, v152
    v_dot2c_f32_bf16 v63, v29, v161
    v_dot2c_f32_bf16 v71, v38, v170
    v_dot2c_f32_bf16 v79, v47, v179
    v_dot2c_f32_bf16 v55, v21, v153
    v_dot2c_f32_bf16 v63, v30, v162
    v_dot2c_f32_bf16 v71, v39, v171
    v_dot2c_f32_bf16 v79, v48, v180
    v_dot2c_f32_bf16 v55, v22, v154
    v_dot2c_f32_bf16 v63, v31, v163
    v_dot2c_f32_bf16 v71, v40, v172
    v_dot2c_f32_bf16 v79, v49, v181
    v_dot2c_f32_bf16 v55, v23, v155
    v_dot2c_f32_bf16 v63, v32, v164
    v_dot2c_f32_bf16 v71, v41, v173
Lpad36:
    s_cbranch_execz Lret
    v_dot2c_f32_bf16 v79, v50, v182
    v_dot2c_f32_bf16 v55, v24, v156
    v_dot2c_f32_bf16 v63, v33, v165
    v_dot2c_f32_bf16 v71, v42, v174
    v_dot2c_f32_bf16 v79, v51, v183
    ds_read_b128 v[148:151], v96 offset:2368
    ds_read_b128 v[152:155], v96 offset:2384
    ds_read_b128 v[156:159], v96 offset:2400
    ds_read_b128 v[160:163], v96 offset:2416
    ds_read_b128 v[164:167], v96 offset:2432
    ds_read_b128 v[168:171], v96 offset:2448
    ds_read_b128 v[172:175], v96 offset:2464
    ds_read_b128 v[176:179], v96 offset:2480
    ds_read_b128 v[180:183], v96 offset:2496
    s_waitcnt lgkmcnt(9)
    v_dot2c_f32_bf16 v56, v16, v112
    v_dot2c_f32_bf16 v64, v25, v121
    v_dot2c_f32_bf16 v72, v34, v130
    v_dot2c_f32_bf16 v80, v43, v139
    v_dot2c_f32_bf16 v56, v17, v113
Lpad37:
    s_cbranch_execz Lret
    v_dot2c_f32_bf16 v64, v26, v122
    v_dot2c_f32_bf16 v72, v35, v131
    v_dot2c_f32_bf16 v80, v44, v140
    v_dot2c_f32_bf16 v56, v18, v114
    v_dot2c_f32_bf16 v64, v27, v123
    v_dot2c_f32_bf16 v72, v36, v132
    v_dot2c_f32_bf16 v80, v45, v141
    v_dot2c_f32_bf16 v56, v19, v115
    v_dot2c_f32_bf16 v64, v28, v124
    v_dot2c_f32_bf16 v72, v37, v133
    v_dot2c_f32_bf16 v80, v46, v142
    v_dot2c_f32_bf16 v56, v20, v116
    v_dot2c_f32_bf16 v64, v29, v125
    v_dot2c_f32_bf16 v72, v38, v134
    v_dot2c_f32_bf16 v80, v47, v143
    v_dot2c_f32_bf16 v56, v21, v117
    v_dot2c_f32_bf16 v64, v30, v126
    v_dot2c_f32_bf16 v72, v39, v135
    v_dot2c_f32_bf16 v80, v48, v144
    v_dot2c_f32_bf16 v56, v22, v118
    v_dot2c_f32_bf16 v64, v31, v127
    v_dot2c_f32_bf16 v72, v40, v136
    v_dot2c_f32_bf16 v80, v49, v145
    v_dot2c_f32_bf16 v56, v23, v119
    v_dot2c_f32_bf16 v64, v32, v128
    v_dot2c_f32_bf16 v72, v41, v137
    v_dot2c_f32_bf16 v80, v50, v146
    v_dot2c_f32_bf16 v56, v24, v120
    v_dot2c_f32_bf16 v64, v33, v129
Lpad38:
    s_cbranch_execz Lret
    v_dot2c_f32_bf16 v72, v42, v138
    v_dot2c_f32_bf16 v80, v51, v147
    ds_read_b128 v[112:115], v96 offset:1184
    ds_read_b128 v[116:119], v96 offset:1200
    ds_read_b128 v[120:123], v96 offset:1216
    ds_read_b128 v[124:127], v96 offset:1232
    ds_read_b128 v[128:131], v96 offset:1248
    ds_read_b128 v[132:135], v96 offset:1264
    ds_read_b128 v[136:139], v96 offset:1280
    ds_read_b128 v[140:143], v96 offset:1296
    ds_read_b128 v[144:147], v96 offset:1312
    s_waitcnt lgkmcnt(9)
    v_dot2c_f32_bf16 v57, v16, v148
    v_dot2c_f32_bf16 v65, v25, v157
    v_dot2c_f32_bf16 v73, v34, v166
    v_dot2c_f32_bf16 v81, v43, v175
    v_dot2c_f32_bf16 v57, v17, v149
    v_dot2c_f32_bf16 v65, v26, v158
    v_dot2c_f32_bf16 v73, v35, v167
    v_dot2c_f32_bf16 v81, v44, v176
Lpad39:
    s_cbranch_execz Lret
    v_dot2c_f32_bf16 v57, v18, v150
    v_dot2c_f32_bf16 v65, v27, v159
    v_dot2c_f32_bf16 v73, v36, v168
    v_dot2c_f32_bf16 v81, v45, v177
    v_dot2c_f32_bf16 v57, v19, v151
    v_dot2c_f32_bf16 v65, v28, v160
    v_dot2c_f32_bf16 v73, v37, v169
    v_dot2c_f32_bf16 v81, v46, v178
    v_dot2c_f32_bf16 v57, v20, v152
    v_dot2c_f32_bf16 v65, v29, v161
    v_dot2c_f32_bf16 v73, v38, v170
    v_dot2c_f32_bf16 v81, v47, v179
    v_dot2c_f32_bf16 v57, v21, v153
    v_dot2c_f32_bf16 v65, v30, v162
    v_dot2c_f32_bf16 v73, v39, v171
    v_dot2c_f32_bf16 v81, v48, v180
    v_dot2c_f32_bf16 v57, v22, v154
    v_dot2c_f32_bf16 v65, v31, v163
    v_dot2c_f32_bf16 v73, v40, v172
    v_dot2c_f32_bf16 v81, v49, v181
    v_dot2c_f32_bf16 v57, v23, v155
    v_dot2c_f32_bf16 v65, v32, v164
    v_dot2c_f32_bf16 v73, v41, v173
    v_dot2c_f32_bf16 v81, v50, v182
    v_dot2c_f32_bf16 v57, v24, v156
    v_dot2c_f32_bf16 v65, v33, v165
    v_dot2c_f32_bf16 v73, v42, v174
    v_dot2c_f32_bf16 v81, v51, v183
    ds_read_b128 v[148:151], v96 offset:0
Lpad40:
    s_cbranch_execz Lret
    ds_read_b128 v[152:155], v96 offset:16
    ds_read_b128 v[156:159], v96 offset:32
    ds_read_b128 v[160:163], v96 offset:48
    ds_read_b128 v[164:167], v96 offset:64
    ds_read_b128 v[168:171], v96 offset:80
    ds_read_b128 v[172:175], v96 offset:96
    ds_read_b128 v[176:179], v96 offset:112
    ds_read_b128 v[180:183], v96 offset:128
    s_waitcnt lgkmcnt(9)
    v_dot2c_f32_bf16 v58, v16, v112
    v_dot2c_f32_bf16 v66, v25, v121
    v_dot2c_f32_bf16 v74, v34, v130
    v_dot2c_f32_bf16 v82, v43, v139
    v_dot2c_f32_bf16 v58, v17, v113
    v_dot2c_f32_bf16 v66, v26, v122
    v_dot2c_f32_bf16 v74, v35, v131
    v_dot2c_f32_bf16 v82, v44, v140
    v_dot2c_f32_bf16 v58, v18, v114
    v_dot2c_f32_bf16 v66, v27, v123
    v_dot2c_f32_bf16 v74, v36, v132
    v_dot2c_f32_bf16 v82, v45, v141
Lpad41:
    s_cbranch_execz Lret
    v_dot2c_f32_bf16 v58, v19, v115
    v_dot2c_f32_bf16 v66, v28, v124
    v_dot2c_f32_bf16 v74, v37, v133
    v_dot2c_f32_bf16 v82, v46, v142
    v_dot2c_f32_bf16 v58, v20, v116
    v_dot2c_f32_bf16 v66, v29, v125
    v_dot2c_f32_bf16 v74, v38, v134
    v_dot2c_f32_bf16 v82, v47, v143
    v_dot2c_f32_bf16 v58, v21, v117
    v_dot2c_f32_bf16 v66, v30, v126
    v_dot2c_f32_bf16 v74, v39, v135
    v_dot2c_f32_bf16 v82, v48, v144
    v_dot2c_f32_bf16 v58, v22, v118
    v_dot2c_f32_bf16 v66, v31, v127
    v_dot2c_f32_bf16 v74, v40, v136
    v_dot2c_f32_bf16 v82, v49, v145
    v_dot2c_f32_bf16 v58, v23, v119
    v_dot2c_f32_bf16 v66, v32, v128
    v_dot2c_f32_bf16 v74, v41, v137
    v_dot2c_f32_bf16 v82, v50, v146
    v_dot2c_f32_bf16 v58, v24, v120
    v_dot2c_f32_bf16 v66, v33, v129
    v_dot2c_f32_bf16 v74, v42, v138
    v_dot2c_f32_bf16 v82, v51, v147
    ds_read_b128 v[112:115], v96 offset:8576
    ds_read_b128 v[116:119], v96 offset:8592
    ds_read_b128 v[120:123], v96 offset:8608
Lpad42:
    s_cbranch_execz Lret
    ds_read_b128 v[124:127], v96 offset:8624
    ds_read_b128 v[128:131], v96 offset:8640
    ds_read_b128 v[132:135], v96 offset:8656
    ds_read_b128 v[136:139], v96 offset:8672
    ds_read_b128 v[140:143], v96 offset:8688
    ds_read_b128 v[144:147], v96 offset:8704
    s_waitcnt lgkmcnt(9)
    v_dot2c_f32_bf16 v59, v16, v148
    v_dot2c_f32_bf16 v67, v25, v157
    v_dot2c_f32_bf16 v75, v34, v166
    v_dot2c_f32_bf16 v83, v43, v175
    v_dot2c_f32_bf16 v59, v17, v149
    v_dot2c_f32_bf16 v67, v26, v158
    v_dot2c_f32_bf16 v75, v35, v167
    v_dot2c_f32_bf16 v83, v44, v176
    v_dot2c_f32_bf16 v59, v18, v150
    v_dot2c_f32_bf16 v67, v27, v159
    v_dot2c_f32_bf16 v75, v36, v168
    v_dot2c_f32_bf16 v83, v45, v177
    v_dot2c_f32_bf16 v59, v19, v151
    v_dot2c_f32_bf16 v67, v28, v160
    v_dot2c_f32_bf16 v75, v37, v169
    v_dot2c_f32_bf16 v83, v46, v178
Lpad43:
    s_cbranch_execz Lret
    v_dot2c_f32_bf16 v59, v20, v152
    v_dot2c_f32_bf16 v67, v29, v161
    v_dot2c_f32_bf16 v75, v38, v170
    v_dot2c_f32_bf16 v83, v47, v179
    v_dot2c_f32_bf16 v59, v21, v153
    v_dot2c_f32_bf16 v67, v30, v162
    v_dot2c_f32_bf16 v75, v39, v171
    v_dot2c_f32_bf16 v83, v48, v180
    v_dot2c_f32_bf16 v59, v22, v154
    v_dot2c_f32_bf16 v67, v31, v163
    v_dot2c_f32_bf16 v75, v40, v172
    v_dot2c_f32_bf16 v83, v49, v181
    v_dot2c_f32_bf16 v59, v23, v155
    v_dot2c_f32_bf16 v67, v32, v164
    v_dot2c_f32_bf16 v75, v41, v173
    v_dot2c_f32_bf16 v83, v50, v182
    v_dot2c_f32_bf16 v59, v24, v156
    v_dot2c_f32_bf16 v67, v33, v165
    v_dot2c_f32_bf16 v75, v42, v174
    v_dot2c_f32_bf16 v83, v51, v183
    s_lshl_b32 s54, s21, 7
    s_lshl_b32 s55, s20, 5
    s_add_u32 s54, s54, s55
    v_add_u32 v98, s54, v2
    v_mov_b32 v99, 0xce6e6b28
    v_cvt_pk_bf16_f32 v100, v52, v52
    v_lshlrev_b32 v52, 16, v100
Lpad44:
    s_cbranch_execz Lret
    v_cvt_pk_bf16_f32 v101, v53, v53
    v_lshlrev_b32 v53, 16, v101
    v_cvt_pk_bf16_f32 v102, v54, v54
    v_lshlrev_b32 v54, 16, v102
    v_cvt_pk_bf16_f32 v103, v55, v55
    v_lshlrev_b32 v55, 16, v103
    v_cvt_pk_bf16_f32 v100, v56, v56
    v_lshlrev_b32 v56, 16, v100
    v_cvt_pk_bf16_f32 v101, v57, v57
    v_lshlrev_b32 v57, 16, v101
    v_cvt_pk_bf16_f32 v102, v58, v58
    v_lshlrev_b32 v58, 16, v102
    v_cvt_pk_bf16_f32 v103, v59, v59
    v_lshlrev_b32 v59, 16, v103
    v_cvt_pk_bf16_f32 v100, v60, v60
    v_lshlrev_b32 v60, 16, v100
    v_cvt_pk_bf16_f32 v101, v61, v61
    v_lshlrev_b32 v61, 16, v101
    v_cvt_pk_bf16_f32 v102, v62, v62
Lpad45:
    s_cbranch_execz Lret
    v_lshlrev_b32 v62, 16, v102
    v_cvt_pk_bf16_f32 v103, v63, v63
    v_lshlrev_b32 v63, 16, v103
    v_cvt_pk_bf16_f32 v100, v64, v64
    v_lshlrev_b32 v64, 16, v100
    v_cvt_pk_bf16_f32 v101, v65, v65
    v_lshlrev_b32 v65, 16, v101
    v_cvt_pk_bf16_f32 v102, v66, v66
    v_lshlrev_b32 v66, 16, v102
    v_cvt_pk_bf16_f32 v103, v67, v67
    v_lshlrev_b32 v67, 16, v103
    v_cvt_pk_bf16_f32 v100, v68, v68
    v_lshlrev_b32 v68, 16, v100
    v_cvt_pk_bf16_f32 v101, v69, v69
    v_lshlrev_b32 v69, 16, v101
    v_cvt_pk_bf16_f32 v102, v70, v70
    v_lshlrev_b32 v70, 16, v102
    v_cvt_pk_bf16_f32 v103, v71, v71
    v_lshlrev_b32 v71, 16, v103
    v_cvt_pk_bf16_f32 v100, v72, v72
Lpad46:
    s_cbranch_execz Lret
    v_lshlrev_b32 v72, 16, v100
    v_cvt_pk_bf16_f32 v101, v73, v73
    v_lshlrev_b32 v73, 16, v101
    v_cvt_pk_bf16_f32 v102, v74, v74
    v_lshlrev_b32 v74, 16, v102
    v_cvt_pk_bf16_f32 v103, v75, v75
    v_lshlrev_b32 v75, 16, v103
    v_cvt_pk_bf16_f32 v100, v76, v76
    v_lshlrev_b32 v76, 16, v100
    v_cvt_pk_bf16_f32 v101, v77, v77
    v_lshlrev_b32 v77, 16, v101
    v_cvt_pk_bf16_f32 v102, v78, v78
    v_lshlrev_b32 v78, 16, v102
    v_cvt_pk_bf16_f32 v103, v79, v79
    v_lshlrev_b32 v79, 16, v103
    v_cvt_pk_bf16_f32 v100, v80, v80
    v_lshlrev_b32 v80, 16, v100
    v_cvt_pk_bf16_f32 v101, v81, v81
    v_lshlrev_b32 v81, 16, v101
    v_cvt_pk_bf16_f32 v102, v82, v82
Lpad47:
    s_cbranch_execz Lret
    v_lshlrev_b32 v82, 16, v102
    v_cvt_pk_bf16_f32 v103, v83, v83
    v_lshlrev_b32 v83, 16, v103
    v_mul_f32 v52, 2.357022604e-01, v52
    v_mul_f32 v53, 2.357022604e-01, v53
    v_mul_f32 v54, 2.357022604e-01, v54
    v_mul_f32 v55, 2.357022604e-01, v55
    v_mul_f32 v56, 2.357022604e-01, v56
    v_mul_f32 v57, 2.357022604e-01, v57
    v_mul_f32 v58, 2.357022604e-01, v58
    v_mul_f32 v59, 2.357022604e-01, v59
    v_mul_f32 v60, 2.357022604e-01, v60
    v_mul_f32 v61, 2.357022604e-01, v61
    v_mul_f32 v62, 2.357022604e-01, v62
    v_mul_f32 v63, 2.357022604e-01, v63
    v_mul_f32 v64, 2.357022604e-01, v64
Lpad48:
    s_cbranch_execz Lret
    v_mul_f32 v65, 2.357022604e-01, v65
    v_mul_f32 v66, 2.357022604e-01, v66
    v_mul_f32 v67, 2.357022604e-01, v67
    v_mul_f32 v68, 2.357022604e-01, v68
    v_mul_f32 v69, 2.357022604e-01, v69
    v_mul_f32 v70, 2.357022604e-01, v70
    v_mul_f32 v71, 2.357022604e-01, v71
    v_mul_f32 v72, 2.357022604e-01, v72
    v_mul_f32 v73, 2.357022604e-01, v73
    v_mul_f32 v74, 2.357022604e-01, v74
    v_mul_f32 v75, 2.357022604e-01, v75
    v_mul_f32 v76, 2.357022604e-01, v76
    v_mul_f32 v77, 2.357022604e-01, v77
    v_mul_f32 v78, 2.357022604e-01, v78
    v_mul_f32 v79, 2.357022604e-01, v79
Lpad49:
    s_cbranch_execz Lret
    v_mul_f32 v80, 2.357022604e-01, v80
    v_mul_f32 v81, 2.357022604e-01, v81
    v_mul_f32 v82, 2.357022604e-01, v82
    v_mul_f32 v83, 2.357022604e-01, v83
    v_cvt_pk_bf16_f32 v100, v52, v52
    v_lshlrev_b32 v52, 16, v100
    v_cvt_pk_bf16_f32 v101, v53, v53
    v_lshlrev_b32 v53, 16, v101
    v_cvt_pk_bf16_f32 v102, v54, v54
    v_lshlrev_b32 v54, 16, v102
    v_cvt_pk_bf16_f32 v103, v55, v55
    v_lshlrev_b32 v55, 16, v103
    v_cvt_pk_bf16_f32 v100, v56, v56
    v_lshlrev_b32 v56, 16, v100
    v_cvt_pk_bf16_f32 v101, v57, v57
    v_lshlrev_b32 v57, 16, v101
    v_cvt_pk_bf16_f32 v102, v58, v58
    v_lshlrev_b32 v58, 16, v102
Lpad50:
    s_cbranch_execz Lret
    v_cvt_pk_bf16_f32 v103, v59, v59
    v_lshlrev_b32 v59, 16, v103
    v_cvt_pk_bf16_f32 v100, v60, v60
    v_lshlrev_b32 v60, 16, v100
    v_cvt_pk_bf16_f32 v101, v61, v61
    v_lshlrev_b32 v61, 16, v101
    v_cvt_pk_bf16_f32 v102, v62, v62
    v_lshlrev_b32 v62, 16, v102
    v_cvt_pk_bf16_f32 v103, v63, v63
    v_lshlrev_b32 v63, 16, v103
    v_cvt_pk_bf16_f32 v100, v64, v64
    v_lshlrev_b32 v64, 16, v100
    v_cvt_pk_bf16_f32 v101, v65, v65
    v_lshlrev_b32 v65, 16, v101
    v_cvt_pk_bf16_f32 v102, v66, v66
    v_lshlrev_b32 v66, 16, v102
    v_cvt_pk_bf16_f32 v103, v67, v67
    v_lshlrev_b32 v67, 16, v103
    v_cvt_pk_bf16_f32 v100, v68, v68
Lpad51:
    s_cbranch_execz Lret
    v_lshlrev_b32 v68, 16, v100
    v_cvt_pk_bf16_f32 v101, v69, v69
    v_lshlrev_b32 v69, 16, v101
    v_cvt_pk_bf16_f32 v102, v70, v70
    v_lshlrev_b32 v70, 16, v102
    v_cvt_pk_bf16_f32 v103, v71, v71
    v_lshlrev_b32 v71, 16, v103
    v_cvt_pk_bf16_f32 v100, v72, v72
    v_lshlrev_b32 v72, 16, v100
    v_cvt_pk_bf16_f32 v101, v73, v73
    v_lshlrev_b32 v73, 16, v101
    v_cvt_pk_bf16_f32 v102, v74, v74
    v_lshlrev_b32 v74, 16, v102
    v_cvt_pk_bf16_f32 v103, v75, v75
    v_lshlrev_b32 v75, 16, v103
    v_cvt_pk_bf16_f32 v100, v76, v76
    v_lshlrev_b32 v76, 16, v100
    v_cvt_pk_bf16_f32 v101, v77, v77
    v_lshlrev_b32 v77, 16, v101
    v_cvt_pk_bf16_f32 v102, v78, v78
Lpad52:
    s_cbranch_execz Lret
    v_lshlrev_b32 v78, 16, v102
    v_cvt_pk_bf16_f32 v103, v79, v79
    v_lshlrev_b32 v79, 16, v103
    v_cvt_pk_bf16_f32 v100, v80, v80
    v_lshlrev_b32 v80, 16, v100
    v_cvt_pk_bf16_f32 v101, v81, v81
    v_lshlrev_b32 v81, 16, v101
    v_cvt_pk_bf16_f32 v102, v82, v82
    v_lshlrev_b32 v82, 16, v102
    v_cvt_pk_bf16_f32 v103, v83, v83
    v_lshlrev_b32 v83, 16, v103
    v_cmp_le_u32 vcc, 2, v98
    s_nop 1
    v_cndmask_b32 v53, v99, v53, vcc
    v_cndmask_b32 v61, v99, v61, vcc
    v_cndmask_b32 v69, v99, v69, vcc
    v_cndmask_b32 v77, v99, v77, vcc
    v_cmp_le_u32 vcc, 4, v98
    s_nop 1
    v_cndmask_b32 v54, v99, v54, vcc
    v_cndmask_b32 v62, v99, v62, vcc
    v_cndmask_b32 v70, v99, v70, vcc
    v_cndmask_b32 v78, v99, v78, vcc
    v_cmp_le_u32 vcc, 6, v98
Lpad53:
    s_cbranch_execz Lret
    s_nop 1
    v_cndmask_b32 v55, v99, v55, vcc
    v_cndmask_b32 v63, v99, v63, vcc
    v_cndmask_b32 v71, v99, v71, vcc
    v_cndmask_b32 v79, v99, v79, vcc
    v_cmp_le_u32 vcc, 8, v98
    s_nop 1
    v_cndmask_b32 v56, v99, v56, vcc
    v_cndmask_b32 v64, v99, v64, vcc
    v_cndmask_b32 v72, v99, v72, vcc
    v_cndmask_b32 v80, v99, v80, vcc
    v_cmp_le_u32 vcc, 10, v98
    s_nop 1
    v_cndmask_b32 v57, v99, v57, vcc
    v_cndmask_b32 v65, v99, v65, vcc
    v_cndmask_b32 v73, v99, v73, vcc
    v_cndmask_b32 v81, v99, v81, vcc
    v_cmp_le_u32 vcc, 12, v98
    s_nop 1
    v_cndmask_b32 v58, v99, v58, vcc
    v_cndmask_b32 v66, v99, v66, vcc
    v_cndmask_b32 v74, v99, v74, vcc
    v_cndmask_b32 v82, v99, v82, vcc
    v_cmp_le_u32 vcc, 14, v98
    s_nop 1
    v_cndmask_b32 v59, v99, v59, vcc
    v_cndmask_b32 v67, v99, v67, vcc
    v_cndmask_b32 v75, v99, v75, vcc
    v_cndmask_b32 v83, v99, v83, vcc
Lpad54:
    s_cbranch_execz Lret
    v_max3_f32 v100, v52, v53, v54
    v_max3_f32 v100, v100, v55, v56
    v_max3_f32 v100, v100, v57, v58
    v_max_f32 v100, v100, v59
    v_max3_f32 v101, v60, v61, v62
    v_max3_f32 v101, v101, v63, v64
    v_max3_f32 v101, v101, v65, v66
    v_max_f32 v101, v101, v67
    v_max3_f32 v102, v68, v69, v70
    v_max3_f32 v102, v102, v71, v72
    v_max3_f32 v102, v102, v73, v74
    v_max_f32 v102, v102, v75
    v_max3_f32 v103, v76, v77, v78
    v_max3_f32 v103, v103, v79, v80
    v_max3_f32 v103, v103, v81, v82
    v_max_f32 v103, v103, v83
    v_sub_f32 v52, v52, v100
Lpad55:
    s_cbranch_execz Lret
    v_sub_f32 v53, v53, v100
    v_sub_f32 v54, v54, v100
    v_sub_f32 v55, v55, v100
    v_sub_f32 v56, v56, v100
    v_sub_f32 v57, v57, v100
    v_sub_f32 v58, v58, v100
    v_sub_f32 v59, v59, v100
    v_sub_f32 v60, v60, v101
    v_sub_f32 v61, v61, v101
    v_sub_f32 v62, v62, v101
    v_sub_f32 v63, v63, v101
    v_sub_f32 v64, v64, v101
    v_sub_f32 v65, v65, v101
    v_sub_f32 v66, v66, v101
    v_sub_f32 v67, v67, v101
    v_sub_f32 v68, v68, v102
    v_sub_f32 v69, v69, v102
    v_sub_f32 v70, v70, v102
    v_sub_f32 v71, v71, v102
    v_sub_f32 v72, v72, v102
    v_sub_f32 v73, v73, v102
    v_sub_f32 v74, v74, v102
    v_sub_f32 v75, v75, v102
    v_sub_f32 v76, v76, v103
    v_sub_f32 v77, v77, v103
    v_sub_f32 v78, v78, v103
    v_sub_f32 v79, v79, v103
    v_sub_f32 v80, v80, v103
    v_sub_f32 v81, v81, v103
Lpad56:
    s_cbranch_execz Lret
    v_sub_f32 v82, v82, v103
    v_sub_f32 v83, v83, v103
    v_mul_f32 v52, 0x3fb8aa3b, v52
    v_mul_f32 v53, 0x3fb8aa3b, v53
    v_mul_f32 v54, 0x3fb8aa3b, v54
    v_mul_f32 v55, 0x3fb8aa3b, v55
    v_mul_f32 v56, 0x3fb8aa3b, v56
    v_mul_f32 v57, 0x3fb8aa3b, v57
    v_mul_f32 v58, 0x3fb8aa3b, v58
    v_mul_f32 v59, 0x3fb8aa3b, v59
    v_mul_f32 v60, 0x3fb8aa3b, v60
    v_mul_f32 v61, 0x3fb8aa3b, v61
    v_mul_f32 v62, 0x3fb8aa3b, v62
    v_mul_f32 v63, 0x3fb8aa3b, v63
    v_mul_f32 v64, 0x3fb8aa3b, v64
    v_mul_f32 v65, 0x3fb8aa3b, v65
Lpad57:
    s_cbranch_execz Lret
    v_mul_f32 v66, 0x3fb8aa3b, v66
    v_mul_f32 v67, 0x3fb8aa3b, v67
    v_mul_f32 v68, 0x3fb8aa3b, v68
    v_mul_f32 v69, 0x3fb8aa3b, v69
    v_mul_f32 v70, 0x3fb8aa3b, v70
    v_mul_f32 v71, 0x3fb8aa3b, v71
    v_mul_f32 v72, 0x3fb8aa3b, v72
    v_mul_f32 v73, 0x3fb8aa3b, v73
    v_mul_f32 v74, 0x3fb8aa3b, v74
    v_mul_f32 v75, 0x3fb8aa3b, v75
    v_mul_f32 v76, 0x3fb8aa3b, v76
    v_mul_f32 v77, 0x3fb8aa3b, v77
    v_mul_f32 v78, 0x3fb8aa3b, v78
    v_mul_f32 v79, 0x3fb8aa3b, v79
    v_mul_f32 v80, 0x3fb8aa3b, v80
Lpad58:
    s_cbranch_execz Lret
    v_mul_f32 v81, 0x3fb8aa3b, v81
    v_mul_f32 v82, 0x3fb8aa3b, v82
    v_mul_f32 v83, 0x3fb8aa3b, v83
    v_exp_f32 v52, v52
    v_exp_f32 v53, v53
    v_exp_f32 v54, v54
    v_exp_f32 v55, v55
    v_exp_f32 v56, v56
    v_exp_f32 v57, v57
    v_exp_f32 v58, v58
    v_exp_f32 v59, v59
    v_exp_f32 v60, v60
    v_exp_f32 v61, v61
    v_exp_f32 v62, v62
    v_exp_f32 v63, v63
    v_exp_f32 v64, v64
    v_exp_f32 v65, v65
    v_exp_f32 v66, v66
    v_exp_f32 v67, v67
    v_exp_f32 v68, v68
    v_exp_f32 v69, v69
    v_exp_f32 v70, v70
    v_exp_f32 v71, v71
    v_exp_f32 v72, v72
    v_exp_f32 v73, v73
    v_exp_f32 v74, v74
Lpad59:
    s_cbranch_execz Lret
    v_exp_f32 v75, v75
    v_exp_f32 v76, v76
    v_exp_f32 v77, v77
    v_exp_f32 v78, v78
    v_exp_f32 v79, v79
    v_exp_f32 v80, v80
    v_exp_f32 v81, v81
    v_exp_f32 v82, v82
    v_exp_f32 v83, v83
    s_nop 0
    v_add_f32 v100, v52, v53
    v_add_f32 v101, v60, v61
    v_add_f32 v102, v68, v69
    v_add_f32 v103, v76, v77
    v_add_f32 v100, v100, v54
    v_add_f32 v101, v101, v62
    v_add_f32 v102, v102, v70
    v_add_f32 v103, v103, v78
    v_add_f32 v100, v100, v55
    v_add_f32 v101, v101, v63
    v_add_f32 v102, v102, v71
    v_add_f32 v103, v103, v79
    v_add_f32 v100, v100, v56
    v_add_f32 v101, v101, v64
    v_add_f32 v102, v102, v72
    v_add_f32 v103, v103, v80
    v_add_f32 v100, v100, v57
    v_add_f32 v101, v101, v65
    v_add_f32 v102, v102, v73
Lpad60:
    s_cbranch_execz Lret
    v_add_f32 v103, v103, v81
    v_add_f32 v100, v100, v58
    v_add_f32 v101, v101, v66
    v_add_f32 v102, v102, v74
    v_add_f32 v103, v103, v82
    v_add_f32 v100, v100, v59
    v_add_f32 v101, v101, v67
    v_add_f32 v102, v102, v75
    v_add_f32 v103, v103, v83
    v_rcp_f32 v100, v100
    v_rcp_f32 v101, v101
    v_rcp_f32 v102, v102
    v_rcp_f32 v103, v103
    s_nop 0
    v_mul_f32 v52, v52, v100
    v_mul_f32 v53, v53, v100
    v_mul_f32 v54, v54, v100
    v_mul_f32 v55, v55, v100
    v_mul_f32 v56, v56, v100
    v_mul_f32 v57, v57, v100
    v_mul_f32 v58, v58, v100
    v_mul_f32 v59, v59, v100
    v_mul_f32 v60, v60, v101
    v_mul_f32 v61, v61, v101
    v_mul_f32 v62, v62, v101
    v_mul_f32 v63, v63, v101
    v_mul_f32 v64, v64, v101
    v_mul_f32 v65, v65, v101
    v_mul_f32 v66, v66, v101
Lpad61:
    s_cbranch_execz Lret
    v_mul_f32 v67, v67, v101
    v_mul_f32 v68, v68, v102
    v_mul_f32 v69, v69, v102
    v_mul_f32 v70, v70, v102
    v_mul_f32 v71, v71, v102
    v_mul_f32 v72, v72, v102
    v_mul_f32 v73, v73, v102
    v_mul_f32 v74, v74, v102
    v_mul_f32 v75, v75, v102
    v_mul_f32 v76, v76, v103
    v_mul_f32 v77, v77, v103
    v_mul_f32 v78, v78, v103
    v_mul_f32 v79, v79, v103
    v_mul_f32 v80, v80, v103
    v_mul_f32 v81, v81, v103
    v_mul_f32 v82, v82, v103
    v_mul_f32 v83, v83, v103
    v_cvt_pk_bf16_f32 v52, v52, 0
    v_cvt_pk_bf16_f32 v53, v53, 0
    v_cvt_pk_bf16_f32 v54, v54, 0
    v_cvt_pk_bf16_f32 v55, v55, 0
    v_cvt_pk_bf16_f32 v56, v56, 0
    v_cvt_pk_bf16_f32 v57, v57, 0
Lpad62:
    s_cbranch_execz Lret
    v_cvt_pk_bf16_f32 v58, v58, 0
    v_cvt_pk_bf16_f32 v59, v59, 0
    v_cvt_pk_bf16_f32 v60, v60, 0
    v_cvt_pk_bf16_f32 v61, v61, 0
    v_cvt_pk_bf16_f32 v62, v62, 0
    v_cvt_pk_bf16_f32 v63, v63, 0
    v_cvt_pk_bf16_f32 v64, v64, 0
    v_cvt_pk_bf16_f32 v65, v65, 0
    v_cvt_pk_bf16_f32 v66, v66, 0
    v_cvt_pk_bf16_f32 v67, v67, 0
    v_cvt_pk_bf16_f32 v68, v68, 0
    v_cvt_pk_bf16_f32 v69, v69, 0
    v_cvt_pk_bf16_f32 v70, v70, 0
    v_cvt_pk_bf16_f32 v71, v71, 0
    v_cvt_pk_bf16_f32 v72, v72, 0
Lpad63:
    s_cbranch_execz Lret
    v_cvt_pk_bf16_f32 v73, v73, 0
    v_cvt_pk_bf16_f32 v74, v74, 0
    v_cvt_pk_bf16_f32 v75, v75, 0
    v_cvt_pk_bf16_f32 v76, v76, 0
    v_cvt_pk_bf16_f32 v77, v77, 0
    v_cvt_pk_bf16_f32 v78, v78, 0
    v_cvt_pk_bf16_f32 v79, v79, 0
    v_cvt_pk_bf16_f32 v80, v80, 0
    v_cvt_pk_bf16_f32 v81, v81, 0
    v_cvt_pk_bf16_f32 v82, v82, 0
    v_cvt_pk_bf16_f32 v83, v83, 0
    v_lshlrev_b32 v16, 16, v52
    v_lshlrev_b32 v17, 16, v53
    v_lshlrev_b32 v18, 16, v54
    v_lshlrev_b32 v19, 16, v55
    v_lshlrev_b32 v20, 16, v56
    v_lshlrev_b32 v21, 16, v57
    v_lshlrev_b32 v22, 16, v58
Lpad64:
    s_cbranch_execz Lret
    v_lshlrev_b32 v23, 16, v59
    v_lshlrev_b32 v24, 16, v60
    v_lshlrev_b32 v25, 16, v61
    v_lshlrev_b32 v26, 16, v62
    v_lshlrev_b32 v27, 16, v63
    v_lshlrev_b32 v28, 16, v64
    v_lshlrev_b32 v29, 16, v65
    v_lshlrev_b32 v30, 16, v66
    v_lshlrev_b32 v31, 16, v67
    v_lshlrev_b32 v32, 16, v68
    v_lshlrev_b32 v33, 16, v69
    v_lshlrev_b32 v34, 16, v70
    v_lshlrev_b32 v35, 16, v71
    v_lshlrev_b32 v36, 16, v72
    v_lshlrev_b32 v37, 16, v73
    v_lshlrev_b32 v38, 16, v74
    v_lshlrev_b32 v39, 16, v75
    v_lshlrev_b32 v40, 16, v76
    v_lshlrev_b32 v41, 16, v77
    v_lshlrev_b32 v42, 16, v78
    v_lshlrev_b32 v43, 16, v79
    v_lshlrev_b32 v44, 16, v80
    v_lshlrev_b32 v45, 16, v81
    v_lshlrev_b32 v46, 16, v82
    v_lshlrev_b32 v47, 16, v83
    v_mov_b32 v184, 0
    v_mov_b32 v185, 0
    v_mov_b32 v186, 0
    v_mov_b32 v187, 0
Lpad65:
    s_cbranch_execz Lret
    v_mov_b32 v188, 0
    v_mov_b32 v189, 0
    v_mov_b32 v190, 0
    v_mov_b32 v191, 0
    v_mov_b32 v192, 0
    v_mov_b32 v193, 0
    v_mov_b32 v194, 0
    v_mov_b32 v195, 0
    v_mov_b32 v196, 0
    v_mov_b32 v197, 0
    v_mov_b32 v198, 0
    v_mov_b32 v199, 0
    v_mov_b32 v200, 0
    v_mov_b32 v201, 0
    v_mov_b32 v202, 0
    v_mov_b32 v203, 0
    v_mov_b32 v204, 0
    v_mov_b32 v205, 0
    v_mov_b32 v206, 0
    v_mov_b32 v207, 0
    v_mov_b32 v208, 0
    v_mov_b32 v209, 0
    v_mov_b32 v210, 0
    v_mov_b32 v211, 0
    v_mov_b32 v212, 0
    v_mov_b32 v213, 0
    v_mov_b32 v214, 0
    v_mov_b32 v215, 0
    v_mov_b32 v216, 0
Lpad66:
    s_cbranch_execz Lret
    v_mov_b32 v217, 0
    v_mov_b32 v218, 0
    v_mov_b32 v219, 0
    v_mov_b32 v220, 0
    v_mov_b32 v221, 0
    v_mov_b32 v222, 0
    v_mov_b32 v223, 0
    v_mov_b32 v224, 0
    v_mov_b32 v225, 0
    v_mov_b32 v226, 0
    v_mov_b32 v227, 0
    v_mov_b32 v228, 0
    v_mov_b32 v229, 0
    v_mov_b32 v230, 0
    v_mov_b32 v231, 0
    v_mov_b32 v232, 0
    v_mov_b32 v233, 0
    v_mov_b32 v234, 0
    v_mov_b32 v235, 0
    v_mov_b32 v236, 0
    v_mov_b32 v237, 0
    v_mov_b32 v238, 0
    v_mov_b32 v239, 0
    v_mov_b32 v240, 0
    v_mov_b32 v241, 0
    v_mov_b32 v242, 0
    v_mov_b32 v243, 0
    v_mov_b32 v244, 0
    v_mov_b32 v245, 0
Lpad67:
    s_cbranch_execz Lret
    v_mov_b32 v246, 0
    v_mov_b32 v247, 0
    v_mov_b32 v248, 0
    v_mov_b32 v249, 0
    v_mov_b32 v250, 0
    v_mov_b32 v251, 0
    v_mov_b32 v252, 0
    v_mov_b32 v253, 0
    v_mov_b32 v254, 0
    v_mov_b32 v255, 0
    ds_read_b128 v[148:151], v96 offset:7392
    ds_read_b128 v[152:155], v96 offset:7408
    ds_read_b128 v[156:159], v96 offset:7424
    ds_read_b128 v[160:163], v96 offset:7440
    ds_read_b128 v[164:167], v96 offset:7456
    ds_read_b128 v[168:171], v96 offset:7472
    ds_read_b128 v[172:175], v96 offset:7488
    ds_read_b128 v[176:179], v96 offset:7504
    ds_read_b128 v[180:183], v96 offset:7520
    s_waitcnt lgkmcnt(9)
Lpad68:
    s_cbranch_execz Lret
    v_dot2c_f32_bf16 v184, v112, v52
    v_dot2c_f32_bf16 v185, v112, v16
    v_dot2c_f32_bf16 v186, v113, v52
    v_dot2c_f32_bf16 v187, v113, v16
    v_dot2c_f32_bf16 v188, v114, v52
    v_dot2c_f32_bf16 v189, v114, v16
    v_dot2c_f32_bf16 v190, v115, v52
    v_dot2c_f32_bf16 v191, v115, v16
    v_dot2c_f32_bf16 v192, v116, v52
    v_dot2c_f32_bf16 v193, v116, v16
    v_dot2c_f32_bf16 v194, v117, v52
    v_dot2c_f32_bf16 v195, v117, v16
    v_dot2c_f32_bf16 v196, v118, v52
    v_dot2c_f32_bf16 v197, v118, v16
    v_dot2c_f32_bf16 v198, v119, v52
    v_dot2c_f32_bf16 v199, v119, v16
    v_dot2c_f32_bf16 v200, v120, v52
    v_dot2c_f32_bf16 v201, v120, v16
    v_dot2c_f32_bf16 v202, v121, v60
    v_dot2c_f32_bf16 v203, v121, v24
    v_dot2c_f32_bf16 v204, v122, v60
    v_dot2c_f32_bf16 v205, v122, v24
    v_dot2c_f32_bf16 v206, v123, v60
    v_dot2c_f32_bf16 v207, v123, v24
    v_dot2c_f32_bf16 v208, v124, v60
    v_dot2c_f32_bf16 v209, v124, v24
    v_dot2c_f32_bf16 v210, v125, v60
    v_dot2c_f32_bf16 v211, v125, v24
    v_dot2c_f32_bf16 v212, v126, v60
Lpad69:
    s_cbranch_execz Lret
    v_dot2c_f32_bf16 v213, v126, v24
    v_dot2c_f32_bf16 v214, v127, v60
    v_dot2c_f32_bf16 v215, v127, v24
    v_dot2c_f32_bf16 v216, v128, v60
    v_dot2c_f32_bf16 v217, v128, v24
    v_dot2c_f32_bf16 v218, v129, v60
    v_dot2c_f32_bf16 v219, v129, v24
    v_dot2c_f32_bf16 v220, v130, v68
    v_dot2c_f32_bf16 v221, v130, v32
    v_dot2c_f32_bf16 v222, v131, v68
    v_dot2c_f32_bf16 v223, v131, v32
    v_dot2c_f32_bf16 v224, v132, v68
    v_dot2c_f32_bf16 v225, v132, v32
    v_dot2c_f32_bf16 v226, v133, v68
    v_dot2c_f32_bf16 v227, v133, v32
    v_dot2c_f32_bf16 v228, v134, v68
    v_dot2c_f32_bf16 v229, v134, v32
    v_dot2c_f32_bf16 v230, v135, v68
    v_dot2c_f32_bf16 v231, v135, v32
    v_dot2c_f32_bf16 v232, v136, v68
    v_dot2c_f32_bf16 v233, v136, v32
    v_dot2c_f32_bf16 v234, v137, v68
    v_dot2c_f32_bf16 v235, v137, v32
    v_dot2c_f32_bf16 v236, v138, v68
    v_dot2c_f32_bf16 v237, v138, v32
    v_dot2c_f32_bf16 v238, v139, v76
    v_dot2c_f32_bf16 v239, v139, v40
    v_dot2c_f32_bf16 v240, v140, v76
    v_dot2c_f32_bf16 v241, v140, v40
Lpad70:
    s_cbranch_execz Lret
    v_dot2c_f32_bf16 v242, v141, v76
    v_dot2c_f32_bf16 v243, v141, v40
    v_dot2c_f32_bf16 v244, v142, v76
    v_dot2c_f32_bf16 v245, v142, v40
    v_dot2c_f32_bf16 v246, v143, v76
    v_dot2c_f32_bf16 v247, v143, v40
    v_dot2c_f32_bf16 v248, v144, v76
    v_dot2c_f32_bf16 v249, v144, v40
    v_dot2c_f32_bf16 v250, v145, v76
    v_dot2c_f32_bf16 v251, v145, v40
    v_dot2c_f32_bf16 v252, v146, v76
    v_dot2c_f32_bf16 v253, v146, v40
    v_dot2c_f32_bf16 v254, v147, v76
    v_dot2c_f32_bf16 v255, v147, v40
    ds_read_b128 v[112:115], v96 offset:6208
    ds_read_b128 v[116:119], v96 offset:6224
    ds_read_b128 v[120:123], v96 offset:6240
    ds_read_b128 v[124:127], v96 offset:6256
    ds_read_b128 v[128:131], v96 offset:6272
    ds_read_b128 v[132:135], v96 offset:6288
    ds_read_b128 v[136:139], v96 offset:6304
    ds_read_b128 v[140:143], v96 offset:6320
Lpad71:
    s_cbranch_execz Lret
    ds_read_b128 v[144:147], v96 offset:6336
    s_waitcnt lgkmcnt(9)
    v_dot2c_f32_bf16 v184, v148, v53
    v_dot2c_f32_bf16 v185, v148, v17
    v_dot2c_f32_bf16 v186, v149, v53
    v_dot2c_f32_bf16 v187, v149, v17
    v_dot2c_f32_bf16 v188, v150, v53
    v_dot2c_f32_bf16 v189, v150, v17
    v_dot2c_f32_bf16 v190, v151, v53
    v_dot2c_f32_bf16 v191, v151, v17
    v_dot2c_f32_bf16 v192, v152, v53
    v_dot2c_f32_bf16 v193, v152, v17
    v_dot2c_f32_bf16 v194, v153, v53
    v_dot2c_f32_bf16 v195, v153, v17
    v_dot2c_f32_bf16 v196, v154, v53
    v_dot2c_f32_bf16 v197, v154, v17
    v_dot2c_f32_bf16 v198, v155, v53
    v_dot2c_f32_bf16 v199, v155, v17
    v_dot2c_f32_bf16 v200, v156, v53
    v_dot2c_f32_bf16 v201, v156, v17
    v_dot2c_f32_bf16 v202, v157, v61
    v_dot2c_f32_bf16 v203, v157, v25
    v_dot2c_f32_bf16 v204, v158, v61
    v_dot2c_f32_bf16 v205, v158, v25
    v_dot2c_f32_bf16 v206, v159, v61
    v_dot2c_f32_bf16 v207, v159, v25
    v_dot2c_f32_bf16 v208, v160, v61
    v_dot2c_f32_bf16 v209, v160, v25
Lpad72:
    s_cbranch_execz Lret
    v_dot2c_f32_bf16 v210, v161, v61
    v_dot2c_f32_bf16 v211, v161, v25
    v_dot2c_f32_bf16 v212, v162, v61
    v_dot2c_f32_bf16 v213, v162, v25
    v_dot2c_f32_bf16 v214, v163, v61
    v_dot2c_f32_bf16 v215, v163, v25
    v_dot2c_f32_bf16 v216, v164, v61
    v_dot2c_f32_bf16 v217, v164, v25
    v_dot2c_f32_bf16 v218, v165, v61
    v_dot2c_f32_bf16 v219, v165, v25
    v_dot2c_f32_bf16 v220, v166, v69
    v_dot2c_f32_bf16 v221, v166, v33
    v_dot2c_f32_bf16 v222, v167, v69
    v_dot2c_f32_bf16 v223, v167, v33
    v_dot2c_f32_bf16 v224, v168, v69
    v_dot2c_f32_bf16 v225, v168, v33
    v_dot2c_f32_bf16 v226, v169, v69
    v_dot2c_f32_bf16 v227, v169, v33
    v_dot2c_f32_bf16 v228, v170, v69
    v_dot2c_f32_bf16 v229, v170, v33
    v_dot2c_f32_bf16 v230, v171, v69
    v_dot2c_f32_bf16 v231, v171, v33
    v_dot2c_f32_bf16 v232, v172, v69
    v_dot2c_f32_bf16 v233, v172, v33
    v_dot2c_f32_bf16 v234, v173, v69
    v_dot2c_f32_bf16 v235, v173, v33
    v_dot2c_f32_bf16 v236, v174, v69
    v_dot2c_f32_bf16 v237, v174, v33
    v_dot2c_f32_bf16 v238, v175, v77
Lpad73:
    s_cbranch_execz Lret
    v_dot2c_f32_bf16 v239, v175, v41
    v_dot2c_f32_bf16 v240, v176, v77
    v_dot2c_f32_bf16 v241, v176, v41
    v_dot2c_f32_bf16 v242, v177, v77
    v_dot2c_f32_bf16 v243, v177, v41
    v_dot2c_f32_bf16 v244, v178, v77
    v_dot2c_f32_bf16 v245, v178, v41
    v_dot2c_f32_bf16 v246, v179, v77
    v_dot2c_f32_bf16 v247, v179, v41
    v_dot2c_f32_bf16 v248, v180, v77
    v_dot2c_f32_bf16 v249, v180, v41
    v_dot2c_f32_bf16 v250, v181, v77
    v_dot2c_f32_bf16 v251, v181, v41
    v_dot2c_f32_bf16 v252, v182, v77
    v_dot2c_f32_bf16 v253, v182, v41
    v_dot2c_f32_bf16 v254, v183, v77
    v_dot2c_f32_bf16 v255, v183, v41
    ds_read_b128 v[148:151], v96 offset:5024
    ds_read_b128 v[152:155], v96 offset:5040
    ds_read_b128 v[156:159], v96 offset:5056
    ds_read_b128 v[160:163], v96 offset:5072
    ds_read_b128 v[164:167], v96 offset:5088
    ds_read_b128 v[168:171], v96 offset:5104
Lpad74:
    s_cbranch_execz Lret
    ds_read_b128 v[172:175], v96 offset:5120
    ds_read_b128 v[176:179], v96 offset:5136
    ds_read_b128 v[180:183], v96 offset:5152
    s_waitcnt lgkmcnt(9)
    v_dot2c_f32_bf16 v184, v112, v54
    v_dot2c_f32_bf16 v185, v112, v18
    v_dot2c_f32_bf16 v186, v113, v54
    v_dot2c_f32_bf16 v187, v113, v18
    v_dot2c_f32_bf16 v188, v114, v54
    v_dot2c_f32_bf16 v189, v114, v18
    v_dot2c_f32_bf16 v190, v115, v54
    v_dot2c_f32_bf16 v191, v115, v18
    v_dot2c_f32_bf16 v192, v116, v54
    v_dot2c_f32_bf16 v193, v116, v18
    v_dot2c_f32_bf16 v194, v117, v54
    v_dot2c_f32_bf16 v195, v117, v18
    v_dot2c_f32_bf16 v196, v118, v54
    v_dot2c_f32_bf16 v197, v118, v18
    v_dot2c_f32_bf16 v198, v119, v54
    v_dot2c_f32_bf16 v199, v119, v18
    v_dot2c_f32_bf16 v200, v120, v54
    v_dot2c_f32_bf16 v201, v120, v18
    v_dot2c_f32_bf16 v202, v121, v62
    v_dot2c_f32_bf16 v203, v121, v26
    v_dot2c_f32_bf16 v204, v122, v62
    v_dot2c_f32_bf16 v205, v122, v26
Lpad75:
    s_cbranch_execz Lret
    v_dot2c_f32_bf16 v206, v123, v62
    v_dot2c_f32_bf16 v207, v123, v26
    v_dot2c_f32_bf16 v208, v124, v62
    v_dot2c_f32_bf16 v209, v124, v26
    v_dot2c_f32_bf16 v210, v125, v62
    v_dot2c_f32_bf16 v211, v125, v26
    v_dot2c_f32_bf16 v212, v126, v62
    v_dot2c_f32_bf16 v213, v126, v26
    v_dot2c_f32_bf16 v214, v127, v62
    v_dot2c_f32_bf16 v215, v127, v26
    v_dot2c_f32_bf16 v216, v128, v62
    v_dot2c_f32_bf16 v217, v128, v26
    v_dot2c_f32_bf16 v218, v129, v62
    v_dot2c_f32_bf16 v219, v129, v26
    v_dot2c_f32_bf16 v220, v130, v70
    v_dot2c_f32_bf16 v221, v130, v34
    v_dot2c_f32_bf16 v222, v131, v70
    v_dot2c_f32_bf16 v223, v131, v34
    v_dot2c_f32_bf16 v224, v132, v70
    v_dot2c_f32_bf16 v225, v132, v34
    v_dot2c_f32_bf16 v226, v133, v70
    v_dot2c_f32_bf16 v227, v133, v34
    v_dot2c_f32_bf16 v228, v134, v70
    v_dot2c_f32_bf16 v229, v134, v34
    v_dot2c_f32_bf16 v230, v135, v70
    v_dot2c_f32_bf16 v231, v135, v34
    v_dot2c_f32_bf16 v232, v136, v70
    v_dot2c_f32_bf16 v233, v136, v34
    v_dot2c_f32_bf16 v234, v137, v70
Lpad76:
    s_cbranch_execz Lret
    v_dot2c_f32_bf16 v235, v137, v34
    v_dot2c_f32_bf16 v236, v138, v70
    v_dot2c_f32_bf16 v237, v138, v34
    v_dot2c_f32_bf16 v238, v139, v78
    v_dot2c_f32_bf16 v239, v139, v42
    v_dot2c_f32_bf16 v240, v140, v78
    v_dot2c_f32_bf16 v241, v140, v42
    v_dot2c_f32_bf16 v242, v141, v78
    v_dot2c_f32_bf16 v243, v141, v42
    v_dot2c_f32_bf16 v244, v142, v78
    v_dot2c_f32_bf16 v245, v142, v42
    v_dot2c_f32_bf16 v246, v143, v78
    v_dot2c_f32_bf16 v247, v143, v42
    v_dot2c_f32_bf16 v248, v144, v78
    v_dot2c_f32_bf16 v249, v144, v42
    v_dot2c_f32_bf16 v250, v145, v78
    v_dot2c_f32_bf16 v251, v145, v42
    v_dot2c_f32_bf16 v252, v146, v78
    v_dot2c_f32_bf16 v253, v146, v42
    v_dot2c_f32_bf16 v254, v147, v78
    v_dot2c_f32_bf16 v255, v147, v42
    ds_read_b128 v[112:115], v96 offset:3840
    ds_read_b128 v[116:119], v96 offset:3856
    ds_read_b128 v[120:123], v96 offset:3872
    ds_read_b128 v[124:127], v96 offset:3888
Lpad77:
    s_cbranch_execz Lret
    ds_read_b128 v[128:131], v96 offset:3904
    ds_read_b128 v[132:135], v96 offset:3920
    ds_read_b128 v[136:139], v96 offset:3936
    ds_read_b128 v[140:143], v96 offset:3952
    ds_read_b128 v[144:147], v96 offset:3968
    s_waitcnt lgkmcnt(9)
    v_dot2c_f32_bf16 v184, v148, v55
    v_dot2c_f32_bf16 v185, v148, v19
    v_dot2c_f32_bf16 v186, v149, v55
    v_dot2c_f32_bf16 v187, v149, v19
    v_dot2c_f32_bf16 v188, v150, v55
    v_dot2c_f32_bf16 v189, v150, v19
    v_dot2c_f32_bf16 v190, v151, v55
    v_dot2c_f32_bf16 v191, v151, v19
    v_dot2c_f32_bf16 v192, v152, v55
    v_dot2c_f32_bf16 v193, v152, v19
    v_dot2c_f32_bf16 v194, v153, v55
    v_dot2c_f32_bf16 v195, v153, v19
    v_dot2c_f32_bf16 v196, v154, v55
    v_dot2c_f32_bf16 v197, v154, v19
    v_dot2c_f32_bf16 v198, v155, v55
    v_dot2c_f32_bf16 v199, v155, v19
    v_dot2c_f32_bf16 v200, v156, v55
    v_dot2c_f32_bf16 v201, v156, v19
Lpad78:
    s_cbranch_execz Lret
    v_dot2c_f32_bf16 v202, v157, v63
    v_dot2c_f32_bf16 v203, v157, v27
    v_dot2c_f32_bf16 v204, v158, v63
    v_dot2c_f32_bf16 v205, v158, v27
    v_dot2c_f32_bf16 v206, v159, v63
    v_dot2c_f32_bf16 v207, v159, v27
    v_dot2c_f32_bf16 v208, v160, v63
    v_dot2c_f32_bf16 v209, v160, v27
    v_dot2c_f32_bf16 v210, v161, v63
    v_dot2c_f32_bf16 v211, v161, v27
    v_dot2c_f32_bf16 v212, v162, v63
    v_dot2c_f32_bf16 v213, v162, v27
    v_dot2c_f32_bf16 v214, v163, v63
    v_dot2c_f32_bf16 v215, v163, v27
    v_dot2c_f32_bf16 v216, v164, v63
    v_dot2c_f32_bf16 v217, v164, v27
    v_dot2c_f32_bf16 v218, v165, v63
    v_dot2c_f32_bf16 v219, v165, v27
    v_dot2c_f32_bf16 v220, v166, v71
    v_dot2c_f32_bf16 v221, v166, v35
    v_dot2c_f32_bf16 v222, v167, v71
    v_dot2c_f32_bf16 v223, v167, v35
    v_dot2c_f32_bf16 v224, v168, v71
    v_dot2c_f32_bf16 v225, v168, v35
    v_dot2c_f32_bf16 v226, v169, v71
    v_dot2c_f32_bf16 v227, v169, v35
    v_dot2c_f32_bf16 v228, v170, v71
    v_dot2c_f32_bf16 v229, v170, v35
    v_dot2c_f32_bf16 v230, v171, v71
Lpad79:
    s_cbranch_execz Lret
    v_dot2c_f32_bf16 v231, v171, v35
    v_dot2c_f32_bf16 v232, v172, v71
    v_dot2c_f32_bf16 v233, v172, v35
    v_dot2c_f32_bf16 v234, v173, v71
    v_dot2c_f32_bf16 v235, v173, v35
    v_dot2c_f32_bf16 v236, v174, v71
    v_dot2c_f32_bf16 v237, v174, v35
    v_dot2c_f32_bf16 v238, v175, v79
    v_dot2c_f32_bf16 v239, v175, v43
    v_dot2c_f32_bf16 v240, v176, v79
    v_dot2c_f32_bf16 v241, v176, v43
    v_dot2c_f32_bf16 v242, v177, v79
    v_dot2c_f32_bf16 v243, v177, v43
    v_dot2c_f32_bf16 v244, v178, v79
    v_dot2c_f32_bf16 v245, v178, v43
    v_dot2c_f32_bf16 v246, v179, v79
    v_dot2c_f32_bf16 v247, v179, v43
    v_dot2c_f32_bf16 v248, v180, v79
    v_dot2c_f32_bf16 v249, v180, v43
    v_dot2c_f32_bf16 v250, v181, v79
    v_dot2c_f32_bf16 v251, v181, v43
    v_dot2c_f32_bf16 v252, v182, v79
    v_dot2c_f32_bf16 v253, v182, v43
    v_dot2c_f32_bf16 v254, v183, v79
    v_dot2c_f32_bf16 v255, v183, v43
    ds_read_b128 v[148:151], v96 offset:2656
    ds_read_b128 v[152:155], v96 offset:2672
Lpad80:
    s_cbranch_execz Lret
    ds_read_b128 v[156:159], v96 offset:2688
    ds_read_b128 v[160:163], v96 offset:2704
    ds_read_b128 v[164:167], v96 offset:2720
    ds_read_b128 v[168:171], v96 offset:2736
    ds_read_b128 v[172:175], v96 offset:2752
    ds_read_b128 v[176:179], v96 offset:2768
    ds_read_b128 v[180:183], v96 offset:2784
    s_waitcnt lgkmcnt(9)
    v_dot2c_f32_bf16 v184, v112, v56
    v_dot2c_f32_bf16 v185, v112, v20
    v_dot2c_f32_bf16 v186, v113, v56
    v_dot2c_f32_bf16 v187, v113, v20
    v_dot2c_f32_bf16 v188, v114, v56
    v_dot2c_f32_bf16 v189, v114, v20
    v_dot2c_f32_bf16 v190, v115, v56
    v_dot2c_f32_bf16 v191, v115, v20
    v_dot2c_f32_bf16 v192, v116, v56
    v_dot2c_f32_bf16 v193, v116, v20
    v_dot2c_f32_bf16 v194, v117, v56
    v_dot2c_f32_bf16 v195, v117, v20
    v_dot2c_f32_bf16 v196, v118, v56
    v_dot2c_f32_bf16 v197, v118, v20
Lpad81:
    s_cbranch_execz Lret
    v_dot2c_f32_bf16 v198, v119, v56
    v_dot2c_f32_bf16 v199, v119, v20
    v_dot2c_f32_bf16 v200, v120, v56
    v_dot2c_f32_bf16 v201, v120, v20
    v_dot2c_f32_bf16 v202, v121, v64
    v_dot2c_f32_bf16 v203, v121, v28
    v_dot2c_f32_bf16 v204, v122, v64
    v_dot2c_f32_bf16 v205, v122, v28
    v_dot2c_f32_bf16 v206, v123, v64
    v_dot2c_f32_bf16 v207, v123, v28
    v_dot2c_f32_bf16 v208, v124, v64
    v_dot2c_f32_bf16 v209, v124, v28
    v_dot2c_f32_bf16 v210, v125, v64
    v_dot2c_f32_bf16 v211, v125, v28
    v_dot2c_f32_bf16 v212, v126, v64
    v_dot2c_f32_bf16 v213, v126, v28
    v_dot2c_f32_bf16 v214, v127, v64
    v_dot2c_f32_bf16 v215, v127, v28
    v_dot2c_f32_bf16 v216, v128, v64
    v_dot2c_f32_bf16 v217, v128, v28
    v_dot2c_f32_bf16 v218, v129, v64
    v_dot2c_f32_bf16 v219, v129, v28
    v_dot2c_f32_bf16 v220, v130, v72
    v_dot2c_f32_bf16 v221, v130, v36
    v_dot2c_f32_bf16 v222, v131, v72
    v_dot2c_f32_bf16 v223, v131, v36
    v_dot2c_f32_bf16 v224, v132, v72
    v_dot2c_f32_bf16 v225, v132, v36
    v_dot2c_f32_bf16 v226, v133, v72
Lpad82:
    s_cbranch_execz Lret
    v_dot2c_f32_bf16 v227, v133, v36
    v_dot2c_f32_bf16 v228, v134, v72
    v_dot2c_f32_bf16 v229, v134, v36
    v_dot2c_f32_bf16 v230, v135, v72
    v_dot2c_f32_bf16 v231, v135, v36
    v_dot2c_f32_bf16 v232, v136, v72
    v_dot2c_f32_bf16 v233, v136, v36
    v_dot2c_f32_bf16 v234, v137, v72
    v_dot2c_f32_bf16 v235, v137, v36
    v_dot2c_f32_bf16 v236, v138, v72
    v_dot2c_f32_bf16 v237, v138, v36
    v_dot2c_f32_bf16 v238, v139, v80
    v_dot2c_f32_bf16 v239, v139, v44
    v_dot2c_f32_bf16 v240, v140, v80
    v_dot2c_f32_bf16 v241, v140, v44
    v_dot2c_f32_bf16 v242, v141, v80
    v_dot2c_f32_bf16 v243, v141, v44
    v_dot2c_f32_bf16 v244, v142, v80
    v_dot2c_f32_bf16 v245, v142, v44
    v_dot2c_f32_bf16 v246, v143, v80
    v_dot2c_f32_bf16 v247, v143, v44
    v_dot2c_f32_bf16 v248, v144, v80
    v_dot2c_f32_bf16 v249, v144, v44
    v_dot2c_f32_bf16 v250, v145, v80
    v_dot2c_f32_bf16 v251, v145, v44
    v_dot2c_f32_bf16 v252, v146, v80
    v_dot2c_f32_bf16 v253, v146, v44
    v_dot2c_f32_bf16 v254, v147, v80
    v_dot2c_f32_bf16 v255, v147, v44
Lpad83:
    s_cbranch_execz Lret
    ds_read_b128 v[112:115], v96 offset:1472
    ds_read_b128 v[116:119], v96 offset:1488
    ds_read_b128 v[120:123], v96 offset:1504
    ds_read_b128 v[124:127], v96 offset:1520
    ds_read_b128 v[128:131], v96 offset:1536
    ds_read_b128 v[132:135], v96 offset:1552
    ds_read_b128 v[136:139], v96 offset:1568
    ds_read_b128 v[140:143], v96 offset:1584
    ds_read_b128 v[144:147], v96 offset:1600
    s_waitcnt lgkmcnt(9)
    v_dot2c_f32_bf16 v184, v148, v57
    v_dot2c_f32_bf16 v185, v148, v21
    v_dot2c_f32_bf16 v186, v149, v57
    v_dot2c_f32_bf16 v187, v149, v21
    v_dot2c_f32_bf16 v188, v150, v57
    v_dot2c_f32_bf16 v189, v150, v21
    v_dot2c_f32_bf16 v190, v151, v57
    v_dot2c_f32_bf16 v191, v151, v21
    v_dot2c_f32_bf16 v192, v152, v57
    v_dot2c_f32_bf16 v193, v152, v21
Lpad84:
    s_cbranch_execz Lret
    v_dot2c_f32_bf16 v194, v153, v57
    v_dot2c_f32_bf16 v195, v153, v21
    v_dot2c_f32_bf16 v196, v154, v57
    v_dot2c_f32_bf16 v197, v154, v21
    v_dot2c_f32_bf16 v198, v155, v57
    v_dot2c_f32_bf16 v199, v155, v21
    v_dot2c_f32_bf16 v200, v156, v57
    v_dot2c_f32_bf16 v201, v156, v21
    v_dot2c_f32_bf16 v202, v157, v65
    v_dot2c_f32_bf16 v203, v157, v29
    v_dot2c_f32_bf16 v204, v158, v65
    v_dot2c_f32_bf16 v205, v158, v29
    v_dot2c_f32_bf16 v206, v159, v65
    v_dot2c_f32_bf16 v207, v159, v29
    v_dot2c_f32_bf16 v208, v160, v65
    v_dot2c_f32_bf16 v209, v160, v29
    v_dot2c_f32_bf16 v210, v161, v65
    v_dot2c_f32_bf16 v211, v161, v29
    v_dot2c_f32_bf16 v212, v162, v65
    v_dot2c_f32_bf16 v213, v162, v29
    v_dot2c_f32_bf16 v214, v163, v65
    v_dot2c_f32_bf16 v215, v163, v29
    v_dot2c_f32_bf16 v216, v164, v65
    v_dot2c_f32_bf16 v217, v164, v29
    v_dot2c_f32_bf16 v218, v165, v65
    v_dot2c_f32_bf16 v219, v165, v29
    v_dot2c_f32_bf16 v220, v166, v73
    v_dot2c_f32_bf16 v221, v166, v37
    v_dot2c_f32_bf16 v222, v167, v73
Lpad85:
    s_cbranch_execz Lret
    v_dot2c_f32_bf16 v223, v167, v37
    v_dot2c_f32_bf16 v224, v168, v73
    v_dot2c_f32_bf16 v225, v168, v37
    v_dot2c_f32_bf16 v226, v169, v73
    v_dot2c_f32_bf16 v227, v169, v37
    v_dot2c_f32_bf16 v228, v170, v73
    v_dot2c_f32_bf16 v229, v170, v37
    v_dot2c_f32_bf16 v230, v171, v73
    v_dot2c_f32_bf16 v231, v171, v37
    v_dot2c_f32_bf16 v232, v172, v73
    v_dot2c_f32_bf16 v233, v172, v37
    v_dot2c_f32_bf16 v234, v173, v73
    v_dot2c_f32_bf16 v235, v173, v37
    v_dot2c_f32_bf16 v236, v174, v73
    v_dot2c_f32_bf16 v237, v174, v37
    v_dot2c_f32_bf16 v238, v175, v81
    v_dot2c_f32_bf16 v239, v175, v45
    v_dot2c_f32_bf16 v240, v176, v81
    v_dot2c_f32_bf16 v241, v176, v45
    v_dot2c_f32_bf16 v242, v177, v81
    v_dot2c_f32_bf16 v243, v177, v45
    v_dot2c_f32_bf16 v244, v178, v81
    v_dot2c_f32_bf16 v245, v178, v45
    v_dot2c_f32_bf16 v246, v179, v81
    v_dot2c_f32_bf16 v247, v179, v45
    v_dot2c_f32_bf16 v248, v180, v81
    v_dot2c_f32_bf16 v249, v180, v45
    v_dot2c_f32_bf16 v250, v181, v81
    v_dot2c_f32_bf16 v251, v181, v45
Lpad86:
    s_cbranch_execz Lret
    v_dot2c_f32_bf16 v252, v182, v81
    v_dot2c_f32_bf16 v253, v182, v45
    v_dot2c_f32_bf16 v254, v183, v81
    v_dot2c_f32_bf16 v255, v183, v45
    ds_read_b128 v[148:151], v96 offset:288
    ds_read_b128 v[152:155], v96 offset:304
    ds_read_b128 v[156:159], v96 offset:320
    ds_read_b128 v[160:163], v96 offset:336
    ds_read_b128 v[164:167], v96 offset:352
    ds_read_b128 v[168:171], v96 offset:368
    ds_read_b128 v[172:175], v96 offset:384
    ds_read_b128 v[176:179], v96 offset:400
    ds_read_b128 v[180:183], v96 offset:416
    s_waitcnt lgkmcnt(9)
    v_dot2c_f32_bf16 v184, v112, v58
    v_dot2c_f32_bf16 v185, v112, v22
    v_dot2c_f32_bf16 v186, v113, v58
    v_dot2c_f32_bf16 v187, v113, v22
    v_dot2c_f32_bf16 v188, v114, v58
    v_dot2c_f32_bf16 v189, v114, v22
Lpad87:
    s_cbranch_execz Lret
    v_dot2c_f32_bf16 v190, v115, v58
    v_dot2c_f32_bf16 v191, v115, v22
    v_dot2c_f32_bf16 v192, v116, v58
    v_dot2c_f32_bf16 v193, v116, v22
    v_dot2c_f32_bf16 v194, v117, v58
    v_dot2c_f32_bf16 v195, v117, v22
    v_dot2c_f32_bf16 v196, v118, v58
    v_dot2c_f32_bf16 v197, v118, v22
    v_dot2c_f32_bf16 v198, v119, v58
    v_dot2c_f32_bf16 v199, v119, v22
    v_dot2c_f32_bf16 v200, v120, v58
    v_dot2c_f32_bf16 v201, v120, v22
    v_dot2c_f32_bf16 v202, v121, v66
    v_dot2c_f32_bf16 v203, v121, v30
    v_dot2c_f32_bf16 v204, v122, v66
    v_dot2c_f32_bf16 v205, v122, v30
    v_dot2c_f32_bf16 v206, v123, v66
    v_dot2c_f32_bf16 v207, v123, v30
    v_dot2c_f32_bf16 v208, v124, v66
    v_dot2c_f32_bf16 v209, v124, v30
    v_dot2c_f32_bf16 v210, v125, v66
    v_dot2c_f32_bf16 v211, v125, v30
    v_dot2c_f32_bf16 v212, v126, v66
    v_dot2c_f32_bf16 v213, v126, v30
    v_dot2c_f32_bf16 v214, v127, v66
    v_dot2c_f32_bf16 v215, v127, v30
    v_dot2c_f32_bf16 v216, v128, v66
    v_dot2c_f32_bf16 v217, v128, v30
    v_dot2c_f32_bf16 v218, v129, v66
Lpad88:
    s_cbranch_execz Lret
    v_dot2c_f32_bf16 v219, v129, v30
    v_dot2c_f32_bf16 v220, v130, v74
    v_dot2c_f32_bf16 v221, v130, v38
    v_dot2c_f32_bf16 v222, v131, v74
    v_dot2c_f32_bf16 v223, v131, v38
    v_dot2c_f32_bf16 v224, v132, v74
    v_dot2c_f32_bf16 v225, v132, v38
    v_dot2c_f32_bf16 v226, v133, v74
    v_dot2c_f32_bf16 v227, v133, v38
    v_dot2c_f32_bf16 v228, v134, v74
    v_dot2c_f32_bf16 v229, v134, v38
    v_dot2c_f32_bf16 v230, v135, v74
    v_dot2c_f32_bf16 v231, v135, v38
    v_dot2c_f32_bf16 v232, v136, v74
    v_dot2c_f32_bf16 v233, v136, v38
    v_dot2c_f32_bf16 v234, v137, v74
    v_dot2c_f32_bf16 v235, v137, v38
    v_dot2c_f32_bf16 v236, v138, v74
    v_dot2c_f32_bf16 v237, v138, v38
    v_dot2c_f32_bf16 v238, v139, v82
    v_dot2c_f32_bf16 v239, v139, v46
    v_dot2c_f32_bf16 v240, v140, v82
    v_dot2c_f32_bf16 v241, v140, v46
    v_dot2c_f32_bf16 v242, v141, v82
    v_dot2c_f32_bf16 v243, v141, v46
    v_dot2c_f32_bf16 v244, v142, v82
    v_dot2c_f32_bf16 v245, v142, v46
    v_dot2c_f32_bf16 v246, v143, v82
    v_dot2c_f32_bf16 v247, v143, v46
Lpad89:
    s_cbranch_execz Lret
    v_dot2c_f32_bf16 v248, v144, v82
    v_dot2c_f32_bf16 v249, v144, v46
    v_dot2c_f32_bf16 v250, v145, v82
    v_dot2c_f32_bf16 v251, v145, v46
    v_dot2c_f32_bf16 v252, v146, v82
    v_dot2c_f32_bf16 v253, v146, v46
    v_dot2c_f32_bf16 v254, v147, v82
    v_dot2c_f32_bf16 v255, v147, v46
    s_waitcnt lgkmcnt(0)
    v_dot2c_f32_bf16 v184, v148, v59
    v_dot2c_f32_bf16 v185, v148, v23
    v_dot2c_f32_bf16 v186, v149, v59
    v_dot2c_f32_bf16 v187, v149, v23
    v_dot2c_f32_bf16 v188, v150, v59
    v_dot2c_f32_bf16 v189, v150, v23
    v_dot2c_f32_bf16 v190, v151, v59
    v_dot2c_f32_bf16 v191, v151, v23
    v_dot2c_f32_bf16 v192, v152, v59
    v_dot2c_f32_bf16 v193, v152, v23
    v_dot2c_f32_bf16 v194, v153, v59
    v_dot2c_f32_bf16 v195, v153, v23
    v_dot2c_f32_bf16 v196, v154, v59
    v_dot2c_f32_bf16 v197, v154, v23
    v_dot2c_f32_bf16 v198, v155, v59
    v_dot2c_f32_bf16 v199, v155, v23
    v_dot2c_f32_bf16 v200, v156, v59
    v_dot2c_f32_bf16 v201, v156, v23
    v_dot2c_f32_bf16 v202, v157, v67
    v_dot2c_f32_bf16 v203, v157, v31
Lpad90:
    s_cbranch_execz Lret
    v_dot2c_f32_bf16 v204, v158, v67
    v_dot2c_f32_bf16 v205, v158, v31
    v_dot2c_f32_bf16 v206, v159, v67
    v_dot2c_f32_bf16 v207, v159, v31
    v_dot2c_f32_bf16 v208, v160, v67
    v_dot2c_f32_bf16 v209, v160, v31
    v_dot2c_f32_bf16 v210, v161, v67
    v_dot2c_f32_bf16 v211, v161, v31
    v_dot2c_f32_bf16 v212, v162, v67
    v_dot2c_f32_bf16 v213, v162, v31
    v_dot2c_f32_bf16 v214, v163, v67
    v_dot2c_f32_bf16 v215, v163, v31
    v_dot2c_f32_bf16 v216, v164, v67
    v_dot2c_f32_bf16 v217, v164, v31
    v_dot2c_f32_bf16 v218, v165, v67
    v_dot2c_f32_bf16 v219, v165, v31
    v_dot2c_f32_bf16 v220, v166, v75
    v_dot2c_f32_bf16 v221, v166, v39
    v_dot2c_f32_bf16 v222, v167, v75
    v_dot2c_f32_bf16 v223, v167, v39
    v_dot2c_f32_bf16 v224, v168, v75
    v_dot2c_f32_bf16 v225, v168, v39
    v_dot2c_f32_bf16 v226, v169, v75
    v_dot2c_f32_bf16 v227, v169, v39
    v_dot2c_f32_bf16 v228, v170, v75
    v_dot2c_f32_bf16 v229, v170, v39
    v_dot2c_f32_bf16 v230, v171, v75
    v_dot2c_f32_bf16 v231, v171, v39
    v_dot2c_f32_bf16 v232, v172, v75
Lpad91:
    s_cbranch_execz Lret
    v_dot2c_f32_bf16 v233, v172, v39
    v_dot2c_f32_bf16 v234, v173, v75
    v_dot2c_f32_bf16 v235, v173, v39
    v_dot2c_f32_bf16 v236, v174, v75
    v_dot2c_f32_bf16 v237, v174, v39
    v_dot2c_f32_bf16 v238, v175, v83
    v_dot2c_f32_bf16 v239, v175, v47
    v_dot2c_f32_bf16 v240, v176, v83
    v_dot2c_f32_bf16 v241, v176, v47
    v_dot2c_f32_bf16 v242, v177, v83
    v_dot2c_f32_bf16 v243, v177, v47
    v_dot2c_f32_bf16 v244, v178, v83
    v_dot2c_f32_bf16 v245, v178, v47
    v_dot2c_f32_bf16 v246, v179, v83
    v_dot2c_f32_bf16 v247, v179, v47
    v_dot2c_f32_bf16 v248, v180, v83
    v_dot2c_f32_bf16 v249, v180, v47
    v_dot2c_f32_bf16 v250, v181, v83
    v_dot2c_f32_bf16 v251, v181, v47
    v_dot2c_f32_bf16 v252, v182, v83
    v_dot2c_f32_bf16 v253, v182, v47
    v_dot2c_f32_bf16 v254, v183, v83
    v_dot2c_f32_bf16 v255, v183, v47
    s_barrier
    s_add_u32 m0, s60, 73728
    s_add_u32 s55, s57, 384
    buffer_load_dwordx4 v9, s[4:7], s55 offen lds
Lpad92:
    s_cbranch_execz Lret
    s_add_u32 m0, s60, 74752
    s_add_u32 s55, s57, 9600
    buffer_load_dwordx4 v9, s[4:7], s55 offen lds
    s_add_u32 m0, s60, 75776
    s_add_u32 s55, s57, 18816
    buffer_load_dwordx4 v9, s[4:7], s55 offen lds
    s_add_u32 m0, s60, 76800
    s_add_u32 s55, s57, 28032
    buffer_load_dwordx4 v9, s[4:7], s55 offen lds
    s_add_u32 m0, s60, 77824
    s_add_u32 s55, s57, 37248
    buffer_load_dwordx4 v9, s[4:7], s55 offen lds
    s_add_u32 m0, s60, 98304
    s_add_u32 s55, s57, 512
    buffer_load_dwordx4 v9, s[4:7], s55 offen lds
Lpad93:
    s_cbranch_execz Lret
    s_add_u32 m0, s60, 99328
    s_add_u32 s55, s57, 9728
    buffer_load_dwordx4 v9, s[4:7], s55 offen lds
    s_add_u32 m0, s60, 100352
    s_add_u32 s55, s57, 18944
    buffer_load_dwordx4 v9, s[4:7], s55 offen lds
    s_add_u32 m0, s60, 101376
    s_add_u32 s55, s57, 28160
    buffer_load_dwordx4 v9, s[4:7], s55 offen lds
    s_add_u32 m0, s60, 102400
    s_add_u32 s55, s57, 37376
    buffer_load_dwordx4 v9, s[4:7], s55 offen lds
    v_cvt_pk_bf16_f32 v112, v184, v185
    v_cvt_pk_bf16_f32 v113, v186, v187
    v_cvt_pk_bf16_f32 v114, v188, v189
Lpad94:
    s_cbranch_execz Lret
    v_cvt_pk_bf16_f32 v115, v190, v191
    v_cvt_pk_bf16_f32 v116, v192, v193
    v_cvt_pk_bf16_f32 v117, v194, v195
    v_cvt_pk_bf16_f32 v118, v196, v197
    v_cvt_pk_bf16_f32 v119, v198, v199
    v_cvt_pk_bf16_f32 v120, v200, v201
    v_cvt_pk_bf16_f32 v121, v202, v203
    v_cvt_pk_bf16_f32 v122, v204, v205
    v_cvt_pk_bf16_f32 v123, v206, v207
    v_cvt_pk_bf16_f32 v124, v208, v209
    v_cvt_pk_bf16_f32 v125, v210, v211
    v_cvt_pk_bf16_f32 v126, v212, v213
    v_cvt_pk_bf16_f32 v127, v214, v215
    v_cvt_pk_bf16_f32 v128, v216, v217
    v_cvt_pk_bf16_f32 v129, v218, v219
Lpad95:
    s_cbranch_execz Lret
    v_cvt_pk_bf16_f32 v130, v220, v221
    v_cvt_pk_bf16_f32 v131, v222, v223
    v_cvt_pk_bf16_f32 v132, v224, v225
    v_cvt_pk_bf16_f32 v133, v226, v227
    v_cvt_pk_bf16_f32 v134, v228, v229
    v_cvt_pk_bf16_f32 v135, v230, v231
    v_cvt_pk_bf16_f32 v136, v232, v233
    v_cvt_pk_bf16_f32 v137, v234, v235
    v_cvt_pk_bf16_f32 v138, v236, v237
    v_cvt_pk_bf16_f32 v139, v238, v239
    v_cvt_pk_bf16_f32 v140, v240, v241
    v_cvt_pk_bf16_f32 v141, v242, v243
    v_cvt_pk_bf16_f32 v142, v244, v245
    v_cvt_pk_bf16_f32 v143, v246, v247
    v_cvt_pk_bf16_f32 v144, v248, v249
Lpad96:
    s_cbranch_execz Lret
    v_cvt_pk_bf16_f32 v145, v250, v251
    v_cvt_pk_bf16_f32 v146, v252, v253
    v_cvt_pk_bf16_f32 v147, v254, v255
    v_mov_b32 v148, v15
    v_xor_b32 v149, 64, v15
    s_mov_b32 s31, 0
    s_mov_b32 s28, 122880
    s_mov_b32 s30, 0
    s_add_u32 s24, s57, 512
    v_add_u32 v150, 8192, v9
    v_add_u32 v151, 16384, v9
    v_add_u32 v152, 24576, v9
    v_add_u32 v153, 36864, v9
    s_mov_b32 s25, 1073741824
    s_mov_b32 s26, s58
    s_waitcnt vmcnt(10)
    s_barrier
    ds_read_b64_tr_b16 a[0:1], v148 offset:0
Lpad97:
    s_cbranch_execz Lret
    ds_read_b64_tr_b16 a[2:3], v148 offset:512
    ds_read_b64_tr_b16 a[4:5], v148 offset:1024
    ds_read_b64_tr_b16 a[6:7], v148 offset:1536
    ds_read_b64_tr_b16 a[8:9], v148 offset:2048
    ds_read_b64_tr_b16 a[10:11], v148 offset:2560
    ds_read_b64_tr_b16 a[12:13], v148 offset:3072
    ds_read_b64_tr_b16 a[14:15], v148 offset:3584
    ds_read_b64_tr_b16 a[16:17], v148 offset:4096
    ds_read_b64_tr_b16 a[18:19], v148 offset:4608
    ds_read_b64_tr_b16 a[20:21], v148 offset:5120
    ds_read_b64_tr_b16 a[22:23], v148 offset:5632
    ds_read_b64_tr_b16 a[24:25], v148 offset:6144
    ds_read_b64_tr_b16 a[26:27], v148 offset:6656
    .p2align 6
Lwo4:
    ds_read_b64_tr_b16 a[28:29], v148 offset:7168
    ds_read_b64_tr_b16 a[30:31], v148 offset:7680
    s_waitcnt lgkmcnt(12)
    v_mfma_f32_32x32x16_bf16 v[16:31], a[0:3], v[112:115], 0
    s_add_u32 s29, s28, s60
    s_mov_b32 s28, s30
    s_add_u32 s24, s24, 128
    ds_read_b64_tr_b16 a[32:33], v148 offset:8192
    ds_read_b64_tr_b16 a[34:35], v148 offset:8704
    v_mfma_f32_32x32x16_bf16 v[16:31], a[4:7], v[116:119], v[16:31]
    s_add_u32 s30, s28, 24576
    buffer_store_dwordx4 v[48:51], v11, s[12:15], s25 offen offset:0 sc0 sc1
    ds_read_b64_tr_b16 a[0:1], v149 offset:0
    ds_read_b64_tr_b16 a[2:3], v149 offset:512
    s_waitcnt lgkmcnt(12)
    v_mfma_f32_32x32x16_bf16 v[16:31], a[8:11], v[120:123], v[16:31]
    v_cvt_pk_bf16_f32 v56, v32, v33
    v_cvt_pk_bf16_f32 v57, v34, v35
    v_cvt_pk_bf16_f32 v58, v36, v37
    ds_read_b64_tr_b16 a[4:5], v149 offset:1024
    ds_read_b64_tr_b16 a[6:7], v149 offset:1536
    v_mfma_f32_32x32x16_bf16 v[16:31], a[12:15], v[124:127], v[16:31]
    s_cmp_eq_u32 s30, 147456
    s_cselect_b32 s30, 0, s30
    buffer_store_dwordx4 v[52:55], v11, s[12:15], s25 offen offset:1024 sc0 sc1
    ds_read_b64_tr_b16 a[8:9], v149 offset:2048
    ds_read_b64_tr_b16 a[10:11], v149 offset:2560
    s_waitcnt lgkmcnt(12)
    v_mfma_f32_32x32x16_bf16 v[16:31], a[16:19], v[128:131], v[16:31]
    v_cvt_pk_bf16_f32 v59, v38, v39
    v_cvt_pk_bf16_f32 v60, v40, v41
    v_cvt_pk_bf16_f32 v61, v42, v43
    ds_read_b64_tr_b16 a[12:13], v149 offset:3072
    ds_read_b64_tr_b16 a[14:15], v149 offset:3584
    v_mfma_f32_32x32x16_bf16 v[16:31], a[20:23], v[132:135], v[16:31]
    buffer_store_dwordx4 v[56:59], v11, s[12:15], s25 offen offset:2048 sc0 sc1
    ds_read_b64_tr_b16 a[16:17], v149 offset:4096
    ds_read_b64_tr_b16 a[18:19], v149 offset:4608
    s_waitcnt lgkmcnt(12)
    v_mfma_f32_32x32x16_bf16 v[16:31], a[24:27], v[136:139], v[16:31]
    v_add_u32 v148, s30, v15
    v_cvt_pk_bf16_f32 v62, v44, v45
    v_cvt_pk_bf16_f32 v63, v46, v47
    ds_read_b64_tr_b16 a[20:21], v149 offset:5120
    ds_read_b64_tr_b16 a[22:23], v149 offset:5632
    v_mfma_f32_32x32x16_bf16 v[16:31], a[28:31], v[140:143], v[16:31]
    buffer_store_dwordx4 v[60:63], v11, s[12:15], s25 offen offset:3072 sc0 sc1
    ds_read_b64_tr_b16 a[24:25], v149 offset:6144
    ds_read_b64_tr_b16 a[26:27], v149 offset:6656
    s_waitcnt lgkmcnt(12)
    v_mfma_f32_32x32x16_bf16 v[16:31], a[32:35], v[144:147], v[16:31]
    s_waitcnt vmcnt(27)
    s_barrier
    s_add_u32 m0, s29, 0
    ds_read_b64_tr_b16 a[28:29], v149 offset:7168
    ds_read_b64_tr_b16 a[30:31], v149 offset:7680
    v_mfma_f32_32x32x16_bf16 v[32:47], a[0:3], v[112:115], 0
    buffer_load_dwordx4 v9, s[4:7], s24 offen offset:0 lds
    ds_read_b64_tr_b16 a[32:33], v149 offset:8192
    ds_read_b64_tr_b16 a[34:35], v149 offset:8704
    s_waitcnt lgkmcnt(12)
    v_mfma_f32_32x32x16_bf16 v[32:47], a[4:7], v[116:119], v[32:47]
    v_xor_b32 v149, 64, v148
    s_mov_b32 s25, s26
    s_add_u32 s26, s26, 4096
    ds_read_b64_tr_b16 a[0:1], v148 offset:0
    ds_read_b64_tr_b16 a[2:3], v148 offset:512
    v_mfma_f32_32x32x16_bf16 v[32:47], a[8:11], v[120:123], v[32:47]
    buffer_load_dwordx4 v150, s[4:7], s24 offen offset:1024 lds
    ds_read_b64_tr_b16 a[4:5], v148 offset:1024
    ds_read_b64_tr_b16 a[6:7], v148 offset:1536
    s_waitcnt lgkmcnt(12)
    v_mfma_f32_32x32x16_bf16 v[32:47], a[12:15], v[124:127], v[32:47]
    v_cvt_pk_bf16_f32 v48, v16, v17
    v_cvt_pk_bf16_f32 v49, v18, v19
    v_cvt_pk_bf16_f32 v50, v20, v21
    ds_read_b64_tr_b16 a[8:9], v148 offset:2048
    ds_read_b64_tr_b16 a[10:11], v148 offset:2560
    v_mfma_f32_32x32x16_bf16 v[32:47], a[16:19], v[128:131], v[32:47]
    buffer_load_dwordx4 v151, s[4:7], s24 offen offset:2048 lds
    ds_read_b64_tr_b16 a[12:13], v148 offset:3072
    ds_read_b64_tr_b16 a[14:15], v148 offset:3584
    s_waitcnt lgkmcnt(12)
    v_mfma_f32_32x32x16_bf16 v[32:47], a[20:23], v[132:135], v[32:47]
    v_cvt_pk_bf16_f32 v51, v22, v23
    v_cvt_pk_bf16_f32 v52, v24, v25
    v_cvt_pk_bf16_f32 v53, v26, v27
    ds_read_b64_tr_b16 a[16:17], v148 offset:4096
    ds_read_b64_tr_b16 a[18:19], v148 offset:4608
    v_mfma_f32_32x32x16_bf16 v[32:47], a[24:27], v[136:139], v[32:47]
    buffer_load_dwordx4 v152, s[4:7], s24 offen offset:3072 lds
    ds_read_b64_tr_b16 a[20:21], v148 offset:5120
    ds_read_b64_tr_b16 a[22:23], v148 offset:5632
    s_waitcnt lgkmcnt(12)
    v_mfma_f32_32x32x16_bf16 v[32:47], a[28:31], v[140:143], v[32:47]
    s_add_u32 m0, s29, 4096
    v_cvt_pk_bf16_f32 v54, v28, v29
    v_cvt_pk_bf16_f32 v55, v30, v31
    ds_read_b64_tr_b16 a[24:25], v148 offset:6144
    ds_read_b64_tr_b16 a[26:27], v148 offset:6656
    v_mfma_f32_32x32x16_bf16 v[32:47], a[32:35], v[144:147], v[32:47]
    buffer_load_dwordx4 v153, s[4:7], s24 offen offset:0 lds
    s_add_u32 s31, s31, 1
    s_cmp_lt_u32 s31, 4
    s_cbranch_scc1 Lwo4
    .p2align 6
Lwo9:
    ds_read_b64_tr_b16 a[28:29], v148 offset:7168
    ds_read_b64_tr_b16 a[30:31], v148 offset:7680
    s_waitcnt lgkmcnt(12)
    v_mfma_f32_32x32x16_bf16 v[16:31], a[0:3], v[112:115], 0
    s_mov_b32 s28, s30
    ds_read_b64_tr_b16 a[32:33], v148 offset:8192
    ds_read_b64_tr_b16 a[34:35], v148 offset:8704
    v_mfma_f32_32x32x16_bf16 v[16:31], a[4:7], v[116:119], v[16:31]
    s_add_u32 s30, s28, 24576
    buffer_store_dwordx4 v[48:51], v11, s[12:15], s25 offen offset:0 sc0 sc1
    ds_read_b64_tr_b16 a[0:1], v149 offset:0
    ds_read_b64_tr_b16 a[2:3], v149 offset:512
    s_waitcnt lgkmcnt(12)
    v_mfma_f32_32x32x16_bf16 v[16:31], a[8:11], v[120:123], v[16:31]
    v_cvt_pk_bf16_f32 v56, v32, v33
    v_cvt_pk_bf16_f32 v57, v34, v35
    v_cvt_pk_bf16_f32 v58, v36, v37
    ds_read_b64_tr_b16 a[4:5], v149 offset:1024
    ds_read_b64_tr_b16 a[6:7], v149 offset:1536
    v_mfma_f32_32x32x16_bf16 v[16:31], a[12:15], v[124:127], v[16:31]
    s_cmp_eq_u32 s30, 147456
    s_cselect_b32 s30, 0, s30
    buffer_store_dwordx4 v[52:55], v11, s[12:15], s25 offen offset:1024 sc0 sc1
    ds_read_b64_tr_b16 a[8:9], v149 offset:2048
    ds_read_b64_tr_b16 a[10:11], v149 offset:2560
    s_waitcnt lgkmcnt(12)
    v_mfma_f32_32x32x16_bf16 v[16:31], a[16:19], v[128:131], v[16:31]
    v_cvt_pk_bf16_f32 v59, v38, v39
    v_cvt_pk_bf16_f32 v60, v40, v41
    v_cvt_pk_bf16_f32 v61, v42, v43
    ds_read_b64_tr_b16 a[12:13], v149 offset:3072
    ds_read_b64_tr_b16 a[14:15], v149 offset:3584
    v_mfma_f32_32x32x16_bf16 v[16:31], a[20:23], v[132:135], v[16:31]
    buffer_store_dwordx4 v[56:59], v11, s[12:15], s25 offen offset:2048 sc0 sc1
    ds_read_b64_tr_b16 a[16:17], v149 offset:4096
    ds_read_b64_tr_b16 a[18:19], v149 offset:4608
    s_waitcnt lgkmcnt(12)
    v_mfma_f32_32x32x16_bf16 v[16:31], a[24:27], v[136:139], v[16:31]
    v_add_u32 v148, s30, v15
    v_cvt_pk_bf16_f32 v62, v44, v45
    v_cvt_pk_bf16_f32 v63, v46, v47
    ds_read_b64_tr_b16 a[20:21], v149 offset:5120
    ds_read_b64_tr_b16 a[22:23], v149 offset:5632
    v_mfma_f32_32x32x16_bf16 v[16:31], a[28:31], v[140:143], v[16:31]
    buffer_store_dwordx4 v[60:63], v11, s[12:15], s25 offen offset:3072 sc0 sc1
    ds_read_b64_tr_b16 a[24:25], v149 offset:6144
    ds_read_b64_tr_b16 a[26:27], v149 offset:6656
    s_waitcnt lgkmcnt(12)
    v_mfma_f32_32x32x16_bf16 v[16:31], a[32:35], v[144:147], v[16:31]
    s_waitcnt vmcnt(16)
    s_barrier
    ds_read_b64_tr_b16 a[28:29], v149 offset:7168
    ds_read_b64_tr_b16 a[30:31], v149 offset:7680
    v_mfma_f32_32x32x16_bf16 v[32:47], a[0:3], v[112:115], 0
    ds_read_b64_tr_b16 a[32:33], v149 offset:8192
    ds_read_b64_tr_b16 a[34:35], v149 offset:8704
    s_waitcnt lgkmcnt(12)
    v_mfma_f32_32x32x16_bf16 v[32:47], a[4:7], v[116:119], v[32:47]
    v_xor_b32 v149, 64, v148
    s_mov_b32 s25, s26
    s_add_u32 s26, s26, 4096
    ds_read_b64_tr_b16 a[0:1], v148 offset:0
    ds_read_b64_tr_b16 a[2:3], v148 offset:512
    v_mfma_f32_32x32x16_bf16 v[32:47], a[8:11], v[120:123], v[32:47]
    ds_read_b64_tr_b16 a[4:5], v148 offset:1024
    ds_read_b64_tr_b16 a[6:7], v148 offset:1536
    s_waitcnt lgkmcnt(12)
    v_mfma_f32_32x32x16_bf16 v[32:47], a[12:15], v[124:127], v[32:47]
    v_cvt_pk_bf16_f32 v48, v16, v17
    v_cvt_pk_bf16_f32 v49, v18, v19
    v_cvt_pk_bf16_f32 v50, v20, v21
    ds_read_b64_tr_b16 a[8:9], v148 offset:2048
    ds_read_b64_tr_b16 a[10:11], v148 offset:2560
    v_mfma_f32_32x32x16_bf16 v[32:47], a[16:19], v[128:131], v[32:47]
    ds_read_b64_tr_b16 a[12:13], v148 offset:3072
    ds_read_b64_tr_b16 a[14:15], v148 offset:3584
    s_waitcnt lgkmcnt(12)
    v_mfma_f32_32x32x16_bf16 v[32:47], a[20:23], v[132:135], v[32:47]
    v_cvt_pk_bf16_f32 v51, v22, v23
    v_cvt_pk_bf16_f32 v52, v24, v25
    v_cvt_pk_bf16_f32 v53, v26, v27
    ds_read_b64_tr_b16 a[16:17], v148 offset:4096
    ds_read_b64_tr_b16 a[18:19], v148 offset:4608
    v_mfma_f32_32x32x16_bf16 v[32:47], a[24:27], v[136:139], v[32:47]
    ds_read_b64_tr_b16 a[20:21], v148 offset:5120
    ds_read_b64_tr_b16 a[22:23], v148 offset:5632
    s_waitcnt lgkmcnt(12)
    v_mfma_f32_32x32x16_bf16 v[32:47], a[28:31], v[140:143], v[32:47]
    v_cvt_pk_bf16_f32 v54, v28, v29
    v_cvt_pk_bf16_f32 v55, v30, v31
    ds_read_b64_tr_b16 a[24:25], v148 offset:6144
    ds_read_b64_tr_b16 a[26:27], v148 offset:6656
    v_mfma_f32_32x32x16_bf16 v[32:47], a[32:35], v[144:147], v[32:47]
    s_add_u32 s31, s31, 1
    s_cmp_lt_u32 s31, 9
    s_cbranch_scc1 Lwo9
    buffer_store_dwordx4 v[48:51], v11, s[12:15], s25 offen offset:0 sc0 sc1
Lpad98:
    s_cbranch_execz Lret
    buffer_store_dwordx4 v[52:55], v11, s[12:15], s25 offen offset:1024 sc0 sc1
    s_nop 7
    s_nop 7
    v_cvt_pk_bf16_f32 v56, v32, v33
    v_cvt_pk_bf16_f32 v57, v34, v35
    v_cvt_pk_bf16_f32 v58, v36, v37
    v_cvt_pk_bf16_f32 v59, v38, v39
    v_cvt_pk_bf16_f32 v60, v40, v41
    v_cvt_pk_bf16_f32 v61, v42, v43
    v_cvt_pk_bf16_f32 v62, v44, v45
    v_cvt_pk_bf16_f32 v63, v46, v47
    buffer_store_dwordx4 v[56:59], v11, s[12:15], s25 offen offset:2048 sc0 sc1
    buffer_store_dwordx4 v[60:63], v11, s[12:15], s25 offen offset:3072 sc0 sc1
    s_waitcnt vmcnt(0)
    s_barrier
    s_cmp_eq_u32 s20, 0
    s_cbranch_scc0 Lnosig_a
    v_accvgpr_read_b32 v78, a60
Lpad99:
    s_cbranch_execz Lret
    s_nop 1
    v_cmp_eq_u32 vcc, 1, v78
    s_nop 3
    s_cmp_eq_u32 vcc_lo, -1
    s_cbranch_scc1 Lrdy_a
    s_lshl_b32 s62, s21, 4
    s_mov_b32 s61, 0x4000
Lpoll_ra:
    buffer_load_dword v76, off, s[16:19], s62 sc0 sc1
    s_waitcnt vmcnt(0)
    v_readfirstlane_b32 s56, v76
    s_nop 3
    s_and_b32 s56, s56, 1
    s_cmp_eq_u32 s56, 1
    s_cbranch_scc1 Lpollok_ra
    s_sleep 4
    s_sub_u32 s61, s61, 1
    s_cbranch_scc0 Lpoll_ra
Lpollok_ra:
Lrdy_a:
    s_mul_i32 s62, s21, 1536
    s_lshl_b32 s63, s22, 2
    s_add_u32 s62, s62, s63
    s_add_u32 s62, s62, 38338560
    v_lshlrev_b32 v77, 7, v1
    v_mov_b32 v79, 1073741824
    v_cmp_gt_u32 vcc, 12, v1
Lpad100:
    s_cbranch_execz Lret
    s_nop 1
    v_cndmask_b32 v77, v79, v77, vcc
    v_mov_b32 v76, 1
    buffer_store_dword v76, v77, s[12:15], s62 offen sc0 sc1
Lnosig_a:
    s_endpgm
Lend1:
    s_endpgm
.section .rodata,"a"
.p2align 6
.amdhsa_kernel recurrent_scan__sliding_local_dilated__dense_activation_relu__prompt_kernel
  .amdhsa_next_free_vgpr 512
  .amdhsa_next_free_sgpr 102
  .amdhsa_accum_offset 256
  .amdhsa_group_segment_fixed_size 0
  .amdhsa_kernarg_size 72
  .amdhsa_user_sgpr_count 2
  .amdhsa_user_sgpr_kernarg_segment_ptr 1
  .amdhsa_system_sgpr_workgroup_id_x 1
.end_amdhsa_kernel
```
